```python
import torch

def _softmax(x, axis=-1):
    return torch.softmax(x, dim=axis)
def _gelu(x):
    return torch.nn.functional.gelu(x, approximate="tanh")
def _silu(x):
    return torch.nn.functional.silu(x)
def _sigmoid(x):
    return torch.sigmoid(x)
def _layernorm(x, axis=-1, eps=1e-5):
    m = x.mean(dim=axis, keepdim=True)
    v = x.var(dim=axis, keepdim=True, unbiased=False)
    return (x - m) / torch.sqrt(v + eps)
def _scatter_add(tgt, idx, src, axis=0):
    return tgt.clone().index_add_(axis, idx, src)
def _segment_sum(src, seg, n):
    out = torch.zeros((n,) + src.shape[1:], dtype=src.dtype)
    return out.index_add_(0, seg, src)
def _pad(x, pw):
    flat = tuple(v for pair in reversed(pw) for v in pair)
    return torch.nn.functional.pad(x, flat)

kernel_name = 'parallel_sum__ssm_conv_h3__glu_gated_bilinear__prompt'

def setup_inputs():

    _w = (lambda a: (lambda t: t.to(torch.bfloat16) if t.is_floating_point() else t)(torch.as_tensor(a)))
    def _A_setup():
        B, S, D = 1, 2048, 640
        ks = 4
        return {
            "q": _w((lambda *s: torch.randn(*s, dtype=torch.bfloat16) * 0.05)(B, S, D)),
            "k": _w((lambda *s: torch.randn(*s, dtype=torch.bfloat16) * 0.2)(B, S, D)),
            "v": _w((lambda *s: torch.randn(*s, dtype=torch.bfloat16) * 0.2)(B, S, D)),
            "shift_k": _w((lambda *s: torch.randn(*s, dtype=torch.bfloat16) * 0.2)(D, ks) * 0.5),
            "ssm_k": _w((lambda *s: torch.randn(*s, dtype=torch.bfloat16) * 0.4)(D, S) * (1.0 / S ** 0.5)),
            "ssm_D": _w((lambda *s: torch.randn(*s, dtype=torch.bfloat16) * 0.2)(D)),
        }
    _A_in = _A_setup()

    def _B_setup():
        B, S, D, F = 1, 2048, 640, 1728
        return {
            "x": _w((lambda *s: torch.randn(*s, dtype=torch.bfloat16) * 0.05)(B, S, D)),
            "w_gate": _w((lambda *s: torch.randn(*s, dtype=torch.bfloat16) * 0.2)(D, F) * (D ** -0.5)),
            "w_up": _w((lambda *s: torch.randn(*s, dtype=torch.bfloat16) * 0.2)(D, F) * (D ** -0.5)),
            "w_down": _w((lambda *s: torch.randn(*s, dtype=torch.bfloat16) * 0.2)(F, D) * (F ** -0.5)),
        }
    _B_in = _B_setup()

    return {
        "A_q": _A_in["q"],
        "A_k": _A_in["k"],
        "A_v": _A_in["v"],
        "A_shift_k": _A_in["shift_k"],
        "A_ssm_k": _A_in["ssm_k"],
        "A_ssm_D": _A_in["ssm_D"],
        "B_x": _B_in["x"],
        "B_w_gate": _B_in["w_gate"],
        "B_w_up": _B_in["w_up"],
        "B_w_down": _B_in["w_down"],
    }

def reference(A_q, A_k, A_v, A_shift_k, A_ssm_k, A_ssm_D, B_x, B_w_gate, B_w_up, B_w_down):
    def _A_ref(q, k, v, shift_k, ssm_k, ssm_D):
        B, S, D = q.shape
        ks = shift_k.shape[-1]
        k_pad = _pad(k, ((0, 0), (ks - 1, 0), (0, 0)))
        k_shift = torch.zeros_like(k)
        for t in range(ks):
            k_shift = k_shift + k_pad[:, t:t + S, :] * shift_k[:, ks - 1 - t][None, None, :]
        kv = k_shift * v
        L = 2 * S
        kv_pad = _pad(kv, ((0, 0), (0, S), (0, 0)))
        kf_pad = _pad(ssm_k, ((0, 0), (0, S)))
        kv_f = (lambda x, axes=(-2,-1): torch.fft.rfft2(x.float(), dim=axes))(kv_pad[:, None, :, :], axes=(1, 2))
        kf_f = (lambda x, axes=(-2,-1): torch.fft.rfft2(x.float(), dim=axes))(kf_pad[:, None, :], axes=(1, 2))
        kf_f = (lambda x, *d: x.permute(*d))(kf_f, 1, 2, 0)
        y_f = kv_f * kf_f[None, :, :, :]
        y = (lambda x, s, axes=(-2,-1): torch.fft.irfft2(x, s=s, dim=axes).to(torch.bfloat16))(y_f, (1, L), axes=(1, 2))[:, 0, :S, :]
        y = y + kv * ssm_D[None, None, :]
        return q * y

    def _B_ref(x, w_gate, w_up, w_down):
        g = torch.einsum("bsd,df->bsf", x, w_gate)
        u = torch.einsum("bsd,df->bsf", x, w_up)
        h = g * u
        return torch.einsum("bsf,fd->bsd", h, w_down)

    x = A_q
    xn = _layernorm(x, axis=-1)
    return x + _A_ref(xn, A_k, A_v, A_shift_k, A_ssm_k, A_ssm_D) + _B_ref(xn, B_w_gate, B_w_up, B_w_down)
```

```asm
; @launch kernel=mid_kernel grid=(256,1,1) block=(512,1,1) lds=163840
; @launch kernel=fin_kernel grid=(256,1,1) block=(512,1,1) lds=131072
.amdgcn_target "amdgcn-amd-amdhsa--gfx950"
.text
.globl mid_kernel
.p2align 12
.p2align 8
.type mid_kernel,@function
mid_kernel:
    s_cmp_ge_u32 s2, 256
    s_cbranch_scc1 M_exit
    s_load_dwordx2 s[6:7], s[0:1], 96
    s_cmp_ge_u32 s2, 16
    s_cbranch_scc1 M_nocw0
    s_getpc_b64 s[8:9]
M_pc0:
    v_lshlrev_b32 v1, 7, v0
    v_min_u32 v1, CODE_END-M_pc0-4, v1
    global_load_dword v253, v1, s[8:9]
M_nocw0:
    v_lshrrev_b32 v1, 6, v0
    s_nop 0
    v_readfirstlane_b32 s3, v1
    s_lshr_b32 s40, s2, 3
    s_andn2_b32 s41, 1, s2
    s_bfe_u32 s42, s2, 0x20001
    s_lshl_b32 s43, s41, 2
    s_sub_u32 s43, 24, s43
    s_cmp_ge_u32 s40, s43
    s_cbranch_scc1 M_noipf
    s_cmp_ge_u32 s3, 4
    s_cbranch_scc1 M_noipf
    s_lshl_b32 s8, s3, 3
    s_add_u32 s8, s8, 56
    s_cmp_ge_u32 s3, 2
    s_cselect_b32 s8, 0, s8
    s_load_dwordx2 s[12:13], s[0:1], s8
    v_and_b32 v1, 63, v0
    s_mov_b32 s15, 0x00020000
    s_cbranch_scc1 M_ipfx
    v_lshrrev_b32 v2, 4, v1
    v_and_b32 v3, 15, v1
    s_mul_i32 s9, s41, 3
    s_sub_u32 s9, 14, s9
    v_min_u32 v3, s9, v3
    v_mul_u32_u24 v2, 3456, v2
    v_lshl_add_u32 v2, v3, 7, v2
    s_mul_i32 s9, s40, 13824
    s_mul_i32 s10, s41, 1920
    s_add_u32 s9, s9, s10
    s_mul_i32 s10, s43, 13824
    s_mov_b32 s14, 2211840
    s_waitcnt lgkmcnt(0)
    buffer_load_dword v255, v2, s[12:15], s9 offen
    s_branch M_noipf
M_ipfx:
    s_cmp_ge_u32 s40, 16
    s_cbranch_scc1 M_noipf
    s_cmp_ge_u32 s3, 3
    s_cbranch_scc1 M_noipf
    v_lshrrev_b32 v2, 1, v1
    v_and_b32 v3, 1, v1
    v_mul_u32_u24 v2, 0x500, v2
    v_lshl_add_u32 v2, v3, 7, v2
    s_lshl_b32 s9, s42, 4
    s_add_u32 s9, s9, s40
    s_mul_i32 s9, s9, 40960
    s_lshl_b32 s10, s3, 8
    s_add_u32 s9, s9, s10
    s_sub_u32 s9, s9, 512
    s_mov_b32 s14, 2621440
    s_waitcnt lgkmcnt(0)
    buffer_load_dword v255, v2, s[12:15], s9 offen
M_noipf:
    s_and_b32 s8, s3, 1
    s_lshl_b32 s8, s8, 3
    s_add_u32 s8, s8, 8
    s_load_dwordx2 s[8:9], s[0:1], s8
    s_mov_b32 s54, 0
    s_mov_b32 s56, 0
    s_mov_b32 s57, 0
    s_lshr_b32 s12, s3, 1
    s_cmp_ge_u32 s40, s43
    s_cselect_b32 s13, 2, 0
    s_xor_b32 s12, s12, s13
    s_cmp_gt_u32 s12, 0
    s_cbranch_scc1 M_nokvpf
    s_mul_i32 s13, s42, 192
    s_add_u32 s13, s13, 512
    s_and_b32 s13, s13, 0xffffff80
    s_lshl_b32 s14, s42, 7
    s_cmp_eq_u32 s41, 0
    s_cselect_b32 s13, s14, s13
    s_lshl_b32 s12, s12, 7
    s_add_u32 s13, s13, s12
    s_xor_b32 s12, s40, 16
    s_mul_i32 s12, s12, 81920
    s_add_u32 s13, s13, s12
    s_cmp_eq_u32 s41, 0
    s_cselect_b32 s57, 0x40000000, s13
    s_mov_b32 s56, s13
    s_cmp_lt_u32 s40, 16
    s_cselect_b32 s54, 2621440, 0
    s_cbranch_scc1 M_nokvpf
    v_and_b32 v1, 63, v0
    v_mul_u32_u24 v1, 0x500, v1
    s_mov_b32 s10, 2621440
    s_mov_b32 s11, 0x00020000
    s_waitcnt lgkmcnt(0)
    s_bitcmp1_b32 s3, 0
    s_cbranch_scc0 M_novd
    s_sleep 8
M_novd:
    buffer_load_dword v255, v1, s[8:11], s13 offen
    buffer_load_dword v255, v1, s[8:11], s57 offen offset:128
M_nokvpf:
    s_waitcnt lgkmcnt(0)
    s_mov_b64 s[52:53], s[8:9]
    s_mov_b32 s55, 0x00020000
    s_cmp_ge_u32 s40, s43
    s_cbranch_scc1 M_conv
    s_mul_i32 s24, s42, s43
    s_add_u32 s24, s24, s40
    s_mul_i32 s25, s41, 96
    s_add_u32 s24, s24, s25
    s_load_dwordx4 s[16:19], s[0:1], 56
    s_load_dwordx2 s[44:45], s[0:1], 0
    s_mov_b32 s47, s24
    s_sub_u32 s25, s3, 6
    s_mul_i32 s25, s25, 176
    s_add_u32 s24, s24, s25
    s_mov_b32 s46, s24
    s_lshl_b32 s24, s42, 2
    s_and_b32 s25, s40, 3
    s_add_u32 s24, s24, s25
    s_mul_i32 s25, s41, 6
    s_lshr_b32 s26, s40, 2
    s_add_u32 s25, s25, s26
    s_mul_i32 s25, s25, 160
    s_min_u32 s25, s25, 1568
    v_and_b32 v1, 63, v0
    s_cmp_lt_u32 s3, 4
    s_cbranch_scc1 G1_cons
    s_and_b32 s26, s3, 3
    s_lshl_b32 s27, s24, 7
    s_lshl_b32 s28, s26, 5
    s_add_u32 s27, s27, s28
    v_lshrrev_b32 v12, 3, v1
    v_xor_b32 v11, v12, v1
    v_and_b32 v11, 7, v11
    v_add_u32 v13, s27, v12
    v_lshlrev_b32 v7, 3, v13
    v_mul_u32_u24 v13, 0x500, v13
    v_lshl_add_u32 v13, v11, 4, v13
    v_add_u32 v14, 9216, v13
    v_add_u32 v15, 18432, v13
    v_add_u32 v16, 27648, v13
    s_lshl_b32 s30, s26, 12
    s_add_u32 s30, s30, 122880
    v_lshl_add_u32 v6, v1, 4, s30
    s_lshl_b32 s28, s26, 8
    s_add_u32 s28, s28, 155648
    v_lshl_add_u32 v5, v12, 3, s28
    s_lshl_b32 s27, s25, 1
    s_and_b32 s28, s26, 1
    s_mul_i32 s28, s28, 320
    v_add_u32 v20, s28, v1
    v_mul_u32_u24 v21, 3277, v20
    v_lshrrev_b32 v21, 16, v21
    v_mul_u32_u24 v22, 20, v21
    v_sub_u32 v22, v20, v22
    v_bfe_u32 v23, v21, 3, 1
    v_lshlrev_b32 v23, 1, v23
    v_xor_b32 v22, v22, v23
    v_mul_u32_u24 v21, 3456, v21
    v_lshl_add_u32 v21, v22, 4, v21
    v_add_u32 v21, s27, v21
    v_subrev_u32 v24, 0, v21
    v_add_u32 v20, s28, v1
    v_add_u32 v20, 64, v20
    v_mul_u32_u24 v21, 3277, v20
    v_lshrrev_b32 v21, 16, v21
    v_mul_u32_u24 v22, 20, v21
    v_sub_u32 v22, v20, v22
    v_bfe_u32 v23, v21, 3, 1
    v_lshlrev_b32 v23, 1, v23
    v_xor_b32 v22, v22, v23
    v_mul_u32_u24 v21, 3456, v21
    v_lshl_add_u32 v21, v22, 4, v21
    v_add_u32 v21, s27, v21
    v_subrev_u32 v25, 1024, v21
    v_add_u32 v20, s28, v1
    v_add_u32 v20, 128, v20
    v_mul_u32_u24 v21, 3277, v20
    v_lshrrev_b32 v21, 16, v21
    v_mul_u32_u24 v22, 20, v21
    v_sub_u32 v22, v20, v22
    v_bfe_u32 v23, v21, 3, 1
    v_lshlrev_b32 v23, 1, v23
    v_xor_b32 v22, v22, v23
    v_mul_u32_u24 v21, 3456, v21
    v_lshl_add_u32 v21, v22, 4, v21
    v_add_u32 v21, s27, v21
    v_subrev_u32 v26, 2048, v21
    v_add_u32 v20, s28, v1
    v_add_u32 v20, 192, v20
    v_mul_u32_u24 v21, 3277, v20
    v_lshrrev_b32 v21, 16, v21
    v_mul_u32_u24 v22, 20, v21
    v_sub_u32 v22, v20, v22
    v_bfe_u32 v23, v21, 3, 1
    v_lshlrev_b32 v23, 1, v23
    v_xor_b32 v22, v22, v23
    v_mul_u32_u24 v21, 3456, v21
    v_lshl_add_u32 v21, v22, 4, v21
    v_add_u32 v21, s27, v21
    v_subrev_u32 v27, 3072, v21
    v_add_u32 v20, s28, v1
    v_add_u32 v20, 256, v20
    v_mul_u32_u24 v21, 3277, v20
    v_lshrrev_b32 v21, 16, v21
    v_mul_u32_u24 v22, 20, v21
    v_sub_u32 v22, v20, v22
    v_bfe_u32 v23, v21, 3, 1
    v_lshlrev_b32 v23, 1, v23
    v_xor_b32 v22, v22, v23
    v_mul_u32_u24 v21, 3456, v21
    v_lshl_add_u32 v21, v22, 4, v21
    v_add_u32 v21, s27, v21
    v_subrev_u32 v28, 0, v21
    s_mul_i32 s29, s26, 5120
    s_waitcnt lgkmcnt(0)
    s_cmp_ge_u32 s26, 2
    s_cselect_b32 s4, s18, s16
    s_cselect_b32 s5, s19, s17
    s_mov_b32 s8, s4
    s_mov_b32 s9, s5
    s_mov_b32 s10, 0x21c000
    s_mov_b32 s11, 0x00020000
    s_mov_b32 s12, s44
    s_mov_b32 s13, s45
    s_mov_b32 s14, 0x280000
    s_mov_b32 s15, 0x00020000
    s_movk_i32 s31, 0
    s_add_u32 m0, s30, 0
    s_nop 0
    buffer_load_dwordx4 v13, s[12:15], s31 offen offset:0 lds
    buffer_load_dwordx4 v14, s[12:15], s31 offen offset:1024 lds
    buffer_load_dwordx4 v15, s[12:15], s31 offen offset:2048 lds
    buffer_load_dwordx4 v16, s[12:15], s31 offen offset:3072 lds
    s_mov_b32 s28, 0
    s_add_u32 m0, s29, 0
    s_nop 0
    buffer_load_dwordx4 v24, s[8:11], s28 offen offset:0 lds
    buffer_load_dwordx4 v25, s[8:11], s28 offen offset:1024 lds
    buffer_load_dwordx4 v26, s[8:11], s28 offen offset:2048 lds
    buffer_load_dwordx4 v27, s[8:11], s28 offen offset:3072 lds
    s_add_u32 m0, s29, 4096
    s_nop 0
    buffer_load_dwordx4 v28, s[8:11], s28 offen offset:0 lds
    s_mov_b32 s28, 110592
    s_add_u32 m0, s29, 20480
    s_nop 0
    buffer_load_dwordx4 v24, s[8:11], s28 offen offset:0 lds
    buffer_load_dwordx4 v25, s[8:11], s28 offen offset:1024 lds
    buffer_load_dwordx4 v26, s[8:11], s28 offen offset:2048 lds
    buffer_load_dwordx4 v27, s[8:11], s28 offen offset:3072 lds
    s_add_u32 m0, s29, 24576
    s_nop 0
    buffer_load_dwordx4 v28, s[8:11], s28 offen offset:0 lds
    s_add_u32 s20, s6, 0x1400000
    s_addc_u32 s21, s7, 0
    s_mov_b32 s22, 0x4000
    s_mov_b32 s23, 0x00020000
    v_mov_b32 v40, 0
    v_mov_b32 v41, 0
    v_mov_b32 v42, 0
    v_mov_b32 v43, 0
    v_mov_b32 v44, 0
    v_mov_b32 v45, 0
    v_mov_b32 v46, 0
    v_mov_b32 v47, 0
    s_mov_b32 s51, 0x3f803f80
    v_mov_b32 v160, 0
    v_mov_b32 v161, 0
    v_mov_b32 v162, 0
    v_mov_b32 v163, 0
    v_mov_b32 v164, 0
    v_mov_b32 v165, 0
    v_mov_b32 v166, 0
    v_mov_b32 v167, 0
    v_mov_b32 v168, 0
    v_mov_b32 v169, 0
    v_mov_b32 v170, 0
    v_mov_b32 v171, 0
    v_mov_b32 v172, 0
    v_mov_b32 v173, 0
    v_mov_b32 v174, 0
    v_mov_b32 v175, 0
    s_waitcnt vmcnt(5)
    s_barrier
    ds_read_b128 v[140:143], v6 offset:0
    ds_read_b128 v[144:147], v6 offset:1024
    ds_read_b128 v[148:151], v6 offset:2048
    ds_read_b128 v[152:155], v6 offset:3072
    s_movk_i32 s31, 128
    s_add_u32 m0, s30, 16384
    s_nop 0
    buffer_load_dwordx4 v13, s[12:15], s31 offen offset:0 lds
    buffer_load_dwordx4 v14, s[12:15], s31 offen offset:1024 lds
    s_waitcnt lgkmcnt(0)
    v_lshlrev_b32 v32, 16, v140
    v_and_b32 v33, 0xffff0000, v140
    v_add_f32 v160, v160, v32
    v_fmac_f32 v168, v32, v32
    v_add_f32 v161, v161, v33
    v_fmac_f32 v169, v33, v33
    buffer_load_dwordx4 v15, s[12:15], s31 offen offset:2048 lds
    v_lshlrev_b32 v34, 16, v144
    v_and_b32 v35, 0xffff0000, v144
    v_add_f32 v162, v162, v34
    v_fmac_f32 v170, v34, v34
    v_add_f32 v163, v163, v35
    v_fmac_f32 v171, v35, v35
    buffer_load_dwordx4 v16, s[12:15], s31 offen offset:3072 lds
    v_lshlrev_b32 v36, 16, v148
    v_and_b32 v37, 0xffff0000, v148
    v_add_f32 v164, v164, v36
    v_fmac_f32 v172, v36, v36
    v_add_f32 v165, v165, v37
    v_fmac_f32 v173, v37, v37
    s_mov_b32 s28, 221184
    s_add_u32 m0, s29, 40960
    s_nop 0
    buffer_load_dwordx4 v24, s[8:11], s28 offen offset:0 lds
    v_lshlrev_b32 v38, 16, v152
    v_and_b32 v39, 0xffff0000, v152
    v_add_f32 v166, v166, v38
    v_fmac_f32 v174, v38, v38
    v_add_f32 v167, v167, v39
    v_fmac_f32 v175, v39, v39
    buffer_load_dwordx4 v25, s[8:11], s28 offen offset:1024 lds
    v_lshlrev_b32 v32, 16, v141
    v_and_b32 v33, 0xffff0000, v141
    v_add_f32 v160, v160, v32
    v_fmac_f32 v168, v32, v32
    v_add_f32 v161, v161, v33
    v_fmac_f32 v169, v33, v33
    buffer_load_dwordx4 v26, s[8:11], s28 offen offset:2048 lds
    v_lshlrev_b32 v34, 16, v145
    v_and_b32 v35, 0xffff0000, v145
    v_add_f32 v162, v162, v34
    v_fmac_f32 v170, v34, v34
    v_add_f32 v163, v163, v35
    v_fmac_f32 v171, v35, v35
    buffer_load_dwordx4 v27, s[8:11], s28 offen offset:3072 lds
    v_lshlrev_b32 v36, 16, v149
    v_and_b32 v37, 0xffff0000, v149
    v_add_f32 v164, v164, v36
    v_fmac_f32 v172, v36, v36
    v_add_f32 v165, v165, v37
    v_fmac_f32 v173, v37, v37
    s_add_u32 m0, s29, 45056
    s_nop 0
    buffer_load_dwordx4 v28, s[8:11], s28 offen offset:0 lds
    v_lshlrev_b32 v38, 16, v153
    v_and_b32 v39, 0xffff0000, v153
    v_add_f32 v166, v166, v38
    v_fmac_f32 v174, v38, v38
    v_add_f32 v167, v167, v39
    v_fmac_f32 v175, v39, v39
    s_waitcnt vmcnt(9)
    s_barrier
    s_mov_b32 s28, 331776
    s_add_u32 m0, s29, 61440
    s_nop 0
    buffer_load_dwordx4 v24, s[8:11], s28 offen offset:0 lds
    buffer_load_dwordx4 v25, s[8:11], s28 offen offset:1024 lds
    v_lshlrev_b32 v32, 16, v142
    v_and_b32 v33, 0xffff0000, v142
    v_add_f32 v160, v160, v32
    v_fmac_f32 v168, v32, v32
    v_add_f32 v161, v161, v33
    v_fmac_f32 v169, v33, v33
    v_lshlrev_b32 v34, 16, v146
    v_and_b32 v35, 0xffff0000, v146
    v_add_f32 v162, v162, v34
    v_fmac_f32 v170, v34, v34
    v_add_f32 v163, v163, v35
    v_fmac_f32 v171, v35, v35
    buffer_load_dwordx4 v26, s[8:11], s28 offen offset:2048 lds
    v_lshlrev_b32 v36, 16, v150
    v_and_b32 v37, 0xffff0000, v150
    v_add_f32 v164, v164, v36
    v_fmac_f32 v172, v36, v36
    v_add_f32 v165, v165, v37
    v_fmac_f32 v173, v37, v37
    v_lshlrev_b32 v38, 16, v154
    v_and_b32 v39, 0xffff0000, v154
    v_add_f32 v166, v166, v38
    v_fmac_f32 v174, v38, v38
    v_add_f32 v167, v167, v39
    v_fmac_f32 v175, v39, v39
    buffer_load_dwordx4 v27, s[8:11], s28 offen offset:3072 lds
    v_lshlrev_b32 v32, 16, v143
    v_and_b32 v33, 0xffff0000, v143
    v_add_f32 v160, v160, v32
    v_fmac_f32 v168, v32, v32
    v_add_f32 v161, v161, v33
    v_fmac_f32 v169, v33, v33
    v_lshlrev_b32 v34, 16, v147
    v_and_b32 v35, 0xffff0000, v147
    v_add_f32 v162, v162, v34
    v_fmac_f32 v170, v34, v34
    v_add_f32 v163, v163, v35
    v_fmac_f32 v171, v35, v35
    s_add_u32 m0, s29, 65536
    s_nop 0
    buffer_load_dwordx4 v28, s[8:11], s28 offen offset:0 lds
    v_lshlrev_b32 v36, 16, v151
    v_and_b32 v37, 0xffff0000, v151
    v_add_f32 v164, v164, v36
    v_fmac_f32 v172, v36, v36
    v_add_f32 v165, v165, v37
    v_fmac_f32 v173, v37, v37
    v_lshlrev_b32 v38, 16, v155
    v_and_b32 v39, 0xffff0000, v155
    v_add_f32 v166, v166, v38
    v_fmac_f32 v174, v38, v38
    v_add_f32 v167, v167, v39
    v_fmac_f32 v175, v39, v39
    s_waitcnt vmcnt(5)
    s_barrier
    ds_read_b128 v[140:143], v6 offset:16384
    ds_read_b128 v[144:147], v6 offset:17408
    ds_read_b128 v[148:151], v6 offset:18432
    ds_read_b128 v[152:155], v6 offset:19456
    s_movk_i32 s31, 256
    s_add_u32 m0, s30, 0
    s_nop 0
    buffer_load_dwordx4 v13, s[12:15], s31 offen offset:0 lds
    buffer_load_dwordx4 v14, s[12:15], s31 offen offset:1024 lds
    s_waitcnt lgkmcnt(0)
    v_lshlrev_b32 v32, 16, v140
    v_and_b32 v33, 0xffff0000, v140
    v_add_f32 v160, v160, v32
    v_fmac_f32 v168, v32, v32
    v_add_f32 v161, v161, v33
    v_fmac_f32 v169, v33, v33
    buffer_load_dwordx4 v15, s[12:15], s31 offen offset:2048 lds
    v_lshlrev_b32 v34, 16, v144
    v_and_b32 v35, 0xffff0000, v144
    v_add_f32 v162, v162, v34
    v_fmac_f32 v170, v34, v34
    v_add_f32 v163, v163, v35
    v_fmac_f32 v171, v35, v35
    buffer_load_dwordx4 v16, s[12:15], s31 offen offset:3072 lds
    v_lshlrev_b32 v36, 16, v148
    v_and_b32 v37, 0xffff0000, v148
    v_add_f32 v164, v164, v36
    v_fmac_f32 v172, v36, v36
    v_add_f32 v165, v165, v37
    v_fmac_f32 v173, v37, v37
    s_mov_b32 s28, 442368
    s_add_u32 m0, s29, 81920
    s_nop 0
    buffer_load_dwordx4 v24, s[8:11], s28 offen offset:0 lds
    v_lshlrev_b32 v38, 16, v152
    v_and_b32 v39, 0xffff0000, v152
    v_add_f32 v166, v166, v38
    v_fmac_f32 v174, v38, v38
    v_add_f32 v167, v167, v39
    v_fmac_f32 v175, v39, v39
    buffer_load_dwordx4 v25, s[8:11], s28 offen offset:1024 lds
    v_lshlrev_b32 v32, 16, v141
    v_and_b32 v33, 0xffff0000, v141
    v_add_f32 v160, v160, v32
    v_fmac_f32 v168, v32, v32
    v_add_f32 v161, v161, v33
    v_fmac_f32 v169, v33, v33
    buffer_load_dwordx4 v26, s[8:11], s28 offen offset:2048 lds
    v_lshlrev_b32 v34, 16, v145
    v_and_b32 v35, 0xffff0000, v145
    v_add_f32 v162, v162, v34
    v_fmac_f32 v170, v34, v34
    v_add_f32 v163, v163, v35
    v_fmac_f32 v171, v35, v35
    buffer_load_dwordx4 v27, s[8:11], s28 offen offset:3072 lds
    v_lshlrev_b32 v36, 16, v149
    v_and_b32 v37, 0xffff0000, v149
    v_add_f32 v164, v164, v36
    v_fmac_f32 v172, v36, v36
    v_add_f32 v165, v165, v37
    v_fmac_f32 v173, v37, v37
    s_add_u32 m0, s29, 86016
    s_nop 0
    buffer_load_dwordx4 v28, s[8:11], s28 offen offset:0 lds
    v_lshlrev_b32 v38, 16, v153
    v_and_b32 v39, 0xffff0000, v153
    v_add_f32 v166, v166, v38
    v_fmac_f32 v174, v38, v38
    v_add_f32 v167, v167, v39
    v_fmac_f32 v175, v39, v39
    s_waitcnt vmcnt(9)
    s_barrier
    s_mov_b32 s28, 552960
    s_add_u32 m0, s29, 102400
    s_nop 0
    buffer_load_dwordx4 v24, s[8:11], s28 offen offset:0 lds
    buffer_load_dwordx4 v25, s[8:11], s28 offen offset:1024 lds
    v_lshlrev_b32 v32, 16, v142
    v_and_b32 v33, 0xffff0000, v142
    v_add_f32 v160, v160, v32
    v_fmac_f32 v168, v32, v32
    v_add_f32 v161, v161, v33
    v_fmac_f32 v169, v33, v33
    v_lshlrev_b32 v34, 16, v146
    v_and_b32 v35, 0xffff0000, v146
    buffer_load_dwordx4 v26, s[8:11], s28 offen offset:2048 lds
    v_add_f32 v162, v162, v34
    v_fmac_f32 v170, v34, v34
    v_add_f32 v163, v163, v35
    v_fmac_f32 v171, v35, v35
    v_lshlrev_b32 v36, 16, v150
    v_and_b32 v37, 0xffff0000, v150
    v_add_f32 v164, v164, v36
    v_fmac_f32 v172, v36, v36
    buffer_load_dwordx4 v27, s[8:11], s28 offen offset:3072 lds
    v_add_f32 v165, v165, v37
    v_fmac_f32 v173, v37, v37
    v_lshlrev_b32 v38, 16, v154
    v_and_b32 v39, 0xffff0000, v154
    v_add_f32 v166, v166, v38
    v_fmac_f32 v174, v38, v38
    v_add_f32 v167, v167, v39
    v_fmac_f32 v175, v39, v39
    s_add_u32 m0, s29, 106496
    s_nop 0
    buffer_load_dwordx4 v28, s[8:11], s28 offen offset:0 lds
    v_lshlrev_b32 v32, 16, v143
    v_and_b32 v33, 0xffff0000, v143
    v_add_f32 v160, v160, v32
    v_fmac_f32 v168, v32, v32
    v_add_f32 v161, v161, v33
    v_fmac_f32 v169, v33, v33
    v_lshlrev_b32 v34, 16, v147
    v_and_b32 v35, 0xffff0000, v147
    s_mov_b32 s28, 663552
    s_add_u32 m0, s29, 0
    s_nop 0
    buffer_load_dwordx4 v24, s[8:11], s28 offen offset:0 lds
    v_add_f32 v162, v162, v34
    v_fmac_f32 v170, v34, v34
    v_add_f32 v163, v163, v35
    v_fmac_f32 v171, v35, v35
    v_lshlrev_b32 v36, 16, v151
    v_and_b32 v37, 0xffff0000, v151
    v_add_f32 v164, v164, v36
    v_fmac_f32 v172, v36, v36
    buffer_load_dwordx4 v25, s[8:11], s28 offen offset:1024 lds
    v_add_f32 v165, v165, v37
    v_fmac_f32 v173, v37, v37
    v_lshlrev_b32 v38, 16, v155
    v_and_b32 v39, 0xffff0000, v155
    v_add_f32 v166, v166, v38
    v_fmac_f32 v174, v38, v38
    v_add_f32 v167, v167, v39
    v_fmac_f32 v175, v39, v39
    s_waitcnt vmcnt(7)
    s_barrier
    ds_read_b128 v[140:143], v6 offset:0
    ds_read_b128 v[144:147], v6 offset:1024
    ds_read_b128 v[148:151], v6 offset:2048
    ds_read_b128 v[152:155], v6 offset:3072
    s_movk_i32 s31, 384
    s_add_u32 m0, s30, 16384
    s_nop 0
    buffer_load_dwordx4 v13, s[12:15], s31 offen offset:0 lds
    buffer_load_dwordx4 v14, s[12:15], s31 offen offset:1024 lds
    s_waitcnt lgkmcnt(0)
    v_lshlrev_b32 v32, 16, v140
    v_and_b32 v33, 0xffff0000, v140
    v_add_f32 v160, v160, v32
    v_fmac_f32 v168, v32, v32
    v_add_f32 v161, v161, v33
    v_fmac_f32 v169, v33, v33
    v_lshlrev_b32 v34, 16, v144
    v_and_b32 v35, 0xffff0000, v144
    buffer_load_dwordx4 v15, s[12:15], s31 offen offset:2048 lds
    v_add_f32 v162, v162, v34
    v_fmac_f32 v170, v34, v34
    v_add_f32 v163, v163, v35
    v_fmac_f32 v171, v35, v35
    v_lshlrev_b32 v36, 16, v148
    v_and_b32 v37, 0xffff0000, v148
    v_add_f32 v164, v164, v36
    v_fmac_f32 v172, v36, v36
    buffer_load_dwordx4 v16, s[12:15], s31 offen offset:3072 lds
    v_add_f32 v165, v165, v37
    v_fmac_f32 v173, v37, v37
    v_lshlrev_b32 v38, 16, v152
    v_and_b32 v39, 0xffff0000, v152
    v_add_f32 v166, v166, v38
    v_fmac_f32 v174, v38, v38
    v_add_f32 v167, v167, v39
    v_fmac_f32 v175, v39, v39
    s_add_u32 m0, s29, 0
    s_nop 0
    buffer_load_dwordx4 v26, s[8:11], s28 offen offset:2048 lds
    v_lshlrev_b32 v32, 16, v141
    v_and_b32 v33, 0xffff0000, v141
    v_add_f32 v160, v160, v32
    v_fmac_f32 v168, v32, v32
    v_add_f32 v161, v161, v33
    v_fmac_f32 v169, v33, v33
    v_lshlrev_b32 v34, 16, v145
    v_and_b32 v35, 0xffff0000, v145
    buffer_load_dwordx4 v27, s[8:11], s28 offen offset:3072 lds
    v_add_f32 v162, v162, v34
    v_fmac_f32 v170, v34, v34
    v_add_f32 v163, v163, v35
    v_fmac_f32 v171, v35, v35
    v_lshlrev_b32 v36, 16, v149
    v_and_b32 v37, 0xffff0000, v149
    v_add_f32 v164, v164, v36
    v_fmac_f32 v172, v36, v36
    s_add_u32 m0, s29, 4096
    s_nop 0
    buffer_load_dwordx4 v28, s[8:11], s28 offen offset:0 lds
    v_add_f32 v165, v165, v37
    v_fmac_f32 v173, v37, v37
    v_lshlrev_b32 v38, 16, v153
    v_and_b32 v39, 0xffff0000, v153
    v_add_f32 v166, v166, v38
    v_fmac_f32 v174, v38, v38
    v_add_f32 v167, v167, v39
    v_fmac_f32 v175, v39, v39
    s_waitcnt vmcnt(9)
    s_barrier
    s_mov_b32 s28, 774144
    s_add_u32 m0, s29, 20480
    s_nop 0
    buffer_load_dwordx4 v24, s[8:11], s28 offen offset:0 lds
    buffer_load_dwordx4 v25, s[8:11], s28 offen offset:1024 lds
    v_lshlrev_b32 v32, 16, v142
    v_and_b32 v33, 0xffff0000, v142
    v_add_f32 v160, v160, v32
    v_fmac_f32 v168, v32, v32
    v_add_f32 v161, v161, v33
    v_fmac_f32 v169, v33, v33
    v_lshlrev_b32 v34, 16, v146
    v_and_b32 v35, 0xffff0000, v146
    buffer_load_dwordx4 v26, s[8:11], s28 offen offset:2048 lds
    v_add_f32 v162, v162, v34
    v_fmac_f32 v170, v34, v34
    v_add_f32 v163, v163, v35
    v_fmac_f32 v171, v35, v35
    v_lshlrev_b32 v36, 16, v150
    v_and_b32 v37, 0xffff0000, v150
    v_add_f32 v164, v164, v36
    v_fmac_f32 v172, v36, v36
    buffer_load_dwordx4 v27, s[8:11], s28 offen offset:3072 lds
    v_add_f32 v165, v165, v37
    v_fmac_f32 v173, v37, v37
    v_lshlrev_b32 v38, 16, v154
    v_and_b32 v39, 0xffff0000, v154
    v_add_f32 v166, v166, v38
    v_fmac_f32 v174, v38, v38
    v_add_f32 v167, v167, v39
    v_fmac_f32 v175, v39, v39
    s_add_u32 m0, s29, 24576
    s_nop 0
    buffer_load_dwordx4 v28, s[8:11], s28 offen offset:0 lds
    v_lshlrev_b32 v32, 16, v143
    v_and_b32 v33, 0xffff0000, v143
    v_add_f32 v160, v160, v32
    v_fmac_f32 v168, v32, v32
    v_add_f32 v161, v161, v33
    v_fmac_f32 v169, v33, v33
    v_lshlrev_b32 v34, 16, v147
    v_and_b32 v35, 0xffff0000, v147
    s_mov_b32 s28, 884736
    s_add_u32 m0, s29, 40960
    s_nop 0
    buffer_load_dwordx4 v24, s[8:11], s28 offen offset:0 lds
    v_add_f32 v162, v162, v34
    v_fmac_f32 v170, v34, v34
    v_add_f32 v163, v163, v35
    v_fmac_f32 v171, v35, v35
    v_lshlrev_b32 v36, 16, v151
    v_and_b32 v37, 0xffff0000, v151
    v_add_f32 v164, v164, v36
    v_fmac_f32 v172, v36, v36
    buffer_load_dwordx4 v25, s[8:11], s28 offen offset:1024 lds
    v_add_f32 v165, v165, v37
    v_fmac_f32 v173, v37, v37
    v_lshlrev_b32 v38, 16, v155
    v_and_b32 v39, 0xffff0000, v155
    v_add_f32 v166, v166, v38
    v_fmac_f32 v174, v38, v38
    v_add_f32 v167, v167, v39
    v_fmac_f32 v175, v39, v39
    s_waitcnt vmcnt(7)
    s_barrier
    ds_read_b128 v[140:143], v6 offset:16384
    ds_read_b128 v[144:147], v6 offset:17408
    ds_read_b128 v[148:151], v6 offset:18432
    ds_read_b128 v[152:155], v6 offset:19456
    s_movk_i32 s31, 512
    s_add_u32 m0, s30, 0
    s_nop 0
    buffer_load_dwordx4 v13, s[12:15], s31 offen offset:0 lds
    buffer_load_dwordx4 v14, s[12:15], s31 offen offset:1024 lds
    s_waitcnt lgkmcnt(0)
    v_lshlrev_b32 v32, 16, v140
    v_and_b32 v33, 0xffff0000, v140
    v_add_f32 v160, v160, v32
    v_fmac_f32 v168, v32, v32
    v_add_f32 v161, v161, v33
    v_fmac_f32 v169, v33, v33
    v_lshlrev_b32 v34, 16, v144
    v_and_b32 v35, 0xffff0000, v144
    buffer_load_dwordx4 v15, s[12:15], s31 offen offset:2048 lds
    v_add_f32 v162, v162, v34
    v_fmac_f32 v170, v34, v34
    v_add_f32 v163, v163, v35
    v_fmac_f32 v171, v35, v35
    v_lshlrev_b32 v36, 16, v148
    v_and_b32 v37, 0xffff0000, v148
    v_add_f32 v164, v164, v36
    v_fmac_f32 v172, v36, v36
    buffer_load_dwordx4 v16, s[12:15], s31 offen offset:3072 lds
    v_add_f32 v165, v165, v37
    v_fmac_f32 v173, v37, v37
    v_lshlrev_b32 v38, 16, v152
    v_and_b32 v39, 0xffff0000, v152
    v_add_f32 v166, v166, v38
    v_fmac_f32 v174, v38, v38
    v_add_f32 v167, v167, v39
    v_fmac_f32 v175, v39, v39
    s_add_u32 m0, s29, 40960
    s_nop 0
    buffer_load_dwordx4 v26, s[8:11], s28 offen offset:2048 lds
    v_lshlrev_b32 v32, 16, v141
    v_and_b32 v33, 0xffff0000, v141
    v_add_f32 v160, v160, v32
    v_fmac_f32 v168, v32, v32
    v_add_f32 v161, v161, v33
    v_fmac_f32 v169, v33, v33
    v_lshlrev_b32 v34, 16, v145
    v_and_b32 v35, 0xffff0000, v145
    buffer_load_dwordx4 v27, s[8:11], s28 offen offset:3072 lds
    v_add_f32 v162, v162, v34
    v_fmac_f32 v170, v34, v34
    v_add_f32 v163, v163, v35
    v_fmac_f32 v171, v35, v35
    v_lshlrev_b32 v36, 16, v149
    v_and_b32 v37, 0xffff0000, v149
    v_add_f32 v164, v164, v36
    v_fmac_f32 v172, v36, v36
    s_add_u32 m0, s29, 45056
    s_nop 0
    buffer_load_dwordx4 v28, s[8:11], s28 offen offset:0 lds
    v_add_f32 v165, v165, v37
    v_fmac_f32 v173, v37, v37
    v_lshlrev_b32 v38, 16, v153
    v_and_b32 v39, 0xffff0000, v153
    v_add_f32 v166, v166, v38
    v_fmac_f32 v174, v38, v38
    v_add_f32 v167, v167, v39
    v_fmac_f32 v175, v39, v39
    s_waitcnt vmcnt(9)
    s_barrier
    s_mov_b32 s28, 995328
    s_add_u32 m0, s29, 61440
    s_nop 0
    buffer_load_dwordx4 v24, s[8:11], s28 offen offset:0 lds
    buffer_load_dwordx4 v25, s[8:11], s28 offen offset:1024 lds
    v_lshlrev_b32 v32, 16, v142
    v_and_b32 v33, 0xffff0000, v142
    v_add_f32 v160, v160, v32
    v_fmac_f32 v168, v32, v32
    v_add_f32 v161, v161, v33
    v_fmac_f32 v169, v33, v33
    v_lshlrev_b32 v34, 16, v146
    v_and_b32 v35, 0xffff0000, v146
PGS_g_4:
    s_cbranch_execz PGR_g
    buffer_load_dwordx4 v26, s[8:11], s28 offen offset:2048 lds
    v_add_f32 v162, v162, v34
    v_fmac_f32 v170, v34, v34
    v_add_f32 v163, v163, v35
    v_fmac_f32 v171, v35, v35
    v_lshlrev_b32 v36, 16, v150
    v_and_b32 v37, 0xffff0000, v150
    v_add_f32 v164, v164, v36
    v_fmac_f32 v172, v36, v36
    buffer_load_dwordx4 v27, s[8:11], s28 offen offset:3072 lds
    v_add_f32 v165, v165, v37
    v_fmac_f32 v173, v37, v37
    v_lshlrev_b32 v38, 16, v154
    v_and_b32 v39, 0xffff0000, v154
    v_add_f32 v166, v166, v38
    v_fmac_f32 v174, v38, v38
    v_add_f32 v167, v167, v39
    v_fmac_f32 v175, v39, v39
    s_add_u32 m0, s29, 65536
    s_nop 0
    buffer_load_dwordx4 v28, s[8:11], s28 offen offset:0 lds
    v_lshlrev_b32 v32, 16, v143
    v_and_b32 v33, 0xffff0000, v143
    v_add_f32 v160, v160, v32
    v_fmac_f32 v168, v32, v32
    v_add_f32 v161, v161, v33
    v_fmac_f32 v169, v33, v33
    v_lshlrev_b32 v34, 16, v147
    v_and_b32 v35, 0xffff0000, v147
    s_mov_b32 s28, 1105920
    s_add_u32 m0, s29, 81920
    s_nop 0
    buffer_load_dwordx4 v24, s[8:11], s28 offen offset:0 lds
    v_add_f32 v162, v162, v34
    v_fmac_f32 v170, v34, v34
    v_add_f32 v163, v163, v35
    v_fmac_f32 v171, v35, v35
    v_lshlrev_b32 v36, 16, v151
    v_and_b32 v37, 0xffff0000, v151
    v_add_f32 v164, v164, v36
    v_fmac_f32 v172, v36, v36
    buffer_load_dwordx4 v25, s[8:11], s28 offen offset:1024 lds
    v_add_f32 v165, v165, v37
    v_fmac_f32 v173, v37, v37
    v_lshlrev_b32 v38, 16, v155
    v_and_b32 v39, 0xffff0000, v155
    v_add_f32 v166, v166, v38
    v_fmac_f32 v174, v38, v38
    v_add_f32 v167, v167, v39
    v_fmac_f32 v175, v39, v39
    s_waitcnt vmcnt(7)
    s_barrier
    ds_read_b128 v[140:143], v6 offset:0
    ds_read_b128 v[144:147], v6 offset:1024
    ds_read_b128 v[148:151], v6 offset:2048
    ds_read_b128 v[152:155], v6 offset:3072
    s_movk_i32 s31, 640
    s_add_u32 m0, s30, 16384
    s_nop 0
    buffer_load_dwordx4 v13, s[12:15], s31 offen offset:0 lds
    buffer_load_dwordx4 v14, s[12:15], s31 offen offset:1024 lds
    s_waitcnt lgkmcnt(0)
    v_lshlrev_b32 v32, 16, v140
    v_and_b32 v33, 0xffff0000, v140
    v_add_f32 v160, v160, v32
    v_fmac_f32 v168, v32, v32
    v_add_f32 v161, v161, v33
    v_fmac_f32 v169, v33, v33
    v_lshlrev_b32 v34, 16, v144
    v_and_b32 v35, 0xffff0000, v144
    buffer_load_dwordx4 v15, s[12:15], s31 offen offset:2048 lds
    v_add_f32 v162, v162, v34
    v_fmac_f32 v170, v34, v34
    v_add_f32 v163, v163, v35
    v_fmac_f32 v171, v35, v35
    v_lshlrev_b32 v36, 16, v148
    v_and_b32 v37, 0xffff0000, v148
    v_add_f32 v164, v164, v36
    v_fmac_f32 v172, v36, v36
    buffer_load_dwordx4 v16, s[12:15], s31 offen offset:3072 lds
    v_add_f32 v165, v165, v37
    v_fmac_f32 v173, v37, v37
    v_lshlrev_b32 v38, 16, v152
    v_and_b32 v39, 0xffff0000, v152
    v_add_f32 v166, v166, v38
    v_fmac_f32 v174, v38, v38
    v_add_f32 v167, v167, v39
    v_fmac_f32 v175, v39, v39
    s_add_u32 m0, s29, 81920
    s_nop 0
    buffer_load_dwordx4 v26, s[8:11], s28 offen offset:2048 lds
    v_lshlrev_b32 v32, 16, v141
    v_and_b32 v33, 0xffff0000, v141
    v_add_f32 v160, v160, v32
    v_fmac_f32 v168, v32, v32
    v_add_f32 v161, v161, v33
    v_fmac_f32 v169, v33, v33
    v_lshlrev_b32 v34, 16, v145
    v_and_b32 v35, 0xffff0000, v145
    buffer_load_dwordx4 v27, s[8:11], s28 offen offset:3072 lds
    v_add_f32 v162, v162, v34
    v_fmac_f32 v170, v34, v34
    v_add_f32 v163, v163, v35
    v_fmac_f32 v171, v35, v35
    v_lshlrev_b32 v36, 16, v149
    v_and_b32 v37, 0xffff0000, v149
    v_add_f32 v164, v164, v36
    v_fmac_f32 v172, v36, v36
    s_add_u32 m0, s29, 86016
    s_nop 0
    buffer_load_dwordx4 v28, s[8:11], s28 offen offset:0 lds
    v_add_f32 v165, v165, v37
    v_fmac_f32 v173, v37, v37
    v_lshlrev_b32 v38, 16, v153
    v_and_b32 v39, 0xffff0000, v153
    v_add_f32 v166, v166, v38
    v_fmac_f32 v174, v38, v38
    v_add_f32 v167, v167, v39
    v_fmac_f32 v175, v39, v39
    s_waitcnt vmcnt(9)
    s_barrier
    s_mov_b32 s28, 1216512
    s_add_u32 m0, s29, 102400
    s_nop 0
    buffer_load_dwordx4 v24, s[8:11], s28 offen offset:0 lds
    buffer_load_dwordx4 v25, s[8:11], s28 offen offset:1024 lds
    v_lshlrev_b32 v32, 16, v142
    v_and_b32 v33, 0xffff0000, v142
    v_add_f32 v160, v160, v32
    v_fmac_f32 v168, v32, v32
    v_add_f32 v161, v161, v33
    v_fmac_f32 v169, v33, v33
    v_lshlrev_b32 v34, 16, v146
    v_and_b32 v35, 0xffff0000, v146
    buffer_load_dwordx4 v26, s[8:11], s28 offen offset:2048 lds
    v_add_f32 v162, v162, v34
    v_fmac_f32 v170, v34, v34
    v_add_f32 v163, v163, v35
    v_fmac_f32 v171, v35, v35
    v_lshlrev_b32 v36, 16, v150
    v_and_b32 v37, 0xffff0000, v150
    v_add_f32 v164, v164, v36
    v_fmac_f32 v172, v36, v36
    buffer_load_dwordx4 v27, s[8:11], s28 offen offset:3072 lds
    v_add_f32 v165, v165, v37
    v_fmac_f32 v173, v37, v37
    v_lshlrev_b32 v38, 16, v154
    v_and_b32 v39, 0xffff0000, v154
    v_add_f32 v166, v166, v38
    v_fmac_f32 v174, v38, v38
    v_add_f32 v167, v167, v39
    v_fmac_f32 v175, v39, v39
    s_add_u32 m0, s29, 106496
    s_nop 0
    buffer_load_dwordx4 v28, s[8:11], s28 offen offset:0 lds
    v_lshlrev_b32 v32, 16, v143
    v_and_b32 v33, 0xffff0000, v143
    v_add_f32 v160, v160, v32
    v_fmac_f32 v168, v32, v32
    v_add_f32 v161, v161, v33
    v_fmac_f32 v169, v33, v33
    v_lshlrev_b32 v34, 16, v147
    v_and_b32 v35, 0xffff0000, v147
    s_mov_b32 s28, 1327104
    s_add_u32 m0, s29, 0
    s_nop 0
    buffer_load_dwordx4 v24, s[8:11], s28 offen offset:0 lds
    v_add_f32 v162, v162, v34
    v_fmac_f32 v170, v34, v34
    v_add_f32 v163, v163, v35
    v_fmac_f32 v171, v35, v35
    v_lshlrev_b32 v36, 16, v151
    v_and_b32 v37, 0xffff0000, v151
    v_add_f32 v164, v164, v36
    v_fmac_f32 v172, v36, v36
    buffer_load_dwordx4 v25, s[8:11], s28 offen offset:1024 lds
    v_add_f32 v165, v165, v37
    v_fmac_f32 v173, v37, v37
    v_lshlrev_b32 v38, 16, v155
    v_and_b32 v39, 0xffff0000, v155
    v_add_f32 v166, v166, v38
    v_fmac_f32 v174, v38, v38
    v_add_f32 v167, v167, v39
    v_fmac_f32 v175, v39, v39
    s_waitcnt vmcnt(7)
    s_barrier
    ds_read_b128 v[140:143], v6 offset:16384
    ds_read_b128 v[144:147], v6 offset:17408
    ds_read_b128 v[148:151], v6 offset:18432
    ds_read_b128 v[152:155], v6 offset:19456
    s_movk_i32 s31, 768
    s_add_u32 m0, s30, 0
    s_nop 0
    buffer_load_dwordx4 v13, s[12:15], s31 offen offset:0 lds
    buffer_load_dwordx4 v14, s[12:15], s31 offen offset:1024 lds
    s_waitcnt lgkmcnt(0)
    v_lshlrev_b32 v32, 16, v140
    v_and_b32 v33, 0xffff0000, v140
    v_add_f32 v160, v160, v32
    v_fmac_f32 v168, v32, v32
    v_add_f32 v161, v161, v33
    v_fmac_f32 v169, v33, v33
    v_lshlrev_b32 v34, 16, v144
    v_and_b32 v35, 0xffff0000, v144
    buffer_load_dwordx4 v15, s[12:15], s31 offen offset:2048 lds
    v_add_f32 v162, v162, v34
    v_fmac_f32 v170, v34, v34
    v_add_f32 v163, v163, v35
    v_fmac_f32 v171, v35, v35
    v_lshlrev_b32 v36, 16, v148
    v_and_b32 v37, 0xffff0000, v148
    v_add_f32 v164, v164, v36
    v_fmac_f32 v172, v36, v36
    buffer_load_dwordx4 v16, s[12:15], s31 offen offset:3072 lds
    v_add_f32 v165, v165, v37
    v_fmac_f32 v173, v37, v37
    v_lshlrev_b32 v38, 16, v152
    v_and_b32 v39, 0xffff0000, v152
    v_add_f32 v166, v166, v38
    v_fmac_f32 v174, v38, v38
    v_add_f32 v167, v167, v39
    v_fmac_f32 v175, v39, v39
    s_add_u32 m0, s29, 0
    s_nop 0
    buffer_load_dwordx4 v26, s[8:11], s28 offen offset:2048 lds
    v_lshlrev_b32 v32, 16, v141
    v_and_b32 v33, 0xffff0000, v141
    v_add_f32 v160, v160, v32
    v_fmac_f32 v168, v32, v32
    v_add_f32 v161, v161, v33
    v_fmac_f32 v169, v33, v33
    v_lshlrev_b32 v34, 16, v145
    v_and_b32 v35, 0xffff0000, v145
    buffer_load_dwordx4 v27, s[8:11], s28 offen offset:3072 lds
    v_add_f32 v162, v162, v34
    v_fmac_f32 v170, v34, v34
    v_add_f32 v163, v163, v35
    v_fmac_f32 v171, v35, v35
    v_lshlrev_b32 v36, 16, v149
    v_and_b32 v37, 0xffff0000, v149
    v_add_f32 v164, v164, v36
    v_fmac_f32 v172, v36, v36
    s_add_u32 m0, s29, 4096
    s_nop 0
    buffer_load_dwordx4 v28, s[8:11], s28 offen offset:0 lds
    v_add_f32 v165, v165, v37
    v_fmac_f32 v173, v37, v37
    v_lshlrev_b32 v38, 16, v153
    v_and_b32 v39, 0xffff0000, v153
    v_add_f32 v166, v166, v38
    v_fmac_f32 v174, v38, v38
    v_add_f32 v167, v167, v39
    v_fmac_f32 v175, v39, v39
    s_waitcnt vmcnt(9)
    s_barrier
    s_mov_b32 s28, 1437696
    s_add_u32 m0, s29, 20480
    s_nop 0
    buffer_load_dwordx4 v24, s[8:11], s28 offen offset:0 lds
    buffer_load_dwordx4 v25, s[8:11], s28 offen offset:1024 lds
    v_lshlrev_b32 v32, 16, v142
    v_and_b32 v33, 0xffff0000, v142
    v_add_f32 v160, v160, v32
    v_fmac_f32 v168, v32, v32
    v_add_f32 v161, v161, v33
    v_fmac_f32 v169, v33, v33
    v_lshlrev_b32 v34, 16, v146
    v_and_b32 v35, 0xffff0000, v146
    buffer_load_dwordx4 v26, s[8:11], s28 offen offset:2048 lds
    v_add_f32 v162, v162, v34
    v_fmac_f32 v170, v34, v34
    v_add_f32 v163, v163, v35
    v_fmac_f32 v171, v35, v35
    v_lshlrev_b32 v36, 16, v150
    v_and_b32 v37, 0xffff0000, v150
    v_add_f32 v164, v164, v36
    v_fmac_f32 v172, v36, v36
    buffer_load_dwordx4 v27, s[8:11], s28 offen offset:3072 lds
    v_add_f32 v165, v165, v37
    v_fmac_f32 v173, v37, v37
    v_lshlrev_b32 v38, 16, v154
    v_and_b32 v39, 0xffff0000, v154
    v_add_f32 v166, v166, v38
    v_fmac_f32 v174, v38, v38
    v_add_f32 v167, v167, v39
    v_fmac_f32 v175, v39, v39
    s_add_u32 m0, s29, 24576
    s_nop 0
    buffer_load_dwordx4 v28, s[8:11], s28 offen offset:0 lds
    v_lshlrev_b32 v32, 16, v143
    v_and_b32 v33, 0xffff0000, v143
    v_add_f32 v160, v160, v32
    v_fmac_f32 v168, v32, v32
    v_add_f32 v161, v161, v33
    v_fmac_f32 v169, v33, v33
    v_lshlrev_b32 v34, 16, v147
    v_and_b32 v35, 0xffff0000, v147
    s_mov_b32 s28, 1548288
    s_add_u32 m0, s29, 40960
    s_nop 0
    buffer_load_dwordx4 v24, s[8:11], s28 offen offset:0 lds
    v_add_f32 v162, v162, v34
    v_fmac_f32 v170, v34, v34
    v_add_f32 v163, v163, v35
    v_fmac_f32 v171, v35, v35
    v_lshlrev_b32 v36, 16, v151
    v_and_b32 v37, 0xffff0000, v151
    v_add_f32 v164, v164, v36
    v_fmac_f32 v172, v36, v36
    buffer_load_dwordx4 v25, s[8:11], s28 offen offset:1024 lds
    v_add_f32 v165, v165, v37
    v_fmac_f32 v173, v37, v37
    v_lshlrev_b32 v38, 16, v155
    v_and_b32 v39, 0xffff0000, v155
    v_add_f32 v166, v166, v38
    v_fmac_f32 v174, v38, v38
    v_add_f32 v167, v167, v39
    v_fmac_f32 v175, v39, v39
    s_waitcnt vmcnt(7)
    s_barrier
    ds_read_b128 v[140:143], v6 offset:0
    ds_read_b128 v[144:147], v6 offset:1024
    ds_read_b128 v[148:151], v6 offset:2048
    ds_read_b128 v[152:155], v6 offset:3072
    s_movk_i32 s31, 896
    s_add_u32 m0, s30, 16384
    s_nop 0
    buffer_load_dwordx4 v13, s[12:15], s31 offen offset:0 lds
    buffer_load_dwordx4 v14, s[12:15], s31 offen offset:1024 lds
    s_waitcnt lgkmcnt(0)
    v_lshlrev_b32 v32, 16, v140
    v_and_b32 v33, 0xffff0000, v140
    v_add_f32 v160, v160, v32
    v_fmac_f32 v168, v32, v32
    v_add_f32 v161, v161, v33
    v_fmac_f32 v169, v33, v33
    v_lshlrev_b32 v34, 16, v144
    v_and_b32 v35, 0xffff0000, v144
    buffer_load_dwordx4 v15, s[12:15], s31 offen offset:2048 lds
    v_add_f32 v162, v162, v34
    v_fmac_f32 v170, v34, v34
    v_add_f32 v163, v163, v35
    v_fmac_f32 v171, v35, v35
    v_lshlrev_b32 v36, 16, v148
    v_and_b32 v37, 0xffff0000, v148
    v_add_f32 v164, v164, v36
    v_fmac_f32 v172, v36, v36
    buffer_load_dwordx4 v16, s[12:15], s31 offen offset:3072 lds
    v_add_f32 v165, v165, v37
    v_fmac_f32 v173, v37, v37
    v_lshlrev_b32 v38, 16, v152
    v_and_b32 v39, 0xffff0000, v152
    v_add_f32 v166, v166, v38
    v_fmac_f32 v174, v38, v38
    v_add_f32 v167, v167, v39
    v_fmac_f32 v175, v39, v39
    s_add_u32 m0, s29, 40960
    s_nop 0
    buffer_load_dwordx4 v26, s[8:11], s28 offen offset:2048 lds
    v_lshlrev_b32 v32, 16, v141
    v_and_b32 v33, 0xffff0000, v141
    v_add_f32 v160, v160, v32
    v_fmac_f32 v168, v32, v32
    v_add_f32 v161, v161, v33
    v_fmac_f32 v169, v33, v33
    v_lshlrev_b32 v34, 16, v145
    v_and_b32 v35, 0xffff0000, v145
    buffer_load_dwordx4 v27, s[8:11], s28 offen offset:3072 lds
    v_add_f32 v162, v162, v34
    v_fmac_f32 v170, v34, v34
    v_add_f32 v163, v163, v35
    v_fmac_f32 v171, v35, v35
    v_lshlrev_b32 v36, 16, v149
    v_and_b32 v37, 0xffff0000, v149
    v_add_f32 v164, v164, v36
    v_fmac_f32 v172, v36, v36
    s_add_u32 m0, s29, 45056
    s_nop 0
    buffer_load_dwordx4 v28, s[8:11], s28 offen offset:0 lds
    v_add_f32 v165, v165, v37
    v_fmac_f32 v173, v37, v37
    v_lshlrev_b32 v38, 16, v153
    v_and_b32 v39, 0xffff0000, v153
    v_add_f32 v166, v166, v38
    v_fmac_f32 v174, v38, v38
    v_add_f32 v167, v167, v39
    v_fmac_f32 v175, v39, v39
    s_waitcnt vmcnt(9)
    s_barrier
    s_mov_b32 s28, 1658880
    s_add_u32 m0, s29, 61440
    s_nop 0
    buffer_load_dwordx4 v24, s[8:11], s28 offen offset:0 lds
    buffer_load_dwordx4 v25, s[8:11], s28 offen offset:1024 lds
    v_lshlrev_b32 v32, 16, v142
    v_and_b32 v33, 0xffff0000, v142
    v_add_f32 v160, v160, v32
    v_fmac_f32 v168, v32, v32
    v_add_f32 v161, v161, v33
    v_fmac_f32 v169, v33, v33
    v_lshlrev_b32 v34, 16, v146
    v_and_b32 v35, 0xffff0000, v146
    buffer_load_dwordx4 v26, s[8:11], s28 offen offset:2048 lds
    v_add_f32 v162, v162, v34
    v_fmac_f32 v170, v34, v34
    v_add_f32 v163, v163, v35
    v_fmac_f32 v171, v35, v35
    v_lshlrev_b32 v36, 16, v150
    v_and_b32 v37, 0xffff0000, v150
    v_add_f32 v164, v164, v36
    v_fmac_f32 v172, v36, v36
    buffer_load_dwordx4 v27, s[8:11], s28 offen offset:3072 lds
    v_add_f32 v165, v165, v37
    v_fmac_f32 v173, v37, v37
    v_lshlrev_b32 v38, 16, v154
    v_and_b32 v39, 0xffff0000, v154
    v_add_f32 v166, v166, v38
    v_fmac_f32 v174, v38, v38
    v_add_f32 v167, v167, v39
    v_fmac_f32 v175, v39, v39
    s_add_u32 m0, s29, 65536
    s_nop 0
    buffer_load_dwordx4 v28, s[8:11], s28 offen offset:0 lds
    v_lshlrev_b32 v32, 16, v143
    v_and_b32 v33, 0xffff0000, v143
    v_add_f32 v160, v160, v32
    v_fmac_f32 v168, v32, v32
    v_add_f32 v161, v161, v33
    v_fmac_f32 v169, v33, v33
    v_lshlrev_b32 v34, 16, v147
    v_and_b32 v35, 0xffff0000, v147
    s_mov_b32 s28, 1769472
    s_add_u32 m0, s29, 81920
    s_nop 0
    buffer_load_dwordx4 v24, s[8:11], s28 offen offset:0 lds
    v_add_f32 v162, v162, v34
    v_fmac_f32 v170, v34, v34
    v_add_f32 v163, v163, v35
    v_fmac_f32 v171, v35, v35
    v_lshlrev_b32 v36, 16, v151
    v_and_b32 v37, 0xffff0000, v151
    v_add_f32 v164, v164, v36
    v_fmac_f32 v172, v36, v36
    buffer_load_dwordx4 v25, s[8:11], s28 offen offset:1024 lds
    v_add_f32 v165, v165, v37
    v_fmac_f32 v173, v37, v37
    v_lshlrev_b32 v38, 16, v155
    v_and_b32 v39, 0xffff0000, v155
    v_add_f32 v166, v166, v38
    v_fmac_f32 v174, v38, v38
    v_add_f32 v167, v167, v39
    v_fmac_f32 v175, v39, v39
    s_waitcnt vmcnt(7)
    s_barrier
    ds_read_b128 v[140:143], v6 offset:16384
    ds_read_b128 v[144:147], v6 offset:17408
    ds_read_b128 v[148:151], v6 offset:18432
    ds_read_b128 v[152:155], v6 offset:19456
    s_movk_i32 s31, 1024
    s_add_u32 m0, s30, 0
    s_nop 0
    buffer_load_dwordx4 v13, s[12:15], s31 offen offset:0 lds
    buffer_load_dwordx4 v14, s[12:15], s31 offen offset:1024 lds
    s_waitcnt lgkmcnt(0)
    v_lshlrev_b32 v32, 16, v140
    v_and_b32 v33, 0xffff0000, v140
    v_add_f32 v160, v160, v32
    v_fmac_f32 v168, v32, v32
    v_add_f32 v161, v161, v33
    v_fmac_f32 v169, v33, v33
    v_lshlrev_b32 v34, 16, v144
    v_and_b32 v35, 0xffff0000, v144
    buffer_load_dwordx4 v15, s[12:15], s31 offen offset:2048 lds
    v_add_f32 v162, v162, v34
    v_fmac_f32 v170, v34, v34
    v_add_f32 v163, v163, v35
    v_fmac_f32 v171, v35, v35
    v_lshlrev_b32 v36, 16, v148
    v_and_b32 v37, 0xffff0000, v148
    v_add_f32 v164, v164, v36
    v_fmac_f32 v172, v36, v36
    buffer_load_dwordx4 v16, s[12:15], s31 offen offset:3072 lds
    v_add_f32 v165, v165, v37
    v_fmac_f32 v173, v37, v37
    v_lshlrev_b32 v38, 16, v152
    v_and_b32 v39, 0xffff0000, v152
    v_add_f32 v166, v166, v38
    v_fmac_f32 v174, v38, v38
    v_add_f32 v167, v167, v39
    v_fmac_f32 v175, v39, v39
    s_add_u32 m0, s29, 81920
    s_nop 0
    buffer_load_dwordx4 v26, s[8:11], s28 offen offset:2048 lds
    v_lshlrev_b32 v32, 16, v141
    v_and_b32 v33, 0xffff0000, v141
    v_add_f32 v160, v160, v32
    v_fmac_f32 v168, v32, v32
    v_add_f32 v161, v161, v33
    v_fmac_f32 v169, v33, v33
    v_lshlrev_b32 v34, 16, v145
    v_and_b32 v35, 0xffff0000, v145
    buffer_load_dwordx4 v27, s[8:11], s28 offen offset:3072 lds
    v_add_f32 v162, v162, v34
    v_fmac_f32 v170, v34, v34
    v_add_f32 v163, v163, v35
    v_fmac_f32 v171, v35, v35
    v_lshlrev_b32 v36, 16, v149
    v_and_b32 v37, 0xffff0000, v149
    v_add_f32 v164, v164, v36
    v_fmac_f32 v172, v36, v36
    s_add_u32 m0, s29, 86016
    s_nop 0
    buffer_load_dwordx4 v28, s[8:11], s28 offen offset:0 lds
    v_add_f32 v165, v165, v37
    v_fmac_f32 v173, v37, v37
    v_lshlrev_b32 v38, 16, v153
    v_and_b32 v39, 0xffff0000, v153
    v_add_f32 v166, v166, v38
    v_fmac_f32 v174, v38, v38
    v_add_f32 v167, v167, v39
    v_fmac_f32 v175, v39, v39
    s_waitcnt vmcnt(9)
    s_barrier
    s_mov_b32 s28, 1880064
    s_add_u32 m0, s29, 102400
    s_nop 0
    buffer_load_dwordx4 v24, s[8:11], s28 offen offset:0 lds
    buffer_load_dwordx4 v25, s[8:11], s28 offen offset:1024 lds
    v_lshlrev_b32 v32, 16, v142
    v_and_b32 v33, 0xffff0000, v142
    v_add_f32 v160, v160, v32
    v_fmac_f32 v168, v32, v32
    v_add_f32 v161, v161, v33
    v_fmac_f32 v169, v33, v33
    v_lshlrev_b32 v34, 16, v146
    v_and_b32 v35, 0xffff0000, v146
    buffer_load_dwordx4 v26, s[8:11], s28 offen offset:2048 lds
    v_add_f32 v162, v162, v34
    v_fmac_f32 v170, v34, v34
    v_add_f32 v163, v163, v35
    v_fmac_f32 v171, v35, v35
    v_lshlrev_b32 v36, 16, v150
    v_and_b32 v37, 0xffff0000, v150
    v_add_f32 v164, v164, v36
    v_fmac_f32 v172, v36, v36
    buffer_load_dwordx4 v27, s[8:11], s28 offen offset:3072 lds
    v_add_f32 v165, v165, v37
    v_fmac_f32 v173, v37, v37
    v_lshlrev_b32 v38, 16, v154
    v_and_b32 v39, 0xffff0000, v154
    v_add_f32 v166, v166, v38
    v_fmac_f32 v174, v38, v38
    v_add_f32 v167, v167, v39
    v_fmac_f32 v175, v39, v39
    s_add_u32 m0, s29, 106496
    s_nop 0
    buffer_load_dwordx4 v28, s[8:11], s28 offen offset:0 lds
    v_lshlrev_b32 v32, 16, v143
    v_and_b32 v33, 0xffff0000, v143
    v_add_f32 v160, v160, v32
    v_fmac_f32 v168, v32, v32
    v_add_f32 v161, v161, v33
    v_fmac_f32 v169, v33, v33
    v_lshlrev_b32 v34, 16, v147
    v_and_b32 v35, 0xffff0000, v147
    s_mov_b32 s28, 1990656
    s_add_u32 m0, s29, 0
    s_nop 0
    buffer_load_dwordx4 v24, s[8:11], s28 offen offset:0 lds
    v_add_f32 v162, v162, v34
    v_fmac_f32 v170, v34, v34
    v_add_f32 v163, v163, v35
    v_fmac_f32 v171, v35, v35
    v_lshlrev_b32 v36, 16, v151
    v_and_b32 v37, 0xffff0000, v151
    v_add_f32 v164, v164, v36
    v_fmac_f32 v172, v36, v36
    buffer_load_dwordx4 v25, s[8:11], s28 offen offset:1024 lds
    v_add_f32 v165, v165, v37
    v_fmac_f32 v173, v37, v37
    v_lshlrev_b32 v38, 16, v155
    v_and_b32 v39, 0xffff0000, v155
    v_add_f32 v166, v166, v38
    v_fmac_f32 v174, v38, v38
    v_add_f32 v167, v167, v39
    v_fmac_f32 v175, v39, v39
    s_waitcnt vmcnt(7)
    s_barrier
    ds_read_b128 v[140:143], v6 offset:0
    ds_read_b128 v[144:147], v6 offset:1024
    ds_read_b128 v[148:151], v6 offset:2048
    ds_read_b128 v[152:155], v6 offset:3072
    s_movk_i32 s31, 1152
    s_add_u32 m0, s30, 16384
    s_nop 0
    buffer_load_dwordx4 v13, s[12:15], s31 offen offset:0 lds
    buffer_load_dwordx4 v14, s[12:15], s31 offen offset:1024 lds
    s_waitcnt lgkmcnt(0)
    v_lshlrev_b32 v32, 16, v140
    v_and_b32 v33, 0xffff0000, v140
    v_add_f32 v160, v160, v32
    v_fmac_f32 v168, v32, v32
    v_add_f32 v161, v161, v33
    v_fmac_f32 v169, v33, v33
    v_lshlrev_b32 v34, 16, v144
    v_and_b32 v35, 0xffff0000, v144
    buffer_load_dwordx4 v15, s[12:15], s31 offen offset:2048 lds
    v_add_f32 v162, v162, v34
    v_fmac_f32 v170, v34, v34
    v_add_f32 v163, v163, v35
    v_fmac_f32 v171, v35, v35
    v_lshlrev_b32 v36, 16, v148
    v_and_b32 v37, 0xffff0000, v148
    v_add_f32 v164, v164, v36
    v_fmac_f32 v172, v36, v36
    buffer_load_dwordx4 v16, s[12:15], s31 offen offset:3072 lds
    v_add_f32 v165, v165, v37
    v_fmac_f32 v173, v37, v37
    v_lshlrev_b32 v38, 16, v152
    v_and_b32 v39, 0xffff0000, v152
    v_add_f32 v166, v166, v38
    v_fmac_f32 v174, v38, v38
    v_add_f32 v167, v167, v39
    v_fmac_f32 v175, v39, v39
    s_add_u32 m0, s29, 0
    s_nop 0
    buffer_load_dwordx4 v26, s[8:11], s28 offen offset:2048 lds
    v_lshlrev_b32 v32, 16, v141
    v_and_b32 v33, 0xffff0000, v141
    v_add_f32 v160, v160, v32
    v_fmac_f32 v168, v32, v32
    v_add_f32 v161, v161, v33
    v_fmac_f32 v169, v33, v33
    v_lshlrev_b32 v34, 16, v145
    v_and_b32 v35, 0xffff0000, v145
    buffer_load_dwordx4 v27, s[8:11], s28 offen offset:3072 lds
    v_add_f32 v162, v162, v34
    v_fmac_f32 v170, v34, v34
    v_add_f32 v163, v163, v35
    v_fmac_f32 v171, v35, v35
    v_lshlrev_b32 v36, 16, v149
    v_and_b32 v37, 0xffff0000, v149
    v_add_f32 v164, v164, v36
    v_fmac_f32 v172, v36, v36
    s_add_u32 m0, s29, 4096
    s_nop 0
    buffer_load_dwordx4 v28, s[8:11], s28 offen offset:0 lds
    v_add_f32 v165, v165, v37
    v_fmac_f32 v173, v37, v37
    v_lshlrev_b32 v38, 16, v153
    v_and_b32 v39, 0xffff0000, v153
    v_add_f32 v166, v166, v38
    v_fmac_f32 v174, v38, v38
    v_add_f32 v167, v167, v39
    v_fmac_f32 v175, v39, v39
    s_waitcnt vmcnt(9)
    s_barrier
    s_mov_b32 s28, 2101248
    s_add_u32 m0, s29, 20480
    s_nop 0
    buffer_load_dwordx4 v24, s[8:11], s28 offen offset:0 lds
    buffer_load_dwordx4 v25, s[8:11], s28 offen offset:1024 lds
    v_lshlrev_b32 v32, 16, v142
    v_and_b32 v33, 0xffff0000, v142
    v_add_f32 v160, v160, v32
    v_fmac_f32 v168, v32, v32
    v_add_f32 v161, v161, v33
    v_fmac_f32 v169, v33, v33
    v_lshlrev_b32 v34, 16, v146
    v_and_b32 v35, 0xffff0000, v146
    v_add_f32 v162, v162, v34
    v_fmac_f32 v170, v34, v34
    v_add_f32 v163, v163, v35
    v_fmac_f32 v171, v35, v35
    buffer_load_dwordx4 v26, s[8:11], s28 offen offset:2048 lds
    v_lshlrev_b32 v36, 16, v150
    v_and_b32 v37, 0xffff0000, v150
    v_add_f32 v164, v164, v36
    v_fmac_f32 v172, v36, v36
    v_add_f32 v165, v165, v37
    v_fmac_f32 v173, v37, v37
    v_lshlrev_b32 v38, 16, v154
    v_and_b32 v39, 0xffff0000, v154
    v_add_f32 v166, v166, v38
    v_fmac_f32 v174, v38, v38
    v_add_f32 v167, v167, v39
    v_fmac_f32 v175, v39, v39
    buffer_load_dwordx4 v27, s[8:11], s28 offen offset:3072 lds
    v_lshlrev_b32 v32, 16, v143
    v_and_b32 v33, 0xffff0000, v143
    v_add_f32 v160, v160, v32
    v_fmac_f32 v168, v32, v32
    v_add_f32 v161, v161, v33
    v_fmac_f32 v169, v33, v33
    v_lshlrev_b32 v34, 16, v147
    v_and_b32 v35, 0xffff0000, v147
    v_add_f32 v162, v162, v34
    v_fmac_f32 v170, v34, v34
    v_add_f32 v163, v163, v35
    v_fmac_f32 v171, v35, v35
    s_add_u32 m0, s29, 24576
    s_nop 0
    buffer_load_dwordx4 v28, s[8:11], s28 offen offset:0 lds
    v_lshlrev_b32 v36, 16, v151
    v_and_b32 v37, 0xffff0000, v151
    v_add_f32 v164, v164, v36
    v_fmac_f32 v172, v36, v36
    v_add_f32 v165, v165, v37
    v_fmac_f32 v173, v37, v37
    v_lshlrev_b32 v38, 16, v155
    v_and_b32 v39, 0xffff0000, v155
    v_add_f32 v166, v166, v38
    v_fmac_f32 v174, v38, v38
    v_add_f32 v167, v167, v39
    v_fmac_f32 v175, v39, v39
    s_add_u32 s32, s6, 0x500000
    s_addc_u32 s33, s7, 0
    s_mov_b32 s34, 0x21c000
    s_mov_b32 s35, 0x00020000
    v_lshlrev_b32 v2, 7, v1
    s_lshl_b32 s36, s40, 2
    s_add_u32 s36, s36, s26
    s_mul_i32 s37, s36, 0xCCCD
    s_lshr_b32 s37, s37, 18
    s_add_u32 s37, s37, s41
    s_mul_i32 s37, s37, 5
    s_add_u32 s37, s37, s36
    s_lshl_b32 s37, s37, 13
    buffer_load_dword v253, v2, s[32:35], s37 offen
    s_lshl_b32 s37, s43, 2
    s_add_u32 s36, s36, s37
    s_mul_i32 s37, s36, 0xCCCD
    s_lshr_b32 s37, s37, 18
    s_add_u32 s37, s37, s41
    s_mul_i32 s37, s37, 5
    s_add_u32 s37, s37, s36
    s_lshl_b32 s37, s37, 13
    buffer_load_dword v253, v2, s[32:35], s37 offen
    s_waitcnt vmcnt(7)
    s_barrier
    ds_read_b128 v[140:143], v6 offset:16384
    ds_read_b128 v[144:147], v6 offset:17408
    ds_read_b128 v[148:151], v6 offset:18432
    ds_read_b128 v[152:155], v6 offset:19456
    s_waitcnt lgkmcnt(0)
    v_lshlrev_b32 v32, 16, v140
    v_and_b32 v33, 0xffff0000, v140
    v_add_f32 v160, v160, v32
    v_fmac_f32 v168, v32, v32
    v_add_f32 v161, v161, v33
    v_fmac_f32 v169, v33, v33
    v_lshlrev_b32 v34, 16, v144
    v_and_b32 v35, 0xffff0000, v144
    v_add_f32 v162, v162, v34
    v_fmac_f32 v170, v34, v34
    v_add_f32 v163, v163, v35
    v_fmac_f32 v171, v35, v35
    v_lshlrev_b32 v36, 16, v148
    v_and_b32 v37, 0xffff0000, v148
    v_add_f32 v164, v164, v36
    v_fmac_f32 v172, v36, v36
    v_add_f32 v165, v165, v37
    v_fmac_f32 v173, v37, v37
    v_lshlrev_b32 v38, 16, v152
    v_and_b32 v39, 0xffff0000, v152
    v_add_f32 v166, v166, v38
    v_fmac_f32 v174, v38, v38
    v_add_f32 v167, v167, v39
    v_fmac_f32 v175, v39, v39
    v_lshlrev_b32 v32, 16, v141
    v_and_b32 v33, 0xffff0000, v141
    v_add_f32 v160, v160, v32
    v_fmac_f32 v168, v32, v32
    v_add_f32 v161, v161, v33
    v_fmac_f32 v169, v33, v33
    v_lshlrev_b32 v34, 16, v145
    v_and_b32 v35, 0xffff0000, v145
    v_add_f32 v162, v162, v34
    v_fmac_f32 v170, v34, v34
    v_add_f32 v163, v163, v35
    v_fmac_f32 v171, v35, v35
    v_lshlrev_b32 v36, 16, v149
    v_and_b32 v37, 0xffff0000, v149
    v_add_f32 v164, v164, v36
    v_fmac_f32 v172, v36, v36
    v_add_f32 v165, v165, v37
    v_fmac_f32 v173, v37, v37
    v_lshlrev_b32 v38, 16, v153
    v_and_b32 v39, 0xffff0000, v153
    v_add_f32 v166, v166, v38
    s_nop 0
    v_fmac_f32 v174, v38, v38
    v_add_f32 v167, v167, v39
    v_fmac_f32 v175, v39, v39
    s_waitcnt vmcnt(2)
    s_barrier
    v_lshlrev_b32 v32, 16, v142
    v_and_b32 v33, 0xffff0000, v142
    v_add_f32 v160, v160, v32
    v_fmac_f32 v168, v32, v32
    v_add_f32 v161, v161, v33
    v_fmac_f32 v169, v33, v33
    v_lshlrev_b32 v34, 16, v146
    v_and_b32 v35, 0xffff0000, v146
    v_add_f32 v162, v162, v34
    v_fmac_f32 v170, v34, v34
    v_add_f32 v163, v163, v35
    v_fmac_f32 v171, v35, v35
    v_lshlrev_b32 v36, 16, v150
    v_and_b32 v37, 0xffff0000, v150
    v_add_f32 v164, v164, v36
    v_fmac_f32 v172, v36, v36
    v_add_f32 v165, v165, v37
    v_fmac_f32 v173, v37, v37
    v_lshlrev_b32 v38, 16, v154
    v_and_b32 v39, 0xffff0000, v154
    v_add_f32 v166, v166, v38
    v_fmac_f32 v174, v38, v38
    v_add_f32 v167, v167, v39
    v_fmac_f32 v175, v39, v39
    v_lshlrev_b32 v32, 16, v143
    v_and_b32 v33, 0xffff0000, v143
    v_add_f32 v160, v160, v32
    v_fmac_f32 v168, v32, v32
    v_add_f32 v161, v161, v33
    v_fmac_f32 v169, v33, v33
    v_lshlrev_b32 v34, 16, v147
    v_and_b32 v35, 0xffff0000, v147
    v_add_f32 v162, v162, v34
    v_fmac_f32 v170, v34, v34
    v_add_f32 v163, v163, v35
    v_fmac_f32 v171, v35, v35
    v_lshlrev_b32 v36, 16, v151
    v_and_b32 v37, 0xffff0000, v151
    v_add_f32 v164, v164, v36
    v_fmac_f32 v172, v36, v36
    v_add_f32 v165, v165, v37
    v_fmac_f32 v173, v37, v37
    v_lshlrev_b32 v38, 16, v155
    v_and_b32 v39, 0xffff0000, v155
    v_add_f32 v166, v166, v38
    v_fmac_f32 v174, v38, v38
    v_add_f32 v167, v167, v39
    v_fmac_f32 v175, v39, v39
    v_add_f32 v40, v160, v161
    v_add_f32 v41, v162, v163
    v_add_f32 v42, v164, v165
    v_add_f32 v43, v166, v167
    v_add_f32 v44, v168, v169
    v_add_f32 v45, v170, v171
    v_add_f32 v46, v172, v173
    v_add_f32 v47, v174, v175
    s_nop 1
    v_add_f32_dpp v40, v40, v40 quad_perm:[1,0,3,2] row_mask:0xf bank_mask:0xf
    v_add_f32_dpp v41, v41, v41 quad_perm:[1,0,3,2] row_mask:0xf bank_mask:0xf
    v_add_f32_dpp v42, v42, v42 quad_perm:[1,0,3,2] row_mask:0xf bank_mask:0xf
    v_add_f32_dpp v43, v43, v43 quad_perm:[1,0,3,2] row_mask:0xf bank_mask:0xf
    v_add_f32_dpp v44, v44, v44 quad_perm:[1,0,3,2] row_mask:0xf bank_mask:0xf
    v_add_f32_dpp v45, v45, v45 quad_perm:[1,0,3,2] row_mask:0xf bank_mask:0xf
    v_add_f32_dpp v46, v46, v46 quad_perm:[1,0,3,2] row_mask:0xf bank_mask:0xf
    v_add_f32_dpp v47, v47, v47 quad_perm:[1,0,3,2] row_mask:0xf bank_mask:0xf
    v_add_f32_dpp v40, v40, v40 quad_perm:[2,3,0,1] row_mask:0xf bank_mask:0xf
    v_add_f32_dpp v41, v41, v41 quad_perm:[2,3,0,1] row_mask:0xf bank_mask:0xf
    v_add_f32_dpp v42, v42, v42 quad_perm:[2,3,0,1] row_mask:0xf bank_mask:0xf
    v_add_f32_dpp v43, v43, v43 quad_perm:[2,3,0,1] row_mask:0xf bank_mask:0xf
    v_add_f32_dpp v44, v44, v44 quad_perm:[2,3,0,1] row_mask:0xf bank_mask:0xf
    v_add_f32_dpp v45, v45, v45 quad_perm:[2,3,0,1] row_mask:0xf bank_mask:0xf
    v_add_f32_dpp v46, v46, v46 quad_perm:[2,3,0,1] row_mask:0xf bank_mask:0xf
    v_add_f32_dpp v47, v47, v47 quad_perm:[2,3,0,1] row_mask:0xf bank_mask:0xf
    v_add_f32_dpp v40, v40, v40 row_half_mirror row_mask:0xf bank_mask:0xf
    v_add_f32_dpp v41, v41, v41 row_half_mirror row_mask:0xf bank_mask:0xf
    v_add_f32_dpp v42, v42, v42 row_half_mirror row_mask:0xf bank_mask:0xf
    v_add_f32_dpp v43, v43, v43 row_half_mirror row_mask:0xf bank_mask:0xf
    v_add_f32_dpp v44, v44, v44 row_half_mirror row_mask:0xf bank_mask:0xf
    v_add_f32_dpp v45, v45, v45 row_half_mirror row_mask:0xf bank_mask:0xf
    v_add_f32_dpp v46, v46, v46 row_half_mirror row_mask:0xf bank_mask:0xf
    v_add_f32_dpp v47, v47, v47 row_half_mirror row_mask:0xf bank_mask:0xf
    v_mul_f32 v40, 0.0015625, v40
    v_mul_f32 v41, 0.0015625, v41
    v_mul_f32 v42, 0.0015625, v42
    v_mul_f32 v43, 0.0015625, v43
    v_mul_f32 v44, 0.0015625, v44
    v_mul_f32 v45, 0.0015625, v45
    v_mul_f32 v46, 0.0015625, v46
    v_mul_f32 v47, 0.0015625, v47
    v_fma_f32 v44, -v40, v40, v44
    v_fma_f32 v45, -v41, v41, v45
    v_fma_f32 v46, -v42, v42, v46
    v_fma_f32 v47, -v43, v43, v47
    v_cvt_pk_bf16_f32 v49, 0, -v40
    v_cvt_pk_bf16_f32 v44, 0, v44
    v_cvt_pk_bf16_f32 v51, 0, -v41
    v_cvt_pk_bf16_f32 v45, 0, v45
    v_cvt_pk_bf16_f32 v53, 0, -v42
    v_cvt_pk_bf16_f32 v46, 0, v46
    v_cvt_pk_bf16_f32 v55, 0, -v43
    v_cvt_pk_bf16_f32 v47, 0, v47
    v_add_f32 v44, 1e-05, v44
    v_add_f32 v45, 1e-05, v45
    v_add_f32 v46, 1e-05, v46
    v_add_f32 v47, 1e-05, v47
    v_cvt_pk_bf16_f32 v44, 0, v44
    v_cvt_pk_bf16_f32 v45, 0, v45
    v_cvt_pk_bf16_f32 v46, 0, v46
    v_cvt_pk_bf16_f32 v47, 0, v47
    v_sqrt_f32 v44, v44
    v_sqrt_f32 v45, v45
    v_sqrt_f32 v46, v46
    v_sqrt_f32 v47, v47
    s_nop 0
    v_cvt_pk_bf16_f32 v44, 0, v44
    v_cvt_pk_bf16_f32 v45, 0, v45
    v_cvt_pk_bf16_f32 v46, 0, v46
    v_cvt_pk_bf16_f32 v47, 0, v47
    v_rcp_f32 v48, v44
    v_rcp_f32 v50, v45
    v_rcp_f32 v52, v46
    v_rcp_f32 v54, v47
    s_nop 0
    ds_write_b64 v5, v[48:49] offset:0
    ds_write_b64 v5, v[50:51] offset:64
    ds_write_b64 v5, v[52:53] offset:128
    ds_write_b64 v5, v[54:55] offset:192
    s_waitcnt lgkmcnt(0)
    s_barrier
    buffer_store_dwordx2 v[48:49], v7, s[20:23], 0 offen offset:0 sc1
    buffer_store_dwordx2 v[50:51], v7, s[20:23], 0 offen offset:64 sc1
    buffer_store_dwordx2 v[52:53], v7, s[20:23], 0 offen offset:128 sc1
    buffer_store_dwordx2 v[54:55], v7, s[20:23], 0 offen offset:192 sc1
    s_lshr_b32 s50, s2, 3
    s_cmp_lg_u32 s3, 7
    s_cbranch_scc1 G1_nocw
    s_cmp_ge_u32 s50, 2
    s_cbranch_scc1 G1_nocw
    s_getpc_b64 s[52:53]
M_pc2:
    s_add_u32 s52, s52, fin_kernel-M_pc2
    s_addc_u32 s53, s53, 0
    s_lshl_b32 s50, s50, 6
    v_add_u32 v2, s50, v1
    v_lshlrev_b32 v2, 7, v2
    v_min_u32 v2, CODE_END-fin_kernel-4, v2
    global_load_dword v253, v2, s[52:53]
G1_nocw:
    s_endpgm
G1_cons:
    s_and_b32 s31, s3, 1
    s_lshr_b32 s33, s3, 1
    s_lshl_b32 s27, s24, 3
    s_lshl_b32 s26, s31, 2
    s_add_u32 s26, s26, s27
    s_mul_i32 s27, s26, 55296
    v_lshl_add_u32 v9, v1, 4, s27
    v_bfe_u32 v17, v0, 4, 2
    v_and_b32 v18, 15, v0
    v_and_b32 v19, 7, v0
    v_xor_b32 v19, v19, v17
    v_lshlrev_b32 v6, 7, v18
    v_lshl_add_u32 v6, v19, 4, v6
    s_lshl_b32 s30, s31, 13
    s_add_u32 s30, s30, 122880
    v_add_u32 v6, s30, v6
    v_xor_b32 v254, 64, v6
    s_lshl_b32 s30, s31, 9
    s_add_u32 s30, s30, 155648
    v_lshl_add_u32 v7, v18, 3, s30
    s_mul_i32 s30, s3, 320
    s_add_u32 s30, s30, 156672
    v_lshl_add_u32 v8, v17, 4, s30
    s_xor_b32 s30, s3, 1
    s_mul_i32 s30, s30, 320
    s_add_u32 s30, s30, 156672
    v_lshl_add_u32 v10, v17, 4, s30
    v_bfe_u32 v18, v0, 2, 2
    v_lshl_add_u32 v19, v17, 3, v18
    v_mul_u32_u24 v19, 320, v19
    v_and_b32 v18, 3, v0
    v_lshl_add_u32 v19, v18, 3, v19
    s_mul_i32 s27, s33, 192
    v_add_u32 v19, s27, v19
    v_and_b32 v18, 1, v17
    v_lshlrev_b32 v18, 5, v18
    s_mul_i32 s27, s31, 10240
    s_sub_u32 s28, 10240, s27
    v_add_u32 v2, v19, v18
    v_sub_u32 v3, v19, v18
    v_add_u32 v11, s27, v2
    v_add_u32 v12, s27, v3
    v_add_u32 v13, s27, v2
    v_add_u32 v13, 61440, v13
    v_add_u32 v14, s27, v3
    v_add_u32 v14, 61440, v14
    v_add_u32 v15, s28, v2
    v_add_u32 v16, s28, v3
    v_add_u32 v17, s28, v2
    v_add_u32 v17, 61440, v17
    v_add_u32 v18, s28, v3
    v_add_u32 v18, 61440, v18
    s_cmp_eq_u32 s33, 1
    s_cselect_b64 vcc, -1, 0
    v_subrev_u32 v21, 160, v3
    v_cndmask_b32 v20, v2, v21, vcc
    v_add_u32 v2, s27, v20
    v_add_u32 v3, 61440, v2
    v_add_u32 v21, s28, v20
    v_mov_b32 v68, 0x3f803f80
    v_mov_b32 v69, 0x3f803f80
    v_mov_b32 v70, 0x3f803f80
    v_mov_b32 v71, 0x3f803f80
    v_lshrrev_b32 v72, 4, v1
    v_xor_b32 v72, v72, v1
    v_and_b32 v72, 2, v72
    v_cmp_eq_u32 vcc, 0, v72
    v_and_b32 v0, 1, v0
    v_mul_u32_u24 v0, 0xaaaa, v0
    v_add_u32 v0, 0x4444, v0
    v_cndmask_b32 v68, 0, v68, vcc
    v_cndmask_b32 v69, 0, v69, vcc
    v_cndmask_b32 v70, 0, v70, vcc
    v_cndmask_b32 v71, 0, v71, vcc
    v_mov_b32 v72, 0
    v_mov_b32 v73, 0
    v_mov_b32 v74, 0
    v_mov_b32 v75, 0
    v_mov_b32 v76, 0
    v_mov_b32 v77, 0
    v_mov_b32 v78, 0
    v_mov_b32 v79, 0
    v_mov_b32 v80, 0
    v_mov_b32 v81, 0
    v_mov_b32 v82, 0
    v_mov_b32 v83, 0
    s_waitcnt lgkmcnt(0)
    s_add_u32 s20, s6, 0x800000
    s_addc_u32 s21, s7, 0
    s_mov_b32 s22, 0x6c0000
    s_mov_b32 s23, 0x00020000
    s_cmp_eq_u32 s3, 1
    s_cselect_b32 s8, s18, s16
    s_cselect_b32 s9, s19, s17
    s_cmp_eq_u32 s3, 2
    s_cselect_b32 s8, s44, s8
    s_cselect_b32 s9, s45, s9
    s_mov_b32 s10, 2211840
    s_cselect_b32 s10, 2621440, s10
    s_mov_b32 s11, 0x00020000
    s_cselect_b32 s12, 24, 20
    s_mov_b32 s13, 442368
    s_cselect_b32 s13, 256, s13
    s_cmp_eq_u32 s3, 3
    s_cselect_b32 s12, 0, s12
    s_mul_i32 s14, s47, s12
    v_add_u32 v4, s14, v1
    v_lshlrev_b32 v5, 7, v4
    v_lshrrev_b32 v19, 1, v4
    v_mul_u32_u24 v19, 0x500, v19
    v_and_b32 v4, 1, v4
    v_lshl_add_u32 v4, v4, 7, v19
    v_min_u32 v5, 442240, v5
    s_cmp_eq_u32 s3, 2
    s_cselect_b64 vcc, -1, 0
    v_cndmask_b32 v4, v5, v4, vcc
    v_cmp_gt_u32 s[14:15], s12, v1
    s_mov_b32 s16, 0
    s_mov_b32 s16, s13
    s_mov_b64 exec, s[14:15]
    buffer_load_dword v19, v4, s[8:11], s16 offen
    s_mov_b64 exec, -1
    s_add_u32 s16, s16, s13
    s_mov_b64 exec, 0
    s_branch PGS_g_0
PGR_g:
    s_mov_b64 exec, -1
    v_mul_u32_u24 v252, 0x500, v1
    s_sleep 8
    buffer_load_dword v255, v252, s[52:55], s56 offen
    buffer_load_dword v255, v252, s[52:55], s57 offen offset:128
    v_mov_b32 v5, v21
    v_add_u32 v252, 61440, v21
    s_barrier
    ds_read_b128 v[20:23], v6 offset:0
    ds_read_b128 v[24:27], v6 offset:2048
    ds_read_b128 v[28:31], v6 offset:4096
    ds_read_b128 v[32:35], v6 offset:6144
    ds_read_b64_tr_b16 v[52:53], v11 offset:0
    ds_read_b64_tr_b16 v[54:55], v11 offset:1280
    ds_read_b64_tr_b16 v[56:57], v12 offset:32
    ds_read_b64_tr_b16 v[58:59], v12 offset:1312
    s_barrier
    s_mov_b64 exec, s[14:15]
    buffer_load_dword v19, v4, s[8:11], s16 offen
    s_mov_b64 exec, -1
    s_add_u32 s16, s16, s13
    s_waitcnt lgkmcnt(2)
    v_mfma_f32_16x16x32_bf16 v[92:95], v[52:55], v[20:23], 0
    ds_read_b64_tr_b16 v[60:61], v11 offset:64
    v_mfma_f32_16x16x32_bf16 v[96:99], v[52:55], v[24:27], 0
    ds_read_b64_tr_b16 v[62:63], v11 offset:1344
    v_mfma_f32_16x16x32_bf16 v[100:103], v[52:55], v[28:31], 0
    v_mfma_f32_16x16x32_bf16 v[104:107], v[52:55], v[32:35], 0
    s_waitcnt lgkmcnt(2)
    v_mfma_f32_16x16x32_bf16 v[108:111], v[56:59], v[20:23], 0
    ds_read_b64_tr_b16 v[64:65], v12 offset:96
    v_mfma_f32_16x16x32_bf16 v[112:115], v[56:59], v[24:27], 0
    ds_read_b64_tr_b16 v[66:67], v12 offset:1376
    v_mfma_f32_16x16x32_bf16 v[116:119], v[56:59], v[28:31], 0
    ds_read_b128 v[36:39], v254 offset:0
    v_mfma_f32_16x16x32_bf16 v[120:123], v[56:59], v[32:35], 0
    v_smfmac_f32_16x16x64_bf16 v[72:75], v[68:71], v[52:59], v0
    s_waitcnt lgkmcnt(3)
    v_mfma_f32_16x16x32_bf16 v[124:127], v[60:63], v[20:23], 0
    ds_read_b64_tr_b16 v[84:85], v2 offset:128
    v_mfma_f32_16x16x32_bf16 v[128:131], v[60:63], v[24:27], 0
    ds_read_b64_tr_b16 v[86:87], v2 offset:1408
    v_mfma_f32_16x16x32_bf16 v[132:135], v[60:63], v[28:31], 0
    ds_read_b128 v[40:43], v254 offset:2048
    v_mfma_f32_16x16x32_bf16 v[136:139], v[60:63], v[32:35], 0
    s_waitcnt lgkmcnt(4)
    v_mfma_f32_16x16x32_bf16 v[140:143], v[64:67], v[20:23], 0
    ds_read_b64_tr_b16 v[56:57], v15 offset:0
    v_mfma_f32_16x16x32_bf16 v[144:147], v[64:67], v[24:27], 0
    ds_read_b64_tr_b16 v[58:59], v15 offset:1280
    v_mfma_f32_16x16x32_bf16 v[148:151], v[64:67], v[28:31], 0
    ds_read_b128 v[44:47], v254 offset:4096
    v_mfma_f32_16x16x32_bf16 v[152:155], v[64:67], v[32:35], 0
    v_smfmac_f32_16x16x64_bf16 v[76:79], v[68:71], v[60:67], v0
    s_waitcnt lgkmcnt(4)
    v_mfma_f32_16x16x32_bf16 v[156:159], v[84:87], v[20:23], 0
    ds_read_b64_tr_b16 v[60:61], v16 offset:32
    v_mfma_f32_16x16x32_bf16 v[160:163], v[84:87], v[24:27], 0
    ds_read_b64_tr_b16 v[62:63], v16 offset:1312
    v_mfma_f32_16x16x32_bf16 v[164:167], v[84:87], v[28:31], 0
    ds_read_b128 v[48:51], v254 offset:6144
    v_mfma_f32_16x16x32_bf16 v[168:171], v[84:87], v[32:35], 0
    s_waitcnt lgkmcnt(4)
    v_mfma_f32_16x16x32_bf16 v[172:175], v[56:59], v[20:23], 0
    ds_read_b64_tr_b16 v[64:65], v15 offset:64
    v_mfma_f32_16x16x32_bf16 v[176:179], v[56:59], v[24:27], 0
    ds_read_b64_tr_b16 v[66:67], v15 offset:1344
    v_mfma_f32_16x16x32_bf16 v[180:183], v[56:59], v[28:31], 0
    v_mfma_f32_16x16x32_bf16 v[184:187], v[56:59], v[32:35], 0
    s_waitcnt lgkmcnt(3)
    v_mfma_f32_16x16x32_bf16 v[188:191], v[60:63], v[20:23], 0
    ds_read_b64_tr_b16 v[52:53], v16 offset:96
    v_mfma_f32_16x16x32_bf16 v[192:195], v[60:63], v[24:27], 0
    ds_read_b64_tr_b16 v[54:55], v16 offset:1376
    v_mfma_f32_16x16x32_bf16 v[196:199], v[60:63], v[28:31], 0
    v_mfma_f32_16x16x32_bf16 v[200:203], v[60:63], v[32:35], 0
    s_waitcnt lgkmcnt(2)
    v_mfma_f32_16x16x32_bf16 v[204:207], v[64:67], v[20:23], 0
    ds_read_b64_tr_b16 v[56:57], v5 offset:128
    v_mfma_f32_16x16x32_bf16 v[208:211], v[64:67], v[24:27], 0
    ds_read_b64_tr_b16 v[58:59], v5 offset:1408
    v_mfma_f32_16x16x32_bf16 v[212:215], v[64:67], v[28:31], 0
    v_mfma_f32_16x16x32_bf16 v[216:219], v[64:67], v[32:35], 0
    s_waitcnt lgkmcnt(2)
    v_mfma_f32_16x16x32_bf16 v[220:223], v[52:55], v[20:23], 0
    ds_read_b64_tr_b16 v[60:61], v11 offset:20480
    v_mfma_f32_16x16x32_bf16 v[224:227], v[52:55], v[24:27], 0
    ds_read_b64_tr_b16 v[62:63], v11 offset:21760
    v_mfma_f32_16x16x32_bf16 v[228:231], v[52:55], v[28:31], 0
    v_mfma_f32_16x16x32_bf16 v[232:235], v[52:55], v[32:35], 0
    s_waitcnt lgkmcnt(2)
    v_mfma_f32_16x16x32_bf16 v[236:239], v[56:59], v[20:23], 0
    ds_read_b64_tr_b16 v[64:65], v12 offset:20512
    v_mfma_f32_16x16x32_bf16 v[240:243], v[56:59], v[24:27], 0
    ds_read_b64_tr_b16 v[66:67], v12 offset:21792
    v_mfma_f32_16x16x32_bf16 v[244:247], v[56:59], v[28:31], 0
    v_mfma_f32_16x16x32_bf16 v[248:251], v[56:59], v[32:35], 0
    s_barrier
    s_waitcnt lgkmcnt(2)
    v_mfma_f32_16x16x32_bf16 v[92:95], v[60:63], v[36:39], v[92:95]
    ds_read_b64_tr_b16 v[52:53], v11 offset:20544
    v_mfma_f32_16x16x32_bf16 v[96:99], v[60:63], v[40:43], v[96:99]
    ds_read_b64_tr_b16 v[54:55], v11 offset:21824
    v_mfma_f32_16x16x32_bf16 v[100:103], v[60:63], v[44:47], v[100:103]
    v_mfma_f32_16x16x32_bf16 v[104:107], v[60:63], v[48:51], v[104:107]
    s_waitcnt lgkmcnt(2)
    v_mfma_f32_16x16x32_bf16 v[108:111], v[64:67], v[36:39], v[108:111]
    ds_read_b64_tr_b16 v[56:57], v12 offset:20576
    v_mfma_f32_16x16x32_bf16 v[112:115], v[64:67], v[40:43], v[112:115]
    ds_read_b64_tr_b16 v[58:59], v12 offset:21856
    v_mfma_f32_16x16x32_bf16 v[116:119], v[64:67], v[44:47], v[116:119]
    ds_read_b128 v[20:23], v6 offset:16384
    v_mfma_f32_16x16x32_bf16 v[120:123], v[64:67], v[48:51], v[120:123]
    v_smfmac_f32_16x16x64_bf16 v[72:75], v[68:71], v[60:67], v0
    s_waitcnt lgkmcnt(3)
    v_mfma_f32_16x16x32_bf16 v[124:127], v[52:55], v[36:39], v[124:127]
    ds_read_b64_tr_b16 v[88:89], v2 offset:20608
    v_mfma_f32_16x16x32_bf16 v[128:131], v[52:55], v[40:43], v[128:131]
    ds_read_b64_tr_b16 v[90:91], v2 offset:21888
    v_mfma_f32_16x16x32_bf16 v[132:135], v[52:55], v[44:47], v[132:135]
    ds_read_b128 v[24:27], v6 offset:18432
    v_mfma_f32_16x16x32_bf16 v[136:139], v[52:55], v[48:51], v[136:139]
    s_waitcnt lgkmcnt(4)
    v_mfma_f32_16x16x32_bf16 v[140:143], v[56:59], v[36:39], v[140:143]
    ds_read_b64_tr_b16 v[64:65], v15 offset:20480
    v_mfma_f32_16x16x32_bf16 v[144:147], v[56:59], v[40:43], v[144:147]
    ds_read_b64_tr_b16 v[66:67], v15 offset:21760
    v_mfma_f32_16x16x32_bf16 v[148:151], v[56:59], v[44:47], v[148:151]
    ds_read_b128 v[28:31], v6 offset:20480
    v_mfma_f32_16x16x32_bf16 v[152:155], v[56:59], v[48:51], v[152:155]
    v_smfmac_f32_16x16x64_bf16 v[76:79], v[68:71], v[52:59], v0
    s_waitcnt lgkmcnt(4)
    v_mfma_f32_16x16x32_bf16 v[156:159], v[88:91], v[36:39], v[156:159]
    ds_read_b64_tr_b16 v[52:53], v16 offset:20512
    v_mfma_f32_16x16x32_bf16 v[160:163], v[88:91], v[40:43], v[160:163]
    ds_read_b64_tr_b16 v[54:55], v16 offset:21792
    v_mfma_f32_16x16x32_bf16 v[164:167], v[88:91], v[44:47], v[164:167]
    ds_read_b128 v[32:35], v6 offset:22528
    v_mfma_f32_16x16x32_bf16 v[168:171], v[88:91], v[48:51], v[168:171]
    v_smfmac_f32_16x16x64_bf16 v[80:83], v[68:71], v[84:91], v0
    s_waitcnt lgkmcnt(4)
    v_mfma_f32_16x16x32_bf16 v[172:175], v[64:67], v[36:39], v[172:175]
    ds_read_b64_tr_b16 v[56:57], v15 offset:20544
    v_mfma_f32_16x16x32_bf16 v[176:179], v[64:67], v[40:43], v[176:179]
    ds_read_b64_tr_b16 v[58:59], v15 offset:21824
    v_mfma_f32_16x16x32_bf16 v[180:183], v[64:67], v[44:47], v[180:183]
    v_mfma_f32_16x16x32_bf16 v[184:187], v[64:67], v[48:51], v[184:187]
    s_waitcnt lgkmcnt(3)
    v_mfma_f32_16x16x32_bf16 v[188:191], v[52:55], v[36:39], v[188:191]
    ds_read_b64_tr_b16 v[60:61], v16 offset:20576
    v_mfma_f32_16x16x32_bf16 v[192:195], v[52:55], v[40:43], v[192:195]
    ds_read_b64_tr_b16 v[62:63], v16 offset:21856
    v_mfma_f32_16x16x32_bf16 v[196:199], v[52:55], v[44:47], v[196:199]
    v_mfma_f32_16x16x32_bf16 v[200:203], v[52:55], v[48:51], v[200:203]
    s_waitcnt lgkmcnt(2)
    v_mfma_f32_16x16x32_bf16 v[204:207], v[56:59], v[36:39], v[204:207]
    ds_read_b64_tr_b16 v[64:65], v5 offset:20608
    v_mfma_f32_16x16x32_bf16 v[208:211], v[56:59], v[40:43], v[208:211]
    ds_read_b64_tr_b16 v[66:67], v5 offset:21888
    v_mfma_f32_16x16x32_bf16 v[212:215], v[56:59], v[44:47], v[212:215]
    v_mfma_f32_16x16x32_bf16 v[216:219], v[56:59], v[48:51], v[216:219]
    s_waitcnt lgkmcnt(2)
    v_mfma_f32_16x16x32_bf16 v[220:223], v[60:63], v[36:39], v[220:223]
    ds_read_b64_tr_b16 v[52:53], v11 offset:40960
    v_mfma_f32_16x16x32_bf16 v[224:227], v[60:63], v[40:43], v[224:227]
    ds_read_b64_tr_b16 v[54:55], v11 offset:42240
    v_mfma_f32_16x16x32_bf16 v[228:231], v[60:63], v[44:47], v[228:231]
    v_mfma_f32_16x16x32_bf16 v[232:235], v[60:63], v[48:51], v[232:235]
    s_waitcnt lgkmcnt(2)
    v_mfma_f32_16x16x32_bf16 v[236:239], v[64:67], v[36:39], v[236:239]
    ds_read_b64_tr_b16 v[56:57], v12 offset:40992
    v_mfma_f32_16x16x32_bf16 v[240:243], v[64:67], v[40:43], v[240:243]
    ds_read_b64_tr_b16 v[58:59], v12 offset:42272
    v_mfma_f32_16x16x32_bf16 v[244:247], v[64:67], v[44:47], v[244:247]
    v_mfma_f32_16x16x32_bf16 v[248:251], v[64:67], v[48:51], v[248:251]
    s_barrier
    s_waitcnt lgkmcnt(2)
    v_mfma_f32_16x16x32_bf16 v[92:95], v[52:55], v[20:23], v[92:95]
    ds_read_b64_tr_b16 v[60:61], v11 offset:41024
    v_mfma_f32_16x16x32_bf16 v[96:99], v[52:55], v[24:27], v[96:99]
    ds_read_b64_tr_b16 v[62:63], v11 offset:42304
    v_mfma_f32_16x16x32_bf16 v[100:103], v[52:55], v[28:31], v[100:103]
    v_mfma_f32_16x16x32_bf16 v[104:107], v[52:55], v[32:35], v[104:107]
    s_waitcnt lgkmcnt(2)
    v_mfma_f32_16x16x32_bf16 v[108:111], v[56:59], v[20:23], v[108:111]
    ds_read_b64_tr_b16 v[64:65], v12 offset:41056
    v_mfma_f32_16x16x32_bf16 v[112:115], v[56:59], v[24:27], v[112:115]
    ds_read_b64_tr_b16 v[66:67], v12 offset:42336
    v_mfma_f32_16x16x32_bf16 v[116:119], v[56:59], v[28:31], v[116:119]
    ds_read_b128 v[36:39], v254 offset:16384
    v_mfma_f32_16x16x32_bf16 v[120:123], v[56:59], v[32:35], v[120:123]
    v_smfmac_f32_16x16x64_bf16 v[72:75], v[68:71], v[52:59], v0
    s_waitcnt lgkmcnt(3)
    v_mfma_f32_16x16x32_bf16 v[124:127], v[60:63], v[20:23], v[124:127]
    ds_read_b64_tr_b16 v[84:85], v2 offset:41088
    v_mfma_f32_16x16x32_bf16 v[128:131], v[60:63], v[24:27], v[128:131]
    ds_read_b64_tr_b16 v[86:87], v2 offset:42368
    v_mfma_f32_16x16x32_bf16 v[132:135], v[60:63], v[28:31], v[132:135]
    ds_read_b128 v[40:43], v254 offset:18432
    v_mfma_f32_16x16x32_bf16 v[136:139], v[60:63], v[32:35], v[136:139]
    s_waitcnt lgkmcnt(4)
    v_mfma_f32_16x16x32_bf16 v[140:143], v[64:67], v[20:23], v[140:143]
    ds_read_b64_tr_b16 v[56:57], v15 offset:40960
    v_mfma_f32_16x16x32_bf16 v[144:147], v[64:67], v[24:27], v[144:147]
    ds_read_b64_tr_b16 v[58:59], v15 offset:42240
    v_mfma_f32_16x16x32_bf16 v[148:151], v[64:67], v[28:31], v[148:151]
    ds_read_b128 v[44:47], v254 offset:20480
    v_mfma_f32_16x16x32_bf16 v[152:155], v[64:67], v[32:35], v[152:155]
    v_smfmac_f32_16x16x64_bf16 v[76:79], v[68:71], v[60:67], v0
    s_waitcnt lgkmcnt(4)
    v_mfma_f32_16x16x32_bf16 v[156:159], v[84:87], v[20:23], v[156:159]
    ds_read_b64_tr_b16 v[60:61], v16 offset:40992
    v_mfma_f32_16x16x32_bf16 v[160:163], v[84:87], v[24:27], v[160:163]
    ds_read_b64_tr_b16 v[62:63], v16 offset:42272
    v_mfma_f32_16x16x32_bf16 v[164:167], v[84:87], v[28:31], v[164:167]
    ds_read_b128 v[48:51], v254 offset:22528
    v_mfma_f32_16x16x32_bf16 v[168:171], v[84:87], v[32:35], v[168:171]
    s_waitcnt lgkmcnt(4)
    v_mfma_f32_16x16x32_bf16 v[172:175], v[56:59], v[20:23], v[172:175]
    ds_read_b64_tr_b16 v[64:65], v15 offset:41024
    v_mfma_f32_16x16x32_bf16 v[176:179], v[56:59], v[24:27], v[176:179]
    ds_read_b64_tr_b16 v[66:67], v15 offset:42304
    v_mfma_f32_16x16x32_bf16 v[180:183], v[56:59], v[28:31], v[180:183]
    v_mfma_f32_16x16x32_bf16 v[184:187], v[56:59], v[32:35], v[184:187]
    s_waitcnt lgkmcnt(3)
    v_mfma_f32_16x16x32_bf16 v[188:191], v[60:63], v[20:23], v[188:191]
    ds_read_b64_tr_b16 v[52:53], v16 offset:41056
    v_mfma_f32_16x16x32_bf16 v[192:195], v[60:63], v[24:27], v[192:195]
    ds_read_b64_tr_b16 v[54:55], v16 offset:42336
    v_mfma_f32_16x16x32_bf16 v[196:199], v[60:63], v[28:31], v[196:199]
    v_mfma_f32_16x16x32_bf16 v[200:203], v[60:63], v[32:35], v[200:203]
    s_waitcnt lgkmcnt(2)
    v_mfma_f32_16x16x32_bf16 v[204:207], v[64:67], v[20:23], v[204:207]
    ds_read_b64_tr_b16 v[56:57], v5 offset:41088
    v_mfma_f32_16x16x32_bf16 v[208:211], v[64:67], v[24:27], v[208:211]
    ds_read_b64_tr_b16 v[58:59], v5 offset:42368
    v_mfma_f32_16x16x32_bf16 v[212:215], v[64:67], v[28:31], v[212:215]
    v_mfma_f32_16x16x32_bf16 v[216:219], v[64:67], v[32:35], v[216:219]
    s_waitcnt lgkmcnt(2)
    v_mfma_f32_16x16x32_bf16 v[220:223], v[52:55], v[20:23], v[220:223]
    ds_read_b64_tr_b16 v[60:61], v13 offset:0
    v_mfma_f32_16x16x32_bf16 v[224:227], v[52:55], v[24:27], v[224:227]
    ds_read_b64_tr_b16 v[62:63], v13 offset:1280
    v_mfma_f32_16x16x32_bf16 v[228:231], v[52:55], v[28:31], v[228:231]
    v_mfma_f32_16x16x32_bf16 v[232:235], v[52:55], v[32:35], v[232:235]
    s_waitcnt lgkmcnt(2)
    v_mfma_f32_16x16x32_bf16 v[236:239], v[56:59], v[20:23], v[236:239]
    ds_read_b64_tr_b16 v[64:65], v14 offset:32
    v_mfma_f32_16x16x32_bf16 v[240:243], v[56:59], v[24:27], v[240:243]
    ds_read_b64_tr_b16 v[66:67], v14 offset:1312
    v_mfma_f32_16x16x32_bf16 v[244:247], v[56:59], v[28:31], v[244:247]
    v_mfma_f32_16x16x32_bf16 v[248:251], v[56:59], v[32:35], v[248:251]
    s_barrier
    s_waitcnt lgkmcnt(2)
    v_mfma_f32_16x16x32_bf16 v[92:95], v[60:63], v[36:39], v[92:95]
    ds_read_b64_tr_b16 v[52:53], v13 offset:64
    v_mfma_f32_16x16x32_bf16 v[96:99], v[60:63], v[40:43], v[96:99]
    ds_read_b64_tr_b16 v[54:55], v13 offset:1344
    v_mfma_f32_16x16x32_bf16 v[100:103], v[60:63], v[44:47], v[100:103]
    v_mfma_f32_16x16x32_bf16 v[104:107], v[60:63], v[48:51], v[104:107]
    s_waitcnt lgkmcnt(2)
    v_mfma_f32_16x16x32_bf16 v[108:111], v[64:67], v[36:39], v[108:111]
    ds_read_b64_tr_b16 v[56:57], v14 offset:96
    v_mfma_f32_16x16x32_bf16 v[112:115], v[64:67], v[40:43], v[112:115]
    ds_read_b64_tr_b16 v[58:59], v14 offset:1376
    v_mfma_f32_16x16x32_bf16 v[116:119], v[64:67], v[44:47], v[116:119]
    ds_read_b128 v[20:23], v6 offset:0
    v_mfma_f32_16x16x32_bf16 v[120:123], v[64:67], v[48:51], v[120:123]
    v_smfmac_f32_16x16x64_bf16 v[72:75], v[68:71], v[60:67], v0
    s_waitcnt lgkmcnt(3)
    v_mfma_f32_16x16x32_bf16 v[124:127], v[52:55], v[36:39], v[124:127]
    ds_read_b64_tr_b16 v[88:89], v3 offset:128
    v_mfma_f32_16x16x32_bf16 v[128:131], v[52:55], v[40:43], v[128:131]
    ds_read_b64_tr_b16 v[90:91], v3 offset:1408
    v_mfma_f32_16x16x32_bf16 v[132:135], v[52:55], v[44:47], v[132:135]
    ds_read_b128 v[24:27], v6 offset:2048
    v_mfma_f32_16x16x32_bf16 v[136:139], v[52:55], v[48:51], v[136:139]
    s_waitcnt lgkmcnt(4)
    v_mfma_f32_16x16x32_bf16 v[140:143], v[56:59], v[36:39], v[140:143]
    ds_read_b64_tr_b16 v[64:65], v17 offset:0
    v_mfma_f32_16x16x32_bf16 v[144:147], v[56:59], v[40:43], v[144:147]
    ds_read_b64_tr_b16 v[66:67], v17 offset:1280
    v_mfma_f32_16x16x32_bf16 v[148:151], v[56:59], v[44:47], v[148:151]
    ds_read_b128 v[28:31], v6 offset:4096
    v_mfma_f32_16x16x32_bf16 v[152:155], v[56:59], v[48:51], v[152:155]
    v_smfmac_f32_16x16x64_bf16 v[76:79], v[68:71], v[52:59], v0
    s_waitcnt lgkmcnt(4)
    v_mfma_f32_16x16x32_bf16 v[156:159], v[88:91], v[36:39], v[156:159]
    ds_read_b64_tr_b16 v[52:53], v18 offset:32
    v_mfma_f32_16x16x32_bf16 v[160:163], v[88:91], v[40:43], v[160:163]
    ds_read_b64_tr_b16 v[54:55], v18 offset:1312
    v_mfma_f32_16x16x32_bf16 v[164:167], v[88:91], v[44:47], v[164:167]
    ds_read_b128 v[32:35], v6 offset:6144
    v_mfma_f32_16x16x32_bf16 v[168:171], v[88:91], v[48:51], v[168:171]
    v_smfmac_f32_16x16x64_bf16 v[80:83], v[68:71], v[84:91], v0
    s_waitcnt lgkmcnt(4)
    v_mfma_f32_16x16x32_bf16 v[172:175], v[64:67], v[36:39], v[172:175]
    ds_read_b64_tr_b16 v[56:57], v17 offset:64
    v_mfma_f32_16x16x32_bf16 v[176:179], v[64:67], v[40:43], v[176:179]
    ds_read_b64_tr_b16 v[58:59], v17 offset:1344
    v_mfma_f32_16x16x32_bf16 v[180:183], v[64:67], v[44:47], v[180:183]
    v_mfma_f32_16x16x32_bf16 v[184:187], v[64:67], v[48:51], v[184:187]
    s_waitcnt lgkmcnt(3)
    v_mfma_f32_16x16x32_bf16 v[188:191], v[52:55], v[36:39], v[188:191]
    ds_read_b64_tr_b16 v[60:61], v18 offset:96
    v_mfma_f32_16x16x32_bf16 v[192:195], v[52:55], v[40:43], v[192:195]
    ds_read_b64_tr_b16 v[62:63], v18 offset:1376
    v_mfma_f32_16x16x32_bf16 v[196:199], v[52:55], v[44:47], v[196:199]
    v_mfma_f32_16x16x32_bf16 v[200:203], v[52:55], v[48:51], v[200:203]
    s_waitcnt lgkmcnt(2)
    v_mfma_f32_16x16x32_bf16 v[204:207], v[56:59], v[36:39], v[204:207]
    ds_read_b64_tr_b16 v[64:65], v252 offset:128
    v_mfma_f32_16x16x32_bf16 v[208:211], v[56:59], v[40:43], v[208:211]
    ds_read_b64_tr_b16 v[66:67], v252 offset:1408
    v_mfma_f32_16x16x32_bf16 v[212:215], v[56:59], v[44:47], v[212:215]
    v_mfma_f32_16x16x32_bf16 v[216:219], v[56:59], v[48:51], v[216:219]
    s_waitcnt lgkmcnt(2)
    v_mfma_f32_16x16x32_bf16 v[220:223], v[60:63], v[36:39], v[220:223]
    ds_read_b64_tr_b16 v[52:53], v13 offset:20480
    v_mfma_f32_16x16x32_bf16 v[224:227], v[60:63], v[40:43], v[224:227]
    ds_read_b64_tr_b16 v[54:55], v13 offset:21760
    v_mfma_f32_16x16x32_bf16 v[228:231], v[60:63], v[44:47], v[228:231]
    v_mfma_f32_16x16x32_bf16 v[232:235], v[60:63], v[48:51], v[232:235]
    s_waitcnt lgkmcnt(2)
    v_mfma_f32_16x16x32_bf16 v[236:239], v[64:67], v[36:39], v[236:239]
    ds_read_b64_tr_b16 v[56:57], v14 offset:20512
    v_mfma_f32_16x16x32_bf16 v[240:243], v[64:67], v[40:43], v[240:243]
    ds_read_b64_tr_b16 v[58:59], v14 offset:21792
    v_mfma_f32_16x16x32_bf16 v[244:247], v[64:67], v[44:47], v[244:247]
    v_mfma_f32_16x16x32_bf16 v[248:251], v[64:67], v[48:51], v[248:251]
    s_barrier
    s_waitcnt lgkmcnt(2)
    v_mfma_f32_16x16x32_bf16 v[92:95], v[52:55], v[20:23], v[92:95]
    ds_read_b64_tr_b16 v[60:61], v13 offset:20544
    v_mfma_f32_16x16x32_bf16 v[96:99], v[52:55], v[24:27], v[96:99]
    ds_read_b64_tr_b16 v[62:63], v13 offset:21824
    v_mfma_f32_16x16x32_bf16 v[100:103], v[52:55], v[28:31], v[100:103]
    v_mfma_f32_16x16x32_bf16 v[104:107], v[52:55], v[32:35], v[104:107]
    s_waitcnt lgkmcnt(2)
    v_mfma_f32_16x16x32_bf16 v[108:111], v[56:59], v[20:23], v[108:111]
PGS_g_0:
    s_cbranch_execz PGS_g_1
    ds_read_b64_tr_b16 v[64:65], v14 offset:20576
    v_mfma_f32_16x16x32_bf16 v[112:115], v[56:59], v[24:27], v[112:115]
    ds_read_b64_tr_b16 v[66:67], v14 offset:21856
    v_mfma_f32_16x16x32_bf16 v[116:119], v[56:59], v[28:31], v[116:119]
    ds_read_b128 v[36:39], v254 offset:0
    v_mfma_f32_16x16x32_bf16 v[120:123], v[56:59], v[32:35], v[120:123]
    v_smfmac_f32_16x16x64_bf16 v[72:75], v[68:71], v[52:59], v0
    s_waitcnt lgkmcnt(3)
    v_mfma_f32_16x16x32_bf16 v[124:127], v[60:63], v[20:23], v[124:127]
    ds_read_b64_tr_b16 v[84:85], v3 offset:20608
    v_mfma_f32_16x16x32_bf16 v[128:131], v[60:63], v[24:27], v[128:131]
    ds_read_b64_tr_b16 v[86:87], v3 offset:21888
    v_mfma_f32_16x16x32_bf16 v[132:135], v[60:63], v[28:31], v[132:135]
    ds_read_b128 v[40:43], v254 offset:2048
    v_mfma_f32_16x16x32_bf16 v[136:139], v[60:63], v[32:35], v[136:139]
    s_waitcnt lgkmcnt(4)
    v_mfma_f32_16x16x32_bf16 v[140:143], v[64:67], v[20:23], v[140:143]
    ds_read_b64_tr_b16 v[56:57], v17 offset:20480
    v_mfma_f32_16x16x32_bf16 v[144:147], v[64:67], v[24:27], v[144:147]
    ds_read_b64_tr_b16 v[58:59], v17 offset:21760
    v_mfma_f32_16x16x32_bf16 v[148:151], v[64:67], v[28:31], v[148:151]
    ds_read_b128 v[44:47], v254 offset:4096
    v_mfma_f32_16x16x32_bf16 v[152:155], v[64:67], v[32:35], v[152:155]
    v_smfmac_f32_16x16x64_bf16 v[76:79], v[68:71], v[60:67], v0
    s_waitcnt lgkmcnt(4)
    v_mfma_f32_16x16x32_bf16 v[156:159], v[84:87], v[20:23], v[156:159]
    ds_read_b64_tr_b16 v[60:61], v18 offset:20512
    v_mfma_f32_16x16x32_bf16 v[160:163], v[84:87], v[24:27], v[160:163]
    ds_read_b64_tr_b16 v[62:63], v18 offset:21792
    v_mfma_f32_16x16x32_bf16 v[164:167], v[84:87], v[28:31], v[164:167]
    ds_read_b128 v[48:51], v254 offset:6144
    v_mfma_f32_16x16x32_bf16 v[168:171], v[84:87], v[32:35], v[168:171]
    s_waitcnt lgkmcnt(4)
    v_mfma_f32_16x16x32_bf16 v[172:175], v[56:59], v[20:23], v[172:175]
    ds_read_b64_tr_b16 v[64:65], v17 offset:20544
    v_mfma_f32_16x16x32_bf16 v[176:179], v[56:59], v[24:27], v[176:179]
    ds_read_b64_tr_b16 v[66:67], v17 offset:21824
    v_mfma_f32_16x16x32_bf16 v[180:183], v[56:59], v[28:31], v[180:183]
    v_mfma_f32_16x16x32_bf16 v[184:187], v[56:59], v[32:35], v[184:187]
    s_waitcnt lgkmcnt(3)
    v_mfma_f32_16x16x32_bf16 v[188:191], v[60:63], v[20:23], v[188:191]
    ds_read_b64_tr_b16 v[52:53], v18 offset:20576
    v_mfma_f32_16x16x32_bf16 v[192:195], v[60:63], v[24:27], v[192:195]
    ds_read_b64_tr_b16 v[54:55], v18 offset:21856
    v_mfma_f32_16x16x32_bf16 v[196:199], v[60:63], v[28:31], v[196:199]
    v_mfma_f32_16x16x32_bf16 v[200:203], v[60:63], v[32:35], v[200:203]
    s_waitcnt lgkmcnt(2)
    v_mfma_f32_16x16x32_bf16 v[204:207], v[64:67], v[20:23], v[204:207]
    ds_read_b64_tr_b16 v[56:57], v252 offset:20608
    v_mfma_f32_16x16x32_bf16 v[208:211], v[64:67], v[24:27], v[208:211]
    ds_read_b64_tr_b16 v[58:59], v252 offset:21888
    v_mfma_f32_16x16x32_bf16 v[212:215], v[64:67], v[28:31], v[212:215]
    v_mfma_f32_16x16x32_bf16 v[216:219], v[64:67], v[32:35], v[216:219]
    s_waitcnt lgkmcnt(2)
    v_mfma_f32_16x16x32_bf16 v[220:223], v[52:55], v[20:23], v[220:223]
    ds_read_b64_tr_b16 v[60:61], v13 offset:40960
    v_mfma_f32_16x16x32_bf16 v[224:227], v[52:55], v[24:27], v[224:227]
    ds_read_b64_tr_b16 v[62:63], v13 offset:42240
    v_mfma_f32_16x16x32_bf16 v[228:231], v[52:55], v[28:31], v[228:231]
    v_mfma_f32_16x16x32_bf16 v[232:235], v[52:55], v[32:35], v[232:235]
    s_waitcnt lgkmcnt(2)
    v_mfma_f32_16x16x32_bf16 v[236:239], v[56:59], v[20:23], v[236:239]
    ds_read_b64_tr_b16 v[64:65], v14 offset:40992
    v_mfma_f32_16x16x32_bf16 v[240:243], v[56:59], v[24:27], v[240:243]
    ds_read_b64_tr_b16 v[66:67], v14 offset:42272
    v_mfma_f32_16x16x32_bf16 v[244:247], v[56:59], v[28:31], v[244:247]
    v_mfma_f32_16x16x32_bf16 v[248:251], v[56:59], v[32:35], v[248:251]
    s_barrier
    s_waitcnt lgkmcnt(2)
    v_mfma_f32_16x16x32_bf16 v[92:95], v[60:63], v[36:39], v[92:95]
    ds_read_b64_tr_b16 v[52:53], v13 offset:41024
    v_mfma_f32_16x16x32_bf16 v[96:99], v[60:63], v[40:43], v[96:99]
    ds_read_b64_tr_b16 v[54:55], v13 offset:42304
    v_mfma_f32_16x16x32_bf16 v[100:103], v[60:63], v[44:47], v[100:103]
    v_mfma_f32_16x16x32_bf16 v[104:107], v[60:63], v[48:51], v[104:107]
    s_waitcnt lgkmcnt(2)
    v_mfma_f32_16x16x32_bf16 v[108:111], v[64:67], v[36:39], v[108:111]
    ds_read_b64_tr_b16 v[56:57], v14 offset:41056
    v_mfma_f32_16x16x32_bf16 v[112:115], v[64:67], v[40:43], v[112:115]
    ds_read_b64_tr_b16 v[58:59], v14 offset:42336
    v_mfma_f32_16x16x32_bf16 v[116:119], v[64:67], v[44:47], v[116:119]
    ds_read_b128 v[20:23], v6 offset:16384
    v_mfma_f32_16x16x32_bf16 v[120:123], v[64:67], v[48:51], v[120:123]
    v_smfmac_f32_16x16x64_bf16 v[72:75], v[68:71], v[60:67], v0
    s_waitcnt lgkmcnt(3)
    v_mfma_f32_16x16x32_bf16 v[124:127], v[52:55], v[36:39], v[124:127]
    ds_read_b64_tr_b16 v[88:89], v3 offset:41088
    v_mfma_f32_16x16x32_bf16 v[128:131], v[52:55], v[40:43], v[128:131]
    ds_read_b64_tr_b16 v[90:91], v3 offset:42368
    v_mfma_f32_16x16x32_bf16 v[132:135], v[52:55], v[44:47], v[132:135]
    ds_read_b128 v[24:27], v6 offset:18432
    v_mfma_f32_16x16x32_bf16 v[136:139], v[52:55], v[48:51], v[136:139]
    s_waitcnt lgkmcnt(4)
    v_mfma_f32_16x16x32_bf16 v[140:143], v[56:59], v[36:39], v[140:143]
    ds_read_b64_tr_b16 v[64:65], v17 offset:40960
    v_mfma_f32_16x16x32_bf16 v[144:147], v[56:59], v[40:43], v[144:147]
    ds_read_b64_tr_b16 v[66:67], v17 offset:42240
    v_mfma_f32_16x16x32_bf16 v[148:151], v[56:59], v[44:47], v[148:151]
    ds_read_b128 v[28:31], v6 offset:20480
    v_mfma_f32_16x16x32_bf16 v[152:155], v[56:59], v[48:51], v[152:155]
    v_smfmac_f32_16x16x64_bf16 v[76:79], v[68:71], v[52:59], v0
    s_waitcnt lgkmcnt(4)
    v_mfma_f32_16x16x32_bf16 v[156:159], v[88:91], v[36:39], v[156:159]
    ds_read_b64_tr_b16 v[52:53], v18 offset:40992
    v_mfma_f32_16x16x32_bf16 v[160:163], v[88:91], v[40:43], v[160:163]
    ds_read_b64_tr_b16 v[54:55], v18 offset:42272
    v_mfma_f32_16x16x32_bf16 v[164:167], v[88:91], v[44:47], v[164:167]
    ds_read_b128 v[32:35], v6 offset:22528
    v_mfma_f32_16x16x32_bf16 v[168:171], v[88:91], v[48:51], v[168:171]
    v_smfmac_f32_16x16x64_bf16 v[80:83], v[68:71], v[84:91], v0
    s_waitcnt lgkmcnt(4)
    v_mfma_f32_16x16x32_bf16 v[172:175], v[64:67], v[36:39], v[172:175]
    ds_read_b64_tr_b16 v[56:57], v17 offset:41024
    v_mfma_f32_16x16x32_bf16 v[176:179], v[64:67], v[40:43], v[176:179]
    ds_read_b64_tr_b16 v[58:59], v17 offset:42304
    v_mfma_f32_16x16x32_bf16 v[180:183], v[64:67], v[44:47], v[180:183]
    v_mfma_f32_16x16x32_bf16 v[184:187], v[64:67], v[48:51], v[184:187]
    s_waitcnt lgkmcnt(3)
    v_mfma_f32_16x16x32_bf16 v[188:191], v[52:55], v[36:39], v[188:191]
    ds_read_b64_tr_b16 v[60:61], v18 offset:41056
    v_mfma_f32_16x16x32_bf16 v[192:195], v[52:55], v[40:43], v[192:195]
    ds_read_b64_tr_b16 v[62:63], v18 offset:42336
    v_mfma_f32_16x16x32_bf16 v[196:199], v[52:55], v[44:47], v[196:199]
    v_mfma_f32_16x16x32_bf16 v[200:203], v[52:55], v[48:51], v[200:203]
    s_waitcnt lgkmcnt(2)
    v_mfma_f32_16x16x32_bf16 v[204:207], v[56:59], v[36:39], v[204:207]
    ds_read_b64_tr_b16 v[64:65], v252 offset:41088
    v_mfma_f32_16x16x32_bf16 v[208:211], v[56:59], v[40:43], v[208:211]
    ds_read_b64_tr_b16 v[66:67], v252 offset:42368
    v_mfma_f32_16x16x32_bf16 v[212:215], v[56:59], v[44:47], v[212:215]
    v_mfma_f32_16x16x32_bf16 v[216:219], v[56:59], v[48:51], v[216:219]
    s_waitcnt lgkmcnt(2)
    v_mfma_f32_16x16x32_bf16 v[220:223], v[60:63], v[36:39], v[220:223]
    ds_read_b64_tr_b16 v[52:53], v11 offset:0
    v_mfma_f32_16x16x32_bf16 v[224:227], v[60:63], v[40:43], v[224:227]
    ds_read_b64_tr_b16 v[54:55], v11 offset:1280
    v_mfma_f32_16x16x32_bf16 v[228:231], v[60:63], v[44:47], v[228:231]
    v_mfma_f32_16x16x32_bf16 v[232:235], v[60:63], v[48:51], v[232:235]
    s_waitcnt lgkmcnt(2)
    v_mfma_f32_16x16x32_bf16 v[236:239], v[64:67], v[36:39], v[236:239]
    ds_read_b64_tr_b16 v[56:57], v12 offset:32
    v_mfma_f32_16x16x32_bf16 v[240:243], v[64:67], v[40:43], v[240:243]
    ds_read_b64_tr_b16 v[58:59], v12 offset:1312
    v_mfma_f32_16x16x32_bf16 v[244:247], v[64:67], v[44:47], v[244:247]
    v_mfma_f32_16x16x32_bf16 v[248:251], v[64:67], v[48:51], v[248:251]
    s_barrier
    s_waitcnt lgkmcnt(2)
    v_mfma_f32_16x16x32_bf16 v[92:95], v[52:55], v[20:23], v[92:95]
    ds_read_b64_tr_b16 v[60:61], v11 offset:64
    v_mfma_f32_16x16x32_bf16 v[96:99], v[52:55], v[24:27], v[96:99]
    ds_read_b64_tr_b16 v[62:63], v11 offset:1344
    v_mfma_f32_16x16x32_bf16 v[100:103], v[52:55], v[28:31], v[100:103]
    v_mfma_f32_16x16x32_bf16 v[104:107], v[52:55], v[32:35], v[104:107]
    s_waitcnt lgkmcnt(2)
    v_mfma_f32_16x16x32_bf16 v[108:111], v[56:59], v[20:23], v[108:111]
    ds_read_b64_tr_b16 v[64:65], v12 offset:96
    v_mfma_f32_16x16x32_bf16 v[112:115], v[56:59], v[24:27], v[112:115]
    ds_read_b64_tr_b16 v[66:67], v12 offset:1376
    v_mfma_f32_16x16x32_bf16 v[116:119], v[56:59], v[28:31], v[116:119]
    ds_read_b128 v[36:39], v254 offset:16384
    v_mfma_f32_16x16x32_bf16 v[120:123], v[56:59], v[32:35], v[120:123]
    v_smfmac_f32_16x16x64_bf16 v[72:75], v[68:71], v[52:59], v0
    s_waitcnt lgkmcnt(3)
    v_mfma_f32_16x16x32_bf16 v[124:127], v[60:63], v[20:23], v[124:127]
    ds_read_b64_tr_b16 v[84:85], v2 offset:128
    v_mfma_f32_16x16x32_bf16 v[128:131], v[60:63], v[24:27], v[128:131]
    ds_read_b64_tr_b16 v[86:87], v2 offset:1408
    v_mfma_f32_16x16x32_bf16 v[132:135], v[60:63], v[28:31], v[132:135]
    ds_read_b128 v[40:43], v254 offset:18432
    v_mfma_f32_16x16x32_bf16 v[136:139], v[60:63], v[32:35], v[136:139]
    s_waitcnt lgkmcnt(4)
    v_mfma_f32_16x16x32_bf16 v[140:143], v[64:67], v[20:23], v[140:143]
    ds_read_b64_tr_b16 v[56:57], v15 offset:0
    v_mfma_f32_16x16x32_bf16 v[144:147], v[64:67], v[24:27], v[144:147]
    ds_read_b64_tr_b16 v[58:59], v15 offset:1280
    v_mfma_f32_16x16x32_bf16 v[148:151], v[64:67], v[28:31], v[148:151]
    ds_read_b128 v[44:47], v254 offset:20480
    v_mfma_f32_16x16x32_bf16 v[152:155], v[64:67], v[32:35], v[152:155]
    v_smfmac_f32_16x16x64_bf16 v[76:79], v[68:71], v[60:67], v0
    s_waitcnt lgkmcnt(4)
    v_mfma_f32_16x16x32_bf16 v[156:159], v[84:87], v[20:23], v[156:159]
    ds_read_b64_tr_b16 v[60:61], v16 offset:32
    v_mfma_f32_16x16x32_bf16 v[160:163], v[84:87], v[24:27], v[160:163]
    ds_read_b64_tr_b16 v[62:63], v16 offset:1312
    v_mfma_f32_16x16x32_bf16 v[164:167], v[84:87], v[28:31], v[164:167]
    ds_read_b128 v[48:51], v254 offset:22528
    v_mfma_f32_16x16x32_bf16 v[168:171], v[84:87], v[32:35], v[168:171]
    s_waitcnt lgkmcnt(4)
    v_mfma_f32_16x16x32_bf16 v[172:175], v[56:59], v[20:23], v[172:175]
    ds_read_b64_tr_b16 v[64:65], v15 offset:64
    v_mfma_f32_16x16x32_bf16 v[176:179], v[56:59], v[24:27], v[176:179]
    ds_read_b64_tr_b16 v[66:67], v15 offset:1344
    v_mfma_f32_16x16x32_bf16 v[180:183], v[56:59], v[28:31], v[180:183]
    v_mfma_f32_16x16x32_bf16 v[184:187], v[56:59], v[32:35], v[184:187]
    s_waitcnt lgkmcnt(3)
    v_mfma_f32_16x16x32_bf16 v[188:191], v[60:63], v[20:23], v[188:191]
    ds_read_b64_tr_b16 v[52:53], v16 offset:96
    v_mfma_f32_16x16x32_bf16 v[192:195], v[60:63], v[24:27], v[192:195]
    ds_read_b64_tr_b16 v[54:55], v16 offset:1376
    v_mfma_f32_16x16x32_bf16 v[196:199], v[60:63], v[28:31], v[196:199]
    v_mfma_f32_16x16x32_bf16 v[200:203], v[60:63], v[32:35], v[200:203]
    s_waitcnt lgkmcnt(2)
    v_mfma_f32_16x16x32_bf16 v[204:207], v[64:67], v[20:23], v[204:207]
    ds_read_b64_tr_b16 v[56:57], v5 offset:128
    v_mfma_f32_16x16x32_bf16 v[208:211], v[64:67], v[24:27], v[208:211]
    ds_read_b64_tr_b16 v[58:59], v5 offset:1408
    v_mfma_f32_16x16x32_bf16 v[212:215], v[64:67], v[28:31], v[212:215]
    v_mfma_f32_16x16x32_bf16 v[216:219], v[64:67], v[32:35], v[216:219]
    s_waitcnt lgkmcnt(2)
    v_mfma_f32_16x16x32_bf16 v[220:223], v[52:55], v[20:23], v[220:223]
    ds_read_b64_tr_b16 v[60:61], v11 offset:20480
    v_mfma_f32_16x16x32_bf16 v[224:227], v[52:55], v[24:27], v[224:227]
    ds_read_b64_tr_b16 v[62:63], v11 offset:21760
    v_mfma_f32_16x16x32_bf16 v[228:231], v[52:55], v[28:31], v[228:231]
    v_mfma_f32_16x16x32_bf16 v[232:235], v[52:55], v[32:35], v[232:235]
    s_waitcnt lgkmcnt(2)
    v_mfma_f32_16x16x32_bf16 v[236:239], v[56:59], v[20:23], v[236:239]
    ds_read_b64_tr_b16 v[64:65], v12 offset:20512
    v_mfma_f32_16x16x32_bf16 v[240:243], v[56:59], v[24:27], v[240:243]
    ds_read_b64_tr_b16 v[66:67], v12 offset:21792
    v_mfma_f32_16x16x32_bf16 v[244:247], v[56:59], v[28:31], v[244:247]
    v_mfma_f32_16x16x32_bf16 v[248:251], v[56:59], v[32:35], v[248:251]
    s_barrier
    s_waitcnt lgkmcnt(2)
    v_mfma_f32_16x16x32_bf16 v[92:95], v[60:63], v[36:39], v[92:95]
    ds_read_b64_tr_b16 v[52:53], v11 offset:20544
    v_mfma_f32_16x16x32_bf16 v[96:99], v[60:63], v[40:43], v[96:99]
    ds_read_b64_tr_b16 v[54:55], v11 offset:21824
    v_mfma_f32_16x16x32_bf16 v[100:103], v[60:63], v[44:47], v[100:103]
    v_mfma_f32_16x16x32_bf16 v[104:107], v[60:63], v[48:51], v[104:107]
    s_waitcnt lgkmcnt(2)
    v_mfma_f32_16x16x32_bf16 v[108:111], v[64:67], v[36:39], v[108:111]
    ds_read_b64_tr_b16 v[56:57], v12 offset:20576
    v_mfma_f32_16x16x32_bf16 v[112:115], v[64:67], v[40:43], v[112:115]
    ds_read_b64_tr_b16 v[58:59], v12 offset:21856
    v_mfma_f32_16x16x32_bf16 v[116:119], v[64:67], v[44:47], v[116:119]
    ds_read_b128 v[20:23], v6 offset:0
    v_mfma_f32_16x16x32_bf16 v[120:123], v[64:67], v[48:51], v[120:123]
    v_smfmac_f32_16x16x64_bf16 v[72:75], v[68:71], v[60:67], v0
    s_waitcnt lgkmcnt(3)
    v_mfma_f32_16x16x32_bf16 v[124:127], v[52:55], v[36:39], v[124:127]
    ds_read_b64_tr_b16 v[88:89], v2 offset:20608
    v_mfma_f32_16x16x32_bf16 v[128:131], v[52:55], v[40:43], v[128:131]
    ds_read_b64_tr_b16 v[90:91], v2 offset:21888
    v_mfma_f32_16x16x32_bf16 v[132:135], v[52:55], v[44:47], v[132:135]
    ds_read_b128 v[24:27], v6 offset:2048
    v_mfma_f32_16x16x32_bf16 v[136:139], v[52:55], v[48:51], v[136:139]
    s_waitcnt lgkmcnt(4)
    v_mfma_f32_16x16x32_bf16 v[140:143], v[56:59], v[36:39], v[140:143]
    ds_read_b64_tr_b16 v[64:65], v15 offset:20480
    v_mfma_f32_16x16x32_bf16 v[144:147], v[56:59], v[40:43], v[144:147]
    ds_read_b64_tr_b16 v[66:67], v15 offset:21760
    v_mfma_f32_16x16x32_bf16 v[148:151], v[56:59], v[44:47], v[148:151]
    ds_read_b128 v[28:31], v6 offset:4096
    v_mfma_f32_16x16x32_bf16 v[152:155], v[56:59], v[48:51], v[152:155]
    v_smfmac_f32_16x16x64_bf16 v[76:79], v[68:71], v[52:59], v0
    s_waitcnt lgkmcnt(4)
    v_mfma_f32_16x16x32_bf16 v[156:159], v[88:91], v[36:39], v[156:159]
    ds_read_b64_tr_b16 v[52:53], v16 offset:20512
    v_mfma_f32_16x16x32_bf16 v[160:163], v[88:91], v[40:43], v[160:163]
    ds_read_b64_tr_b16 v[54:55], v16 offset:21792
    v_mfma_f32_16x16x32_bf16 v[164:167], v[88:91], v[44:47], v[164:167]
    ds_read_b128 v[32:35], v6 offset:6144
    v_mfma_f32_16x16x32_bf16 v[168:171], v[88:91], v[48:51], v[168:171]
    v_smfmac_f32_16x16x64_bf16 v[80:83], v[68:71], v[84:91], v0
    s_waitcnt lgkmcnt(4)
    v_mfma_f32_16x16x32_bf16 v[172:175], v[64:67], v[36:39], v[172:175]
    ds_read_b64_tr_b16 v[56:57], v15 offset:20544
    v_mfma_f32_16x16x32_bf16 v[176:179], v[64:67], v[40:43], v[176:179]
    ds_read_b64_tr_b16 v[58:59], v15 offset:21824
    v_mfma_f32_16x16x32_bf16 v[180:183], v[64:67], v[44:47], v[180:183]
    v_mfma_f32_16x16x32_bf16 v[184:187], v[64:67], v[48:51], v[184:187]
    s_waitcnt lgkmcnt(3)
    v_mfma_f32_16x16x32_bf16 v[188:191], v[52:55], v[36:39], v[188:191]
    ds_read_b64_tr_b16 v[60:61], v16 offset:20576
    v_mfma_f32_16x16x32_bf16 v[192:195], v[52:55], v[40:43], v[192:195]
    ds_read_b64_tr_b16 v[62:63], v16 offset:21856
    v_mfma_f32_16x16x32_bf16 v[196:199], v[52:55], v[44:47], v[196:199]
    v_mfma_f32_16x16x32_bf16 v[200:203], v[52:55], v[48:51], v[200:203]
    s_waitcnt lgkmcnt(2)
    v_mfma_f32_16x16x32_bf16 v[204:207], v[56:59], v[36:39], v[204:207]
    ds_read_b64_tr_b16 v[64:65], v5 offset:20608
    v_mfma_f32_16x16x32_bf16 v[208:211], v[56:59], v[40:43], v[208:211]
    ds_read_b64_tr_b16 v[66:67], v5 offset:21888
    v_mfma_f32_16x16x32_bf16 v[212:215], v[56:59], v[44:47], v[212:215]
    v_mfma_f32_16x16x32_bf16 v[216:219], v[56:59], v[48:51], v[216:219]
    s_waitcnt lgkmcnt(2)
    v_mfma_f32_16x16x32_bf16 v[220:223], v[60:63], v[36:39], v[220:223]
    ds_read_b64_tr_b16 v[52:53], v11 offset:40960
    v_mfma_f32_16x16x32_bf16 v[224:227], v[60:63], v[40:43], v[224:227]
    ds_read_b64_tr_b16 v[54:55], v11 offset:42240
    v_mfma_f32_16x16x32_bf16 v[228:231], v[60:63], v[44:47], v[228:231]
    v_mfma_f32_16x16x32_bf16 v[232:235], v[60:63], v[48:51], v[232:235]
    s_waitcnt lgkmcnt(2)
    v_mfma_f32_16x16x32_bf16 v[236:239], v[64:67], v[36:39], v[236:239]
    ds_read_b64_tr_b16 v[56:57], v12 offset:40992
    v_mfma_f32_16x16x32_bf16 v[240:243], v[64:67], v[40:43], v[240:243]
    ds_read_b64_tr_b16 v[58:59], v12 offset:42272
    v_mfma_f32_16x16x32_bf16 v[244:247], v[64:67], v[44:47], v[244:247]
    v_mfma_f32_16x16x32_bf16 v[248:251], v[64:67], v[48:51], v[248:251]
    s_barrier
    s_waitcnt lgkmcnt(2)
    v_mfma_f32_16x16x32_bf16 v[92:95], v[52:55], v[20:23], v[92:95]
    ds_read_b64_tr_b16 v[60:61], v11 offset:41024
    v_mfma_f32_16x16x32_bf16 v[96:99], v[52:55], v[24:27], v[96:99]
    ds_read_b64_tr_b16 v[62:63], v11 offset:42304
    v_mfma_f32_16x16x32_bf16 v[100:103], v[52:55], v[28:31], v[100:103]
    v_mfma_f32_16x16x32_bf16 v[104:107], v[52:55], v[32:35], v[104:107]
    s_waitcnt lgkmcnt(2)
    v_mfma_f32_16x16x32_bf16 v[108:111], v[56:59], v[20:23], v[108:111]
    ds_read_b64_tr_b16 v[64:65], v12 offset:41056
    v_mfma_f32_16x16x32_bf16 v[112:115], v[56:59], v[24:27], v[112:115]
    ds_read_b64_tr_b16 v[66:67], v12 offset:42336
    v_mfma_f32_16x16x32_bf16 v[116:119], v[56:59], v[28:31], v[116:119]
    ds_read_b128 v[36:39], v254 offset:0
    v_mfma_f32_16x16x32_bf16 v[120:123], v[56:59], v[32:35], v[120:123]
    v_smfmac_f32_16x16x64_bf16 v[72:75], v[68:71], v[52:59], v0
    s_waitcnt lgkmcnt(3)
    v_mfma_f32_16x16x32_bf16 v[124:127], v[60:63], v[20:23], v[124:127]
    ds_read_b64_tr_b16 v[84:85], v2 offset:41088
    v_mfma_f32_16x16x32_bf16 v[128:131], v[60:63], v[24:27], v[128:131]
    ds_read_b64_tr_b16 v[86:87], v2 offset:42368
    v_mfma_f32_16x16x32_bf16 v[132:135], v[60:63], v[28:31], v[132:135]
    ds_read_b128 v[40:43], v254 offset:2048
    v_mfma_f32_16x16x32_bf16 v[136:139], v[60:63], v[32:35], v[136:139]
    s_waitcnt lgkmcnt(4)
    v_mfma_f32_16x16x32_bf16 v[140:143], v[64:67], v[20:23], v[140:143]
    ds_read_b64_tr_b16 v[56:57], v15 offset:40960
    v_mfma_f32_16x16x32_bf16 v[144:147], v[64:67], v[24:27], v[144:147]
    ds_read_b64_tr_b16 v[58:59], v15 offset:42240
    v_mfma_f32_16x16x32_bf16 v[148:151], v[64:67], v[28:31], v[148:151]
    ds_read_b128 v[44:47], v254 offset:4096
    v_mfma_f32_16x16x32_bf16 v[152:155], v[64:67], v[32:35], v[152:155]
    v_smfmac_f32_16x16x64_bf16 v[76:79], v[68:71], v[60:67], v0
    s_waitcnt lgkmcnt(4)
    v_mfma_f32_16x16x32_bf16 v[156:159], v[84:87], v[20:23], v[156:159]
    ds_read_b64_tr_b16 v[60:61], v16 offset:40992
    v_mfma_f32_16x16x32_bf16 v[160:163], v[84:87], v[24:27], v[160:163]
    ds_read_b64_tr_b16 v[62:63], v16 offset:42272
    v_mfma_f32_16x16x32_bf16 v[164:167], v[84:87], v[28:31], v[164:167]
    ds_read_b128 v[48:51], v254 offset:6144
    v_mfma_f32_16x16x32_bf16 v[168:171], v[84:87], v[32:35], v[168:171]
    s_waitcnt lgkmcnt(4)
    v_mfma_f32_16x16x32_bf16 v[172:175], v[56:59], v[20:23], v[172:175]
    ds_read_b64_tr_b16 v[64:65], v15 offset:41024
    v_mfma_f32_16x16x32_bf16 v[176:179], v[56:59], v[24:27], v[176:179]
    ds_read_b64_tr_b16 v[66:67], v15 offset:42304
    v_mfma_f32_16x16x32_bf16 v[180:183], v[56:59], v[28:31], v[180:183]
    v_mfma_f32_16x16x32_bf16 v[184:187], v[56:59], v[32:35], v[184:187]
    s_waitcnt lgkmcnt(3)
    v_mfma_f32_16x16x32_bf16 v[188:191], v[60:63], v[20:23], v[188:191]
    ds_read_b64_tr_b16 v[52:53], v16 offset:41056
    v_mfma_f32_16x16x32_bf16 v[192:195], v[60:63], v[24:27], v[192:195]
    ds_read_b64_tr_b16 v[54:55], v16 offset:42336
    v_mfma_f32_16x16x32_bf16 v[196:199], v[60:63], v[28:31], v[196:199]
    v_mfma_f32_16x16x32_bf16 v[200:203], v[60:63], v[32:35], v[200:203]
    s_waitcnt lgkmcnt(2)
    v_mfma_f32_16x16x32_bf16 v[204:207], v[64:67], v[20:23], v[204:207]
    ds_read_b64_tr_b16 v[56:57], v5 offset:41088
    v_mfma_f32_16x16x32_bf16 v[208:211], v[64:67], v[24:27], v[208:211]
    ds_read_b64_tr_b16 v[58:59], v5 offset:42368
    v_mfma_f32_16x16x32_bf16 v[212:215], v[64:67], v[28:31], v[212:215]
    v_mfma_f32_16x16x32_bf16 v[216:219], v[64:67], v[32:35], v[216:219]
    s_waitcnt lgkmcnt(2)
    v_mfma_f32_16x16x32_bf16 v[220:223], v[52:55], v[20:23], v[220:223]
    ds_read_b64_tr_b16 v[60:61], v13 offset:0
    v_mfma_f32_16x16x32_bf16 v[224:227], v[52:55], v[24:27], v[224:227]
    ds_read_b64_tr_b16 v[62:63], v13 offset:1280
    v_mfma_f32_16x16x32_bf16 v[228:231], v[52:55], v[28:31], v[228:231]
    v_mfma_f32_16x16x32_bf16 v[232:235], v[52:55], v[32:35], v[232:235]
    s_waitcnt lgkmcnt(2)
    v_mfma_f32_16x16x32_bf16 v[236:239], v[56:59], v[20:23], v[236:239]
    ds_read_b64_tr_b16 v[64:65], v14 offset:32
    v_mfma_f32_16x16x32_bf16 v[240:243], v[56:59], v[24:27], v[240:243]
    ds_read_b64_tr_b16 v[66:67], v14 offset:1312
    v_mfma_f32_16x16x32_bf16 v[244:247], v[56:59], v[28:31], v[244:247]
    v_mfma_f32_16x16x32_bf16 v[248:251], v[56:59], v[32:35], v[248:251]
    s_barrier
    s_waitcnt lgkmcnt(2)
    v_mfma_f32_16x16x32_bf16 v[92:95], v[60:63], v[36:39], v[92:95]
    ds_read_b64_tr_b16 v[52:53], v13 offset:64
    v_mfma_f32_16x16x32_bf16 v[96:99], v[60:63], v[40:43], v[96:99]
    ds_read_b64_tr_b16 v[54:55], v13 offset:1344
    v_mfma_f32_16x16x32_bf16 v[100:103], v[60:63], v[44:47], v[100:103]
    v_mfma_f32_16x16x32_bf16 v[104:107], v[60:63], v[48:51], v[104:107]
    s_waitcnt lgkmcnt(2)
    v_mfma_f32_16x16x32_bf16 v[108:111], v[64:67], v[36:39], v[108:111]
    ds_read_b64_tr_b16 v[56:57], v14 offset:96
    v_mfma_f32_16x16x32_bf16 v[112:115], v[64:67], v[40:43], v[112:115]
    ds_read_b64_tr_b16 v[58:59], v14 offset:1376
    v_mfma_f32_16x16x32_bf16 v[116:119], v[64:67], v[44:47], v[116:119]
    ds_read_b128 v[20:23], v6 offset:16384
    v_mfma_f32_16x16x32_bf16 v[120:123], v[64:67], v[48:51], v[120:123]
    v_smfmac_f32_16x16x64_bf16 v[72:75], v[68:71], v[60:67], v0
    s_waitcnt lgkmcnt(3)
    v_mfma_f32_16x16x32_bf16 v[124:127], v[52:55], v[36:39], v[124:127]
    ds_read_b64_tr_b16 v[88:89], v3 offset:128
    v_mfma_f32_16x16x32_bf16 v[128:131], v[52:55], v[40:43], v[128:131]
    ds_read_b64_tr_b16 v[90:91], v3 offset:1408
    v_mfma_f32_16x16x32_bf16 v[132:135], v[52:55], v[44:47], v[132:135]
    ds_read_b128 v[24:27], v6 offset:18432
    v_mfma_f32_16x16x32_bf16 v[136:139], v[52:55], v[48:51], v[136:139]
    s_waitcnt lgkmcnt(4)
    v_mfma_f32_16x16x32_bf16 v[140:143], v[56:59], v[36:39], v[140:143]
    ds_read_b64_tr_b16 v[64:65], v17 offset:0
    v_mfma_f32_16x16x32_bf16 v[144:147], v[56:59], v[40:43], v[144:147]
    ds_read_b64_tr_b16 v[66:67], v17 offset:1280
    v_mfma_f32_16x16x32_bf16 v[148:151], v[56:59], v[44:47], v[148:151]
    ds_read_b128 v[28:31], v6 offset:20480
    v_mfma_f32_16x16x32_bf16 v[152:155], v[56:59], v[48:51], v[152:155]
    v_smfmac_f32_16x16x64_bf16 v[76:79], v[68:71], v[52:59], v0
    s_waitcnt lgkmcnt(4)
    v_mfma_f32_16x16x32_bf16 v[156:159], v[88:91], v[36:39], v[156:159]
    ds_read_b64_tr_b16 v[52:53], v18 offset:32
    v_mfma_f32_16x16x32_bf16 v[160:163], v[88:91], v[40:43], v[160:163]
    ds_read_b64_tr_b16 v[54:55], v18 offset:1312
    v_mfma_f32_16x16x32_bf16 v[164:167], v[88:91], v[44:47], v[164:167]
    ds_read_b128 v[32:35], v6 offset:22528
    v_mfma_f32_16x16x32_bf16 v[168:171], v[88:91], v[48:51], v[168:171]
    v_smfmac_f32_16x16x64_bf16 v[80:83], v[68:71], v[84:91], v0
    s_waitcnt lgkmcnt(4)
    v_mfma_f32_16x16x32_bf16 v[172:175], v[64:67], v[36:39], v[172:175]
    ds_read_b64_tr_b16 v[56:57], v17 offset:64
    v_mfma_f32_16x16x32_bf16 v[176:179], v[64:67], v[40:43], v[176:179]
    ds_read_b64_tr_b16 v[58:59], v17 offset:1344
    v_mfma_f32_16x16x32_bf16 v[180:183], v[64:67], v[44:47], v[180:183]
    v_mfma_f32_16x16x32_bf16 v[184:187], v[64:67], v[48:51], v[184:187]
    s_waitcnt lgkmcnt(3)
    v_mfma_f32_16x16x32_bf16 v[188:191], v[52:55], v[36:39], v[188:191]
    ds_read_b64_tr_b16 v[60:61], v18 offset:96
    v_mfma_f32_16x16x32_bf16 v[192:195], v[52:55], v[40:43], v[192:195]
    ds_read_b64_tr_b16 v[62:63], v18 offset:1376
    v_mfma_f32_16x16x32_bf16 v[196:199], v[52:55], v[44:47], v[196:199]
    v_mfma_f32_16x16x32_bf16 v[200:203], v[52:55], v[48:51], v[200:203]
    s_waitcnt lgkmcnt(2)
    v_mfma_f32_16x16x32_bf16 v[204:207], v[56:59], v[36:39], v[204:207]
    ds_read_b64_tr_b16 v[64:65], v252 offset:128
    v_mfma_f32_16x16x32_bf16 v[208:211], v[56:59], v[40:43], v[208:211]
    ds_read_b64_tr_b16 v[66:67], v252 offset:1408
    v_mfma_f32_16x16x32_bf16 v[212:215], v[56:59], v[44:47], v[212:215]
    v_mfma_f32_16x16x32_bf16 v[216:219], v[56:59], v[48:51], v[216:219]
    s_waitcnt lgkmcnt(2)
    v_mfma_f32_16x16x32_bf16 v[220:223], v[60:63], v[36:39], v[220:223]
    ds_read_b64_tr_b16 v[52:53], v13 offset:20480
    v_mfma_f32_16x16x32_bf16 v[224:227], v[60:63], v[40:43], v[224:227]
    ds_read_b64_tr_b16 v[54:55], v13 offset:21760
    v_mfma_f32_16x16x32_bf16 v[228:231], v[60:63], v[44:47], v[228:231]
    v_mfma_f32_16x16x32_bf16 v[232:235], v[60:63], v[48:51], v[232:235]
    s_waitcnt lgkmcnt(2)
    v_mfma_f32_16x16x32_bf16 v[236:239], v[64:67], v[36:39], v[236:239]
    ds_read_b64_tr_b16 v[56:57], v14 offset:20512
    v_mfma_f32_16x16x32_bf16 v[240:243], v[64:67], v[40:43], v[240:243]
    ds_read_b64_tr_b16 v[58:59], v14 offset:21792
    v_mfma_f32_16x16x32_bf16 v[244:247], v[64:67], v[44:47], v[244:247]
    v_mfma_f32_16x16x32_bf16 v[248:251], v[64:67], v[48:51], v[248:251]
    s_barrier
    s_waitcnt lgkmcnt(2)
    v_mfma_f32_16x16x32_bf16 v[92:95], v[52:55], v[20:23], v[92:95]
    ds_read_b64_tr_b16 v[60:61], v13 offset:20544
    v_mfma_f32_16x16x32_bf16 v[96:99], v[52:55], v[24:27], v[96:99]
    ds_read_b64_tr_b16 v[62:63], v13 offset:21824
    v_mfma_f32_16x16x32_bf16 v[100:103], v[52:55], v[28:31], v[100:103]
    v_mfma_f32_16x16x32_bf16 v[104:107], v[52:55], v[32:35], v[104:107]
    s_waitcnt lgkmcnt(2)
    v_mfma_f32_16x16x32_bf16 v[108:111], v[56:59], v[20:23], v[108:111]
    ds_read_b64_tr_b16 v[64:65], v14 offset:20576
    v_mfma_f32_16x16x32_bf16 v[112:115], v[56:59], v[24:27], v[112:115]
    ds_read_b64_tr_b16 v[66:67], v14 offset:21856
    v_mfma_f32_16x16x32_bf16 v[116:119], v[56:59], v[28:31], v[116:119]
    ds_read_b128 v[36:39], v254 offset:16384
    v_mfma_f32_16x16x32_bf16 v[120:123], v[56:59], v[32:35], v[120:123]
    v_smfmac_f32_16x16x64_bf16 v[72:75], v[68:71], v[52:59], v0
    s_waitcnt lgkmcnt(3)
    v_mfma_f32_16x16x32_bf16 v[124:127], v[60:63], v[20:23], v[124:127]
    ds_read_b64_tr_b16 v[84:85], v3 offset:20608
    v_mfma_f32_16x16x32_bf16 v[128:131], v[60:63], v[24:27], v[128:131]
    ds_read_b64_tr_b16 v[86:87], v3 offset:21888
    v_mfma_f32_16x16x32_bf16 v[132:135], v[60:63], v[28:31], v[132:135]
    ds_read_b128 v[40:43], v254 offset:18432
    v_mfma_f32_16x16x32_bf16 v[136:139], v[60:63], v[32:35], v[136:139]
    s_waitcnt lgkmcnt(4)
    v_mfma_f32_16x16x32_bf16 v[140:143], v[64:67], v[20:23], v[140:143]
    ds_read_b64_tr_b16 v[56:57], v17 offset:20480
    v_mfma_f32_16x16x32_bf16 v[144:147], v[64:67], v[24:27], v[144:147]
    ds_read_b64_tr_b16 v[58:59], v17 offset:21760
    v_mfma_f32_16x16x32_bf16 v[148:151], v[64:67], v[28:31], v[148:151]
    ds_read_b128 v[44:47], v254 offset:20480
    v_mfma_f32_16x16x32_bf16 v[152:155], v[64:67], v[32:35], v[152:155]
    v_smfmac_f32_16x16x64_bf16 v[76:79], v[68:71], v[60:67], v0
    s_waitcnt lgkmcnt(4)
    v_mfma_f32_16x16x32_bf16 v[156:159], v[84:87], v[20:23], v[156:159]
    ds_read_b64_tr_b16 v[60:61], v18 offset:20512
    v_mfma_f32_16x16x32_bf16 v[160:163], v[84:87], v[24:27], v[160:163]
    ds_read_b64_tr_b16 v[62:63], v18 offset:21792
    v_mfma_f32_16x16x32_bf16 v[164:167], v[84:87], v[28:31], v[164:167]
    ds_read_b128 v[48:51], v254 offset:22528
    v_mfma_f32_16x16x32_bf16 v[168:171], v[84:87], v[32:35], v[168:171]
    s_waitcnt lgkmcnt(4)
    v_mfma_f32_16x16x32_bf16 v[172:175], v[56:59], v[20:23], v[172:175]
    ds_read_b64_tr_b16 v[64:65], v17 offset:20544
    v_mfma_f32_16x16x32_bf16 v[176:179], v[56:59], v[24:27], v[176:179]
    ds_read_b64_tr_b16 v[66:67], v17 offset:21824
    v_mfma_f32_16x16x32_bf16 v[180:183], v[56:59], v[28:31], v[180:183]
    v_mfma_f32_16x16x32_bf16 v[184:187], v[56:59], v[32:35], v[184:187]
    s_waitcnt lgkmcnt(3)
    v_mfma_f32_16x16x32_bf16 v[188:191], v[60:63], v[20:23], v[188:191]
    ds_read_b64_tr_b16 v[52:53], v18 offset:20576
    v_mfma_f32_16x16x32_bf16 v[192:195], v[60:63], v[24:27], v[192:195]
    ds_read_b64_tr_b16 v[54:55], v18 offset:21856
    v_mfma_f32_16x16x32_bf16 v[196:199], v[60:63], v[28:31], v[196:199]
    v_mfma_f32_16x16x32_bf16 v[200:203], v[60:63], v[32:35], v[200:203]
    s_waitcnt lgkmcnt(2)
    v_mfma_f32_16x16x32_bf16 v[204:207], v[64:67], v[20:23], v[204:207]
    ds_read_b64_tr_b16 v[56:57], v252 offset:20608
    v_mfma_f32_16x16x32_bf16 v[208:211], v[64:67], v[24:27], v[208:211]
    ds_read_b64_tr_b16 v[58:59], v252 offset:21888
    v_mfma_f32_16x16x32_bf16 v[212:215], v[64:67], v[28:31], v[212:215]
    v_mfma_f32_16x16x32_bf16 v[216:219], v[64:67], v[32:35], v[216:219]
    s_waitcnt lgkmcnt(2)
    v_mfma_f32_16x16x32_bf16 v[220:223], v[52:55], v[20:23], v[220:223]
    ds_read_b64_tr_b16 v[60:61], v13 offset:40960
    v_mfma_f32_16x16x32_bf16 v[224:227], v[52:55], v[24:27], v[224:227]
    ds_read_b64_tr_b16 v[62:63], v13 offset:42240
    v_mfma_f32_16x16x32_bf16 v[228:231], v[52:55], v[28:31], v[228:231]
    v_mfma_f32_16x16x32_bf16 v[232:235], v[52:55], v[32:35], v[232:235]
    s_waitcnt lgkmcnt(2)
    v_mfma_f32_16x16x32_bf16 v[236:239], v[56:59], v[20:23], v[236:239]
    ds_read_b64_tr_b16 v[64:65], v14 offset:40992
    v_mfma_f32_16x16x32_bf16 v[240:243], v[56:59], v[24:27], v[240:243]
    ds_read_b64_tr_b16 v[66:67], v14 offset:42272
    v_mfma_f32_16x16x32_bf16 v[244:247], v[56:59], v[28:31], v[244:247]
    v_mfma_f32_16x16x32_bf16 v[248:251], v[56:59], v[32:35], v[248:251]
    s_barrier
    s_waitcnt lgkmcnt(2)
    v_mfma_f32_16x16x32_bf16 v[92:95], v[60:63], v[36:39], v[92:95]
    ds_read_b64_tr_b16 v[52:53], v13 offset:41024
    v_mfma_f32_16x16x32_bf16 v[96:99], v[60:63], v[40:43], v[96:99]
    ds_read_b64_tr_b16 v[54:55], v13 offset:42304
    v_mfma_f32_16x16x32_bf16 v[100:103], v[60:63], v[44:47], v[100:103]
    v_mfma_f32_16x16x32_bf16 v[104:107], v[60:63], v[48:51], v[104:107]
    s_waitcnt lgkmcnt(2)
    v_mfma_f32_16x16x32_bf16 v[108:111], v[64:67], v[36:39], v[108:111]
    ds_read_b64_tr_b16 v[56:57], v14 offset:41056
    v_mfma_f32_16x16x32_bf16 v[112:115], v[64:67], v[40:43], v[112:115]
    ds_read_b64_tr_b16 v[58:59], v14 offset:42336
    v_mfma_f32_16x16x32_bf16 v[116:119], v[64:67], v[44:47], v[116:119]
    ds_read_b128 v[20:23], v6 offset:0
    v_mfma_f32_16x16x32_bf16 v[120:123], v[64:67], v[48:51], v[120:123]
    v_smfmac_f32_16x16x64_bf16 v[72:75], v[68:71], v[60:67], v0
    s_waitcnt lgkmcnt(3)
    v_mfma_f32_16x16x32_bf16 v[124:127], v[52:55], v[36:39], v[124:127]
PGS_g_1:
    s_cbranch_execz PGS_g_2
    ds_read_b64_tr_b16 v[88:89], v3 offset:41088
    v_mfma_f32_16x16x32_bf16 v[128:131], v[52:55], v[40:43], v[128:131]
    ds_read_b64_tr_b16 v[90:91], v3 offset:42368
    v_mfma_f32_16x16x32_bf16 v[132:135], v[52:55], v[44:47], v[132:135]
    ds_read_b128 v[24:27], v6 offset:2048
    v_mfma_f32_16x16x32_bf16 v[136:139], v[52:55], v[48:51], v[136:139]
    s_waitcnt lgkmcnt(4)
    v_mfma_f32_16x16x32_bf16 v[140:143], v[56:59], v[36:39], v[140:143]
    ds_read_b64_tr_b16 v[64:65], v17 offset:40960
    v_mfma_f32_16x16x32_bf16 v[144:147], v[56:59], v[40:43], v[144:147]
    ds_read_b64_tr_b16 v[66:67], v17 offset:42240
    v_mfma_f32_16x16x32_bf16 v[148:151], v[56:59], v[44:47], v[148:151]
    ds_read_b128 v[28:31], v6 offset:4096
    v_mfma_f32_16x16x32_bf16 v[152:155], v[56:59], v[48:51], v[152:155]
    v_smfmac_f32_16x16x64_bf16 v[76:79], v[68:71], v[52:59], v0
    s_waitcnt lgkmcnt(4)
    v_mfma_f32_16x16x32_bf16 v[156:159], v[88:91], v[36:39], v[156:159]
    ds_read_b64_tr_b16 v[52:53], v18 offset:40992
    v_mfma_f32_16x16x32_bf16 v[160:163], v[88:91], v[40:43], v[160:163]
    ds_read_b64_tr_b16 v[54:55], v18 offset:42272
    v_mfma_f32_16x16x32_bf16 v[164:167], v[88:91], v[44:47], v[164:167]
    ds_read_b128 v[32:35], v6 offset:6144
    v_mfma_f32_16x16x32_bf16 v[168:171], v[88:91], v[48:51], v[168:171]
    v_smfmac_f32_16x16x64_bf16 v[80:83], v[68:71], v[84:91], v0
    s_waitcnt lgkmcnt(4)
    v_mfma_f32_16x16x32_bf16 v[172:175], v[64:67], v[36:39], v[172:175]
    ds_read_b64_tr_b16 v[56:57], v17 offset:41024
    v_mfma_f32_16x16x32_bf16 v[176:179], v[64:67], v[40:43], v[176:179]
    ds_read_b64_tr_b16 v[58:59], v17 offset:42304
    v_mfma_f32_16x16x32_bf16 v[180:183], v[64:67], v[44:47], v[180:183]
    v_mfma_f32_16x16x32_bf16 v[184:187], v[64:67], v[48:51], v[184:187]
    s_waitcnt lgkmcnt(3)
    v_mfma_f32_16x16x32_bf16 v[188:191], v[52:55], v[36:39], v[188:191]
    ds_read_b64_tr_b16 v[60:61], v18 offset:41056
    v_mfma_f32_16x16x32_bf16 v[192:195], v[52:55], v[40:43], v[192:195]
    ds_read_b64_tr_b16 v[62:63], v18 offset:42336
    v_mfma_f32_16x16x32_bf16 v[196:199], v[52:55], v[44:47], v[196:199]
    v_mfma_f32_16x16x32_bf16 v[200:203], v[52:55], v[48:51], v[200:203]
    s_waitcnt lgkmcnt(2)
    v_mfma_f32_16x16x32_bf16 v[204:207], v[56:59], v[36:39], v[204:207]
    ds_read_b64_tr_b16 v[64:65], v252 offset:41088
    v_mfma_f32_16x16x32_bf16 v[208:211], v[56:59], v[40:43], v[208:211]
    ds_read_b64_tr_b16 v[66:67], v252 offset:42368
    v_mfma_f32_16x16x32_bf16 v[212:215], v[56:59], v[44:47], v[212:215]
    v_mfma_f32_16x16x32_bf16 v[216:219], v[56:59], v[48:51], v[216:219]
    s_waitcnt lgkmcnt(2)
    v_mfma_f32_16x16x32_bf16 v[220:223], v[60:63], v[36:39], v[220:223]
    ds_read_b64_tr_b16 v[52:53], v11 offset:0
    v_mfma_f32_16x16x32_bf16 v[224:227], v[60:63], v[40:43], v[224:227]
    ds_read_b64_tr_b16 v[54:55], v11 offset:1280
    v_mfma_f32_16x16x32_bf16 v[228:231], v[60:63], v[44:47], v[228:231]
    v_mfma_f32_16x16x32_bf16 v[232:235], v[60:63], v[48:51], v[232:235]
    s_waitcnt lgkmcnt(2)
    v_mfma_f32_16x16x32_bf16 v[236:239], v[64:67], v[36:39], v[236:239]
    ds_read_b64_tr_b16 v[56:57], v12 offset:32
    v_mfma_f32_16x16x32_bf16 v[240:243], v[64:67], v[40:43], v[240:243]
    ds_read_b64_tr_b16 v[58:59], v12 offset:1312
    v_mfma_f32_16x16x32_bf16 v[244:247], v[64:67], v[44:47], v[244:247]
    v_mfma_f32_16x16x32_bf16 v[248:251], v[64:67], v[48:51], v[248:251]
    s_barrier
    s_waitcnt lgkmcnt(2)
    v_mfma_f32_16x16x32_bf16 v[92:95], v[52:55], v[20:23], v[92:95]
    ds_read_b64_tr_b16 v[60:61], v11 offset:64
    v_mfma_f32_16x16x32_bf16 v[96:99], v[52:55], v[24:27], v[96:99]
    ds_read_b64_tr_b16 v[62:63], v11 offset:1344
    v_mfma_f32_16x16x32_bf16 v[100:103], v[52:55], v[28:31], v[100:103]
    v_mfma_f32_16x16x32_bf16 v[104:107], v[52:55], v[32:35], v[104:107]
    s_waitcnt lgkmcnt(2)
    v_mfma_f32_16x16x32_bf16 v[108:111], v[56:59], v[20:23], v[108:111]
    ds_read_b64_tr_b16 v[64:65], v12 offset:96
    v_mfma_f32_16x16x32_bf16 v[112:115], v[56:59], v[24:27], v[112:115]
    ds_read_b64_tr_b16 v[66:67], v12 offset:1376
    v_mfma_f32_16x16x32_bf16 v[116:119], v[56:59], v[28:31], v[116:119]
    ds_read_b128 v[36:39], v254 offset:0
    v_mfma_f32_16x16x32_bf16 v[120:123], v[56:59], v[32:35], v[120:123]
    v_smfmac_f32_16x16x64_bf16 v[72:75], v[68:71], v[52:59], v0
    s_waitcnt lgkmcnt(3)
    v_mfma_f32_16x16x32_bf16 v[124:127], v[60:63], v[20:23], v[124:127]
    ds_read_b64_tr_b16 v[84:85], v2 offset:128
    v_mfma_f32_16x16x32_bf16 v[128:131], v[60:63], v[24:27], v[128:131]
    ds_read_b64_tr_b16 v[86:87], v2 offset:1408
    v_mfma_f32_16x16x32_bf16 v[132:135], v[60:63], v[28:31], v[132:135]
    ds_read_b128 v[40:43], v254 offset:2048
    v_mfma_f32_16x16x32_bf16 v[136:139], v[60:63], v[32:35], v[136:139]
    s_waitcnt lgkmcnt(4)
    v_mfma_f32_16x16x32_bf16 v[140:143], v[64:67], v[20:23], v[140:143]
    ds_read_b64_tr_b16 v[56:57], v15 offset:0
    v_mfma_f32_16x16x32_bf16 v[144:147], v[64:67], v[24:27], v[144:147]
    ds_read_b64_tr_b16 v[58:59], v15 offset:1280
    v_mfma_f32_16x16x32_bf16 v[148:151], v[64:67], v[28:31], v[148:151]
    ds_read_b128 v[44:47], v254 offset:4096
    v_mfma_f32_16x16x32_bf16 v[152:155], v[64:67], v[32:35], v[152:155]
    v_smfmac_f32_16x16x64_bf16 v[76:79], v[68:71], v[60:67], v0
    s_waitcnt lgkmcnt(4)
    v_mfma_f32_16x16x32_bf16 v[156:159], v[84:87], v[20:23], v[156:159]
    ds_read_b64_tr_b16 v[60:61], v16 offset:32
    v_mfma_f32_16x16x32_bf16 v[160:163], v[84:87], v[24:27], v[160:163]
    ds_read_b64_tr_b16 v[62:63], v16 offset:1312
    v_mfma_f32_16x16x32_bf16 v[164:167], v[84:87], v[28:31], v[164:167]
    ds_read_b128 v[48:51], v254 offset:6144
    v_mfma_f32_16x16x32_bf16 v[168:171], v[84:87], v[32:35], v[168:171]
    s_waitcnt lgkmcnt(4)
    v_mfma_f32_16x16x32_bf16 v[172:175], v[56:59], v[20:23], v[172:175]
    ds_read_b64_tr_b16 v[64:65], v15 offset:64
    v_mfma_f32_16x16x32_bf16 v[176:179], v[56:59], v[24:27], v[176:179]
    ds_read_b64_tr_b16 v[66:67], v15 offset:1344
    v_mfma_f32_16x16x32_bf16 v[180:183], v[56:59], v[28:31], v[180:183]
    v_mfma_f32_16x16x32_bf16 v[184:187], v[56:59], v[32:35], v[184:187]
    s_waitcnt lgkmcnt(3)
    v_mfma_f32_16x16x32_bf16 v[188:191], v[60:63], v[20:23], v[188:191]
    ds_read_b64_tr_b16 v[52:53], v16 offset:96
    v_mfma_f32_16x16x32_bf16 v[192:195], v[60:63], v[24:27], v[192:195]
    ds_read_b64_tr_b16 v[54:55], v16 offset:1376
    v_mfma_f32_16x16x32_bf16 v[196:199], v[60:63], v[28:31], v[196:199]
    v_mfma_f32_16x16x32_bf16 v[200:203], v[60:63], v[32:35], v[200:203]
    s_waitcnt lgkmcnt(2)
    v_mfma_f32_16x16x32_bf16 v[204:207], v[64:67], v[20:23], v[204:207]
    ds_read_b64_tr_b16 v[56:57], v5 offset:128
    v_mfma_f32_16x16x32_bf16 v[208:211], v[64:67], v[24:27], v[208:211]
    ds_read_b64_tr_b16 v[58:59], v5 offset:1408
    v_mfma_f32_16x16x32_bf16 v[212:215], v[64:67], v[28:31], v[212:215]
    v_mfma_f32_16x16x32_bf16 v[216:219], v[64:67], v[32:35], v[216:219]
    s_waitcnt lgkmcnt(2)
    v_mfma_f32_16x16x32_bf16 v[220:223], v[52:55], v[20:23], v[220:223]
    ds_read_b64_tr_b16 v[60:61], v11 offset:20480
    v_mfma_f32_16x16x32_bf16 v[224:227], v[52:55], v[24:27], v[224:227]
    ds_read_b64_tr_b16 v[62:63], v11 offset:21760
    v_mfma_f32_16x16x32_bf16 v[228:231], v[52:55], v[28:31], v[228:231]
    v_mfma_f32_16x16x32_bf16 v[232:235], v[52:55], v[32:35], v[232:235]
    s_waitcnt lgkmcnt(2)
    v_mfma_f32_16x16x32_bf16 v[236:239], v[56:59], v[20:23], v[236:239]
    ds_read_b64_tr_b16 v[64:65], v12 offset:20512
    v_mfma_f32_16x16x32_bf16 v[240:243], v[56:59], v[24:27], v[240:243]
    ds_read_b64_tr_b16 v[66:67], v12 offset:21792
    v_mfma_f32_16x16x32_bf16 v[244:247], v[56:59], v[28:31], v[244:247]
    v_mfma_f32_16x16x32_bf16 v[248:251], v[56:59], v[32:35], v[248:251]
    s_barrier
    s_waitcnt lgkmcnt(2)
    v_mfma_f32_16x16x32_bf16 v[92:95], v[60:63], v[36:39], v[92:95]
    ds_read_b64_tr_b16 v[52:53], v11 offset:20544
    v_mfma_f32_16x16x32_bf16 v[96:99], v[60:63], v[40:43], v[96:99]
    ds_read_b64_tr_b16 v[54:55], v11 offset:21824
    v_mfma_f32_16x16x32_bf16 v[100:103], v[60:63], v[44:47], v[100:103]
    v_mfma_f32_16x16x32_bf16 v[104:107], v[60:63], v[48:51], v[104:107]
    s_waitcnt lgkmcnt(2)
    v_mfma_f32_16x16x32_bf16 v[108:111], v[64:67], v[36:39], v[108:111]
    ds_read_b64_tr_b16 v[56:57], v12 offset:20576
    v_mfma_f32_16x16x32_bf16 v[112:115], v[64:67], v[40:43], v[112:115]
    ds_read_b64_tr_b16 v[58:59], v12 offset:21856
    v_mfma_f32_16x16x32_bf16 v[116:119], v[64:67], v[44:47], v[116:119]
    ds_read_b128 v[20:23], v6 offset:16384
    v_mfma_f32_16x16x32_bf16 v[120:123], v[64:67], v[48:51], v[120:123]
    v_smfmac_f32_16x16x64_bf16 v[72:75], v[68:71], v[60:67], v0
    s_waitcnt lgkmcnt(3)
    v_mfma_f32_16x16x32_bf16 v[124:127], v[52:55], v[36:39], v[124:127]
    ds_read_b64_tr_b16 v[88:89], v2 offset:20608
    v_mfma_f32_16x16x32_bf16 v[128:131], v[52:55], v[40:43], v[128:131]
    ds_read_b64_tr_b16 v[90:91], v2 offset:21888
    v_mfma_f32_16x16x32_bf16 v[132:135], v[52:55], v[44:47], v[132:135]
    ds_read_b128 v[24:27], v6 offset:18432
    v_mfma_f32_16x16x32_bf16 v[136:139], v[52:55], v[48:51], v[136:139]
    s_waitcnt lgkmcnt(4)
    v_mfma_f32_16x16x32_bf16 v[140:143], v[56:59], v[36:39], v[140:143]
    ds_read_b64_tr_b16 v[64:65], v15 offset:20480
    v_mfma_f32_16x16x32_bf16 v[144:147], v[56:59], v[40:43], v[144:147]
    ds_read_b64_tr_b16 v[66:67], v15 offset:21760
    v_mfma_f32_16x16x32_bf16 v[148:151], v[56:59], v[44:47], v[148:151]
    ds_read_b128 v[28:31], v6 offset:20480
    v_mfma_f32_16x16x32_bf16 v[152:155], v[56:59], v[48:51], v[152:155]
    v_smfmac_f32_16x16x64_bf16 v[76:79], v[68:71], v[52:59], v0
    s_waitcnt lgkmcnt(4)
    v_mfma_f32_16x16x32_bf16 v[156:159], v[88:91], v[36:39], v[156:159]
    ds_read_b64_tr_b16 v[52:53], v16 offset:20512
    v_mfma_f32_16x16x32_bf16 v[160:163], v[88:91], v[40:43], v[160:163]
    ds_read_b64_tr_b16 v[54:55], v16 offset:21792
    v_mfma_f32_16x16x32_bf16 v[164:167], v[88:91], v[44:47], v[164:167]
    ds_read_b128 v[32:35], v6 offset:22528
    v_mfma_f32_16x16x32_bf16 v[168:171], v[88:91], v[48:51], v[168:171]
    v_smfmac_f32_16x16x64_bf16 v[80:83], v[68:71], v[84:91], v0
    s_waitcnt lgkmcnt(4)
    v_mfma_f32_16x16x32_bf16 v[172:175], v[64:67], v[36:39], v[172:175]
    ds_read_b64_tr_b16 v[56:57], v15 offset:20544
    v_mfma_f32_16x16x32_bf16 v[176:179], v[64:67], v[40:43], v[176:179]
    ds_read_b64_tr_b16 v[58:59], v15 offset:21824
    v_mfma_f32_16x16x32_bf16 v[180:183], v[64:67], v[44:47], v[180:183]
    v_mfma_f32_16x16x32_bf16 v[184:187], v[64:67], v[48:51], v[184:187]
    s_waitcnt lgkmcnt(3)
    v_mfma_f32_16x16x32_bf16 v[188:191], v[52:55], v[36:39], v[188:191]
    ds_read_b64_tr_b16 v[60:61], v16 offset:20576
    v_mfma_f32_16x16x32_bf16 v[192:195], v[52:55], v[40:43], v[192:195]
    ds_read_b64_tr_b16 v[62:63], v16 offset:21856
    v_mfma_f32_16x16x32_bf16 v[196:199], v[52:55], v[44:47], v[196:199]
    v_mfma_f32_16x16x32_bf16 v[200:203], v[52:55], v[48:51], v[200:203]
    s_waitcnt lgkmcnt(2)
    v_mfma_f32_16x16x32_bf16 v[204:207], v[56:59], v[36:39], v[204:207]
    ds_read_b64_tr_b16 v[64:65], v5 offset:20608
    v_mfma_f32_16x16x32_bf16 v[208:211], v[56:59], v[40:43], v[208:211]
    ds_read_b64_tr_b16 v[66:67], v5 offset:21888
    v_mfma_f32_16x16x32_bf16 v[212:215], v[56:59], v[44:47], v[212:215]
    v_mfma_f32_16x16x32_bf16 v[216:219], v[56:59], v[48:51], v[216:219]
    s_waitcnt lgkmcnt(2)
    v_mfma_f32_16x16x32_bf16 v[220:223], v[60:63], v[36:39], v[220:223]
    ds_read_b64_tr_b16 v[52:53], v11 offset:40960
    v_mfma_f32_16x16x32_bf16 v[224:227], v[60:63], v[40:43], v[224:227]
    ds_read_b64_tr_b16 v[54:55], v11 offset:42240
    v_mfma_f32_16x16x32_bf16 v[228:231], v[60:63], v[44:47], v[228:231]
    v_mfma_f32_16x16x32_bf16 v[232:235], v[60:63], v[48:51], v[232:235]
    s_waitcnt lgkmcnt(2)
    v_mfma_f32_16x16x32_bf16 v[236:239], v[64:67], v[36:39], v[236:239]
    ds_read_b64_tr_b16 v[56:57], v12 offset:40992
    v_mfma_f32_16x16x32_bf16 v[240:243], v[64:67], v[40:43], v[240:243]
    ds_read_b64_tr_b16 v[58:59], v12 offset:42272
    v_mfma_f32_16x16x32_bf16 v[244:247], v[64:67], v[44:47], v[244:247]
    v_mfma_f32_16x16x32_bf16 v[248:251], v[64:67], v[48:51], v[248:251]
    s_barrier
    s_waitcnt lgkmcnt(2)
    v_mfma_f32_16x16x32_bf16 v[92:95], v[52:55], v[20:23], v[92:95]
    ds_read_b64_tr_b16 v[60:61], v11 offset:41024
    v_mfma_f32_16x16x32_bf16 v[96:99], v[52:55], v[24:27], v[96:99]
    ds_read_b64_tr_b16 v[62:63], v11 offset:42304
    v_mfma_f32_16x16x32_bf16 v[100:103], v[52:55], v[28:31], v[100:103]
    v_mfma_f32_16x16x32_bf16 v[104:107], v[52:55], v[32:35], v[104:107]
    s_waitcnt lgkmcnt(2)
    v_mfma_f32_16x16x32_bf16 v[108:111], v[56:59], v[20:23], v[108:111]
    ds_read_b64_tr_b16 v[64:65], v12 offset:41056
    v_mfma_f32_16x16x32_bf16 v[112:115], v[56:59], v[24:27], v[112:115]
    ds_read_b64_tr_b16 v[66:67], v12 offset:42336
    v_mfma_f32_16x16x32_bf16 v[116:119], v[56:59], v[28:31], v[116:119]
    ds_read_b128 v[36:39], v254 offset:16384
    v_mfma_f32_16x16x32_bf16 v[120:123], v[56:59], v[32:35], v[120:123]
    v_smfmac_f32_16x16x64_bf16 v[72:75], v[68:71], v[52:59], v0
    s_waitcnt lgkmcnt(3)
    v_mfma_f32_16x16x32_bf16 v[124:127], v[60:63], v[20:23], v[124:127]
    ds_read_b64_tr_b16 v[84:85], v2 offset:41088
    v_mfma_f32_16x16x32_bf16 v[128:131], v[60:63], v[24:27], v[128:131]
    ds_read_b64_tr_b16 v[86:87], v2 offset:42368
    v_mfma_f32_16x16x32_bf16 v[132:135], v[60:63], v[28:31], v[132:135]
    ds_read_b128 v[40:43], v254 offset:18432
    v_mfma_f32_16x16x32_bf16 v[136:139], v[60:63], v[32:35], v[136:139]
    s_waitcnt lgkmcnt(4)
    v_mfma_f32_16x16x32_bf16 v[140:143], v[64:67], v[20:23], v[140:143]
    ds_read_b64_tr_b16 v[56:57], v15 offset:40960
    v_mfma_f32_16x16x32_bf16 v[144:147], v[64:67], v[24:27], v[144:147]
    ds_read_b64_tr_b16 v[58:59], v15 offset:42240
    v_mfma_f32_16x16x32_bf16 v[148:151], v[64:67], v[28:31], v[148:151]
    ds_read_b128 v[44:47], v254 offset:20480
    v_mfma_f32_16x16x32_bf16 v[152:155], v[64:67], v[32:35], v[152:155]
    v_smfmac_f32_16x16x64_bf16 v[76:79], v[68:71], v[60:67], v0
    s_waitcnt lgkmcnt(4)
    v_mfma_f32_16x16x32_bf16 v[156:159], v[84:87], v[20:23], v[156:159]
    ds_read_b64_tr_b16 v[60:61], v16 offset:40992
    v_mfma_f32_16x16x32_bf16 v[160:163], v[84:87], v[24:27], v[160:163]
    ds_read_b64_tr_b16 v[62:63], v16 offset:42272
    v_mfma_f32_16x16x32_bf16 v[164:167], v[84:87], v[28:31], v[164:167]
    ds_read_b128 v[48:51], v254 offset:22528
    v_mfma_f32_16x16x32_bf16 v[168:171], v[84:87], v[32:35], v[168:171]
    s_waitcnt lgkmcnt(4)
    v_mfma_f32_16x16x32_bf16 v[172:175], v[56:59], v[20:23], v[172:175]
    ds_read_b64_tr_b16 v[64:65], v15 offset:41024
    v_mfma_f32_16x16x32_bf16 v[176:179], v[56:59], v[24:27], v[176:179]
    ds_read_b64_tr_b16 v[66:67], v15 offset:42304
    v_mfma_f32_16x16x32_bf16 v[180:183], v[56:59], v[28:31], v[180:183]
    v_mfma_f32_16x16x32_bf16 v[184:187], v[56:59], v[32:35], v[184:187]
    s_waitcnt lgkmcnt(3)
    v_mfma_f32_16x16x32_bf16 v[188:191], v[60:63], v[20:23], v[188:191]
    ds_read_b64_tr_b16 v[52:53], v16 offset:41056
    v_mfma_f32_16x16x32_bf16 v[192:195], v[60:63], v[24:27], v[192:195]
    ds_read_b64_tr_b16 v[54:55], v16 offset:42336
    v_mfma_f32_16x16x32_bf16 v[196:199], v[60:63], v[28:31], v[196:199]
    v_mfma_f32_16x16x32_bf16 v[200:203], v[60:63], v[32:35], v[200:203]
    s_waitcnt lgkmcnt(2)
    v_mfma_f32_16x16x32_bf16 v[204:207], v[64:67], v[20:23], v[204:207]
    ds_read_b64_tr_b16 v[56:57], v5 offset:41088
    v_mfma_f32_16x16x32_bf16 v[208:211], v[64:67], v[24:27], v[208:211]
    ds_read_b64_tr_b16 v[58:59], v5 offset:42368
    v_mfma_f32_16x16x32_bf16 v[212:215], v[64:67], v[28:31], v[212:215]
    v_mfma_f32_16x16x32_bf16 v[216:219], v[64:67], v[32:35], v[216:219]
    s_waitcnt lgkmcnt(2)
    v_mfma_f32_16x16x32_bf16 v[220:223], v[52:55], v[20:23], v[220:223]
    ds_read_b64_tr_b16 v[60:61], v13 offset:0
    v_mfma_f32_16x16x32_bf16 v[224:227], v[52:55], v[24:27], v[224:227]
    ds_read_b64_tr_b16 v[62:63], v13 offset:1280
    v_mfma_f32_16x16x32_bf16 v[228:231], v[52:55], v[28:31], v[228:231]
    v_mfma_f32_16x16x32_bf16 v[232:235], v[52:55], v[32:35], v[232:235]
    s_waitcnt lgkmcnt(2)
    v_mfma_f32_16x16x32_bf16 v[236:239], v[56:59], v[20:23], v[236:239]
    ds_read_b64_tr_b16 v[64:65], v14 offset:32
    v_mfma_f32_16x16x32_bf16 v[240:243], v[56:59], v[24:27], v[240:243]
    ds_read_b64_tr_b16 v[66:67], v14 offset:1312
    v_mfma_f32_16x16x32_bf16 v[244:247], v[56:59], v[28:31], v[244:247]
    v_mfma_f32_16x16x32_bf16 v[248:251], v[56:59], v[32:35], v[248:251]
    s_barrier
    s_waitcnt lgkmcnt(2)
    v_mfma_f32_16x16x32_bf16 v[92:95], v[60:63], v[36:39], v[92:95]
    ds_read_b64_tr_b16 v[52:53], v13 offset:64
    v_mfma_f32_16x16x32_bf16 v[96:99], v[60:63], v[40:43], v[96:99]
    ds_read_b64_tr_b16 v[54:55], v13 offset:1344
    v_mfma_f32_16x16x32_bf16 v[100:103], v[60:63], v[44:47], v[100:103]
    v_mfma_f32_16x16x32_bf16 v[104:107], v[60:63], v[48:51], v[104:107]
    s_waitcnt lgkmcnt(2)
    v_mfma_f32_16x16x32_bf16 v[108:111], v[64:67], v[36:39], v[108:111]
    ds_read_b64_tr_b16 v[56:57], v14 offset:96
    v_mfma_f32_16x16x32_bf16 v[112:115], v[64:67], v[40:43], v[112:115]
    ds_read_b64_tr_b16 v[58:59], v14 offset:1376
    v_mfma_f32_16x16x32_bf16 v[116:119], v[64:67], v[44:47], v[116:119]
    ds_read_b128 v[20:23], v6 offset:0
    v_mfma_f32_16x16x32_bf16 v[120:123], v[64:67], v[48:51], v[120:123]
    v_smfmac_f32_16x16x64_bf16 v[72:75], v[68:71], v[60:67], v0
    s_waitcnt lgkmcnt(3)
    v_mfma_f32_16x16x32_bf16 v[124:127], v[52:55], v[36:39], v[124:127]
    ds_read_b64_tr_b16 v[88:89], v3 offset:128
    v_mfma_f32_16x16x32_bf16 v[128:131], v[52:55], v[40:43], v[128:131]
    ds_read_b64_tr_b16 v[90:91], v3 offset:1408
    v_mfma_f32_16x16x32_bf16 v[132:135], v[52:55], v[44:47], v[132:135]
    ds_read_b128 v[24:27], v6 offset:2048
    v_mfma_f32_16x16x32_bf16 v[136:139], v[52:55], v[48:51], v[136:139]
    s_waitcnt lgkmcnt(4)
    v_mfma_f32_16x16x32_bf16 v[140:143], v[56:59], v[36:39], v[140:143]
    ds_read_b64_tr_b16 v[64:65], v17 offset:0
    v_mfma_f32_16x16x32_bf16 v[144:147], v[56:59], v[40:43], v[144:147]
    ds_read_b64_tr_b16 v[66:67], v17 offset:1280
    v_mfma_f32_16x16x32_bf16 v[148:151], v[56:59], v[44:47], v[148:151]
    ds_read_b128 v[28:31], v6 offset:4096
    v_mfma_f32_16x16x32_bf16 v[152:155], v[56:59], v[48:51], v[152:155]
    v_smfmac_f32_16x16x64_bf16 v[76:79], v[68:71], v[52:59], v0
    s_waitcnt lgkmcnt(4)
    v_mfma_f32_16x16x32_bf16 v[156:159], v[88:91], v[36:39], v[156:159]
    ds_read_b64_tr_b16 v[52:53], v18 offset:32
    v_mfma_f32_16x16x32_bf16 v[160:163], v[88:91], v[40:43], v[160:163]
    ds_read_b64_tr_b16 v[54:55], v18 offset:1312
    v_mfma_f32_16x16x32_bf16 v[164:167], v[88:91], v[44:47], v[164:167]
    ds_read_b128 v[32:35], v6 offset:6144
    v_mfma_f32_16x16x32_bf16 v[168:171], v[88:91], v[48:51], v[168:171]
    v_smfmac_f32_16x16x64_bf16 v[80:83], v[68:71], v[84:91], v0
    s_waitcnt lgkmcnt(4)
    v_mfma_f32_16x16x32_bf16 v[172:175], v[64:67], v[36:39], v[172:175]
    ds_read_b64_tr_b16 v[56:57], v17 offset:64
    v_mfma_f32_16x16x32_bf16 v[176:179], v[64:67], v[40:43], v[176:179]
    ds_read_b64_tr_b16 v[58:59], v17 offset:1344
    v_mfma_f32_16x16x32_bf16 v[180:183], v[64:67], v[44:47], v[180:183]
    v_mfma_f32_16x16x32_bf16 v[184:187], v[64:67], v[48:51], v[184:187]
    s_waitcnt lgkmcnt(3)
    v_mfma_f32_16x16x32_bf16 v[188:191], v[52:55], v[36:39], v[188:191]
    ds_read_b64_tr_b16 v[60:61], v18 offset:96
    v_mfma_f32_16x16x32_bf16 v[192:195], v[52:55], v[40:43], v[192:195]
    ds_read_b64_tr_b16 v[62:63], v18 offset:1376
    v_mfma_f32_16x16x32_bf16 v[196:199], v[52:55], v[44:47], v[196:199]
    v_mfma_f32_16x16x32_bf16 v[200:203], v[52:55], v[48:51], v[200:203]
    s_waitcnt lgkmcnt(2)
    v_mfma_f32_16x16x32_bf16 v[204:207], v[56:59], v[36:39], v[204:207]
    ds_read_b64_tr_b16 v[64:65], v252 offset:128
    v_mfma_f32_16x16x32_bf16 v[208:211], v[56:59], v[40:43], v[208:211]
    ds_read_b64_tr_b16 v[66:67], v252 offset:1408
    v_mfma_f32_16x16x32_bf16 v[212:215], v[56:59], v[44:47], v[212:215]
    v_mfma_f32_16x16x32_bf16 v[216:219], v[56:59], v[48:51], v[216:219]
    s_waitcnt lgkmcnt(2)
    v_mfma_f32_16x16x32_bf16 v[220:223], v[60:63], v[36:39], v[220:223]
    ds_read_b64_tr_b16 v[52:53], v13 offset:20480
    v_mfma_f32_16x16x32_bf16 v[224:227], v[60:63], v[40:43], v[224:227]
    ds_read_b64_tr_b16 v[54:55], v13 offset:21760
    v_mfma_f32_16x16x32_bf16 v[228:231], v[60:63], v[44:47], v[228:231]
    v_mfma_f32_16x16x32_bf16 v[232:235], v[60:63], v[48:51], v[232:235]
    s_waitcnt lgkmcnt(2)
    v_mfma_f32_16x16x32_bf16 v[236:239], v[64:67], v[36:39], v[236:239]
    ds_read_b64_tr_b16 v[56:57], v14 offset:20512
    v_mfma_f32_16x16x32_bf16 v[240:243], v[64:67], v[40:43], v[240:243]
    ds_read_b64_tr_b16 v[58:59], v14 offset:21792
    v_mfma_f32_16x16x32_bf16 v[244:247], v[64:67], v[44:47], v[244:247]
    v_mfma_f32_16x16x32_bf16 v[248:251], v[64:67], v[48:51], v[248:251]
    s_barrier
    s_waitcnt lgkmcnt(2)
    v_mfma_f32_16x16x32_bf16 v[92:95], v[52:55], v[20:23], v[92:95]
    ds_read_b64_tr_b16 v[60:61], v13 offset:20544
    v_mfma_f32_16x16x32_bf16 v[96:99], v[52:55], v[24:27], v[96:99]
    ds_read_b64_tr_b16 v[62:63], v13 offset:21824
    v_mfma_f32_16x16x32_bf16 v[100:103], v[52:55], v[28:31], v[100:103]
    v_mfma_f32_16x16x32_bf16 v[104:107], v[52:55], v[32:35], v[104:107]
    s_waitcnt lgkmcnt(2)
    v_mfma_f32_16x16x32_bf16 v[108:111], v[56:59], v[20:23], v[108:111]
    ds_read_b64_tr_b16 v[64:65], v14 offset:20576
    v_mfma_f32_16x16x32_bf16 v[112:115], v[56:59], v[24:27], v[112:115]
    ds_read_b64_tr_b16 v[66:67], v14 offset:21856
    v_mfma_f32_16x16x32_bf16 v[116:119], v[56:59], v[28:31], v[116:119]
    ds_read_b128 v[36:39], v254 offset:0
    v_mfma_f32_16x16x32_bf16 v[120:123], v[56:59], v[32:35], v[120:123]
    v_smfmac_f32_16x16x64_bf16 v[72:75], v[68:71], v[52:59], v0
    s_waitcnt lgkmcnt(3)
    v_mfma_f32_16x16x32_bf16 v[124:127], v[60:63], v[20:23], v[124:127]
    ds_read_b64_tr_b16 v[84:85], v3 offset:20608
    v_mfma_f32_16x16x32_bf16 v[128:131], v[60:63], v[24:27], v[128:131]
    ds_read_b64_tr_b16 v[86:87], v3 offset:21888
    v_mfma_f32_16x16x32_bf16 v[132:135], v[60:63], v[28:31], v[132:135]
    ds_read_b128 v[40:43], v254 offset:2048
    v_mfma_f32_16x16x32_bf16 v[136:139], v[60:63], v[32:35], v[136:139]
    s_waitcnt lgkmcnt(4)
    v_mfma_f32_16x16x32_bf16 v[140:143], v[64:67], v[20:23], v[140:143]
    ds_read_b64_tr_b16 v[56:57], v17 offset:20480
    v_mfma_f32_16x16x32_bf16 v[144:147], v[64:67], v[24:27], v[144:147]
    ds_read_b64_tr_b16 v[58:59], v17 offset:21760
    v_mfma_f32_16x16x32_bf16 v[148:151], v[64:67], v[28:31], v[148:151]
    ds_read_b128 v[44:47], v254 offset:4096
    v_mfma_f32_16x16x32_bf16 v[152:155], v[64:67], v[32:35], v[152:155]
    v_smfmac_f32_16x16x64_bf16 v[76:79], v[68:71], v[60:67], v0
    s_waitcnt lgkmcnt(4)
    v_mfma_f32_16x16x32_bf16 v[156:159], v[84:87], v[20:23], v[156:159]
    ds_read_b64_tr_b16 v[60:61], v18 offset:20512
    v_mfma_f32_16x16x32_bf16 v[160:163], v[84:87], v[24:27], v[160:163]
    ds_read_b64_tr_b16 v[62:63], v18 offset:21792
    v_mfma_f32_16x16x32_bf16 v[164:167], v[84:87], v[28:31], v[164:167]
    ds_read_b128 v[48:51], v254 offset:6144
    v_mfma_f32_16x16x32_bf16 v[168:171], v[84:87], v[32:35], v[168:171]
    s_waitcnt lgkmcnt(4)
    v_mfma_f32_16x16x32_bf16 v[172:175], v[56:59], v[20:23], v[172:175]
    ds_read_b64_tr_b16 v[64:65], v17 offset:20544
    v_mfma_f32_16x16x32_bf16 v[176:179], v[56:59], v[24:27], v[176:179]
    ds_read_b64_tr_b16 v[66:67], v17 offset:21824
    v_mfma_f32_16x16x32_bf16 v[180:183], v[56:59], v[28:31], v[180:183]
    v_mfma_f32_16x16x32_bf16 v[184:187], v[56:59], v[32:35], v[184:187]
    s_waitcnt lgkmcnt(3)
    v_mfma_f32_16x16x32_bf16 v[188:191], v[60:63], v[20:23], v[188:191]
    ds_read_b64_tr_b16 v[52:53], v18 offset:20576
    v_mfma_f32_16x16x32_bf16 v[192:195], v[60:63], v[24:27], v[192:195]
    ds_read_b64_tr_b16 v[54:55], v18 offset:21856
    v_mfma_f32_16x16x32_bf16 v[196:199], v[60:63], v[28:31], v[196:199]
    v_mfma_f32_16x16x32_bf16 v[200:203], v[60:63], v[32:35], v[200:203]
    s_waitcnt lgkmcnt(2)
    v_mfma_f32_16x16x32_bf16 v[204:207], v[64:67], v[20:23], v[204:207]
    ds_read_b64_tr_b16 v[56:57], v252 offset:20608
    v_mfma_f32_16x16x32_bf16 v[208:211], v[64:67], v[24:27], v[208:211]
    ds_read_b64_tr_b16 v[58:59], v252 offset:21888
    v_mfma_f32_16x16x32_bf16 v[212:215], v[64:67], v[28:31], v[212:215]
    v_mfma_f32_16x16x32_bf16 v[216:219], v[64:67], v[32:35], v[216:219]
    s_waitcnt lgkmcnt(2)
    v_mfma_f32_16x16x32_bf16 v[220:223], v[52:55], v[20:23], v[220:223]
    ds_read_b64_tr_b16 v[60:61], v13 offset:40960
    v_mfma_f32_16x16x32_bf16 v[224:227], v[52:55], v[24:27], v[224:227]
    ds_read_b64_tr_b16 v[62:63], v13 offset:42240
    v_mfma_f32_16x16x32_bf16 v[228:231], v[52:55], v[28:31], v[228:231]
    v_mfma_f32_16x16x32_bf16 v[232:235], v[52:55], v[32:35], v[232:235]
    s_waitcnt lgkmcnt(2)
    v_mfma_f32_16x16x32_bf16 v[236:239], v[56:59], v[20:23], v[236:239]
    ds_read_b64_tr_b16 v[64:65], v14 offset:40992
    v_mfma_f32_16x16x32_bf16 v[240:243], v[56:59], v[24:27], v[240:243]
    ds_read_b64_tr_b16 v[66:67], v14 offset:42272
    v_mfma_f32_16x16x32_bf16 v[244:247], v[56:59], v[28:31], v[244:247]
    v_mfma_f32_16x16x32_bf16 v[248:251], v[56:59], v[32:35], v[248:251]
    s_barrier
    s_waitcnt lgkmcnt(2)
    v_mfma_f32_16x16x32_bf16 v[92:95], v[60:63], v[36:39], v[92:95]
    ds_read_b64_tr_b16 v[52:53], v13 offset:41024
    v_mfma_f32_16x16x32_bf16 v[96:99], v[60:63], v[40:43], v[96:99]
    ds_read_b64_tr_b16 v[54:55], v13 offset:42304
    v_mfma_f32_16x16x32_bf16 v[100:103], v[60:63], v[44:47], v[100:103]
    v_mfma_f32_16x16x32_bf16 v[104:107], v[60:63], v[48:51], v[104:107]
    s_waitcnt lgkmcnt(2)
    v_mfma_f32_16x16x32_bf16 v[108:111], v[64:67], v[36:39], v[108:111]
    ds_read_b64_tr_b16 v[56:57], v14 offset:41056
    v_mfma_f32_16x16x32_bf16 v[112:115], v[64:67], v[40:43], v[112:115]
    ds_read_b64_tr_b16 v[58:59], v14 offset:42336
    v_mfma_f32_16x16x32_bf16 v[116:119], v[64:67], v[44:47], v[116:119]
    ds_read_b128 v[20:23], v6 offset:16384
    v_mfma_f32_16x16x32_bf16 v[120:123], v[64:67], v[48:51], v[120:123]
    v_smfmac_f32_16x16x64_bf16 v[72:75], v[68:71], v[60:67], v0
    s_waitcnt lgkmcnt(3)
    v_mfma_f32_16x16x32_bf16 v[124:127], v[52:55], v[36:39], v[124:127]
    ds_read_b64_tr_b16 v[88:89], v3 offset:41088
    v_mfma_f32_16x16x32_bf16 v[128:131], v[52:55], v[40:43], v[128:131]
    ds_read_b64_tr_b16 v[90:91], v3 offset:42368
    v_mfma_f32_16x16x32_bf16 v[132:135], v[52:55], v[44:47], v[132:135]
    ds_read_b128 v[24:27], v6 offset:18432
    v_mfma_f32_16x16x32_bf16 v[136:139], v[52:55], v[48:51], v[136:139]
    s_waitcnt lgkmcnt(4)
    v_mfma_f32_16x16x32_bf16 v[140:143], v[56:59], v[36:39], v[140:143]
    ds_read_b64_tr_b16 v[64:65], v17 offset:40960
    v_mfma_f32_16x16x32_bf16 v[144:147], v[56:59], v[40:43], v[144:147]
    ds_read_b64_tr_b16 v[66:67], v17 offset:42240
    v_mfma_f32_16x16x32_bf16 v[148:151], v[56:59], v[44:47], v[148:151]
    ds_read_b128 v[28:31], v6 offset:20480
    v_mfma_f32_16x16x32_bf16 v[152:155], v[56:59], v[48:51], v[152:155]
    v_smfmac_f32_16x16x64_bf16 v[76:79], v[68:71], v[52:59], v0
    s_waitcnt lgkmcnt(4)
    v_mfma_f32_16x16x32_bf16 v[156:159], v[88:91], v[36:39], v[156:159]
    ds_read_b64_tr_b16 v[52:53], v18 offset:40992
    v_mfma_f32_16x16x32_bf16 v[160:163], v[88:91], v[40:43], v[160:163]
    ds_read_b64_tr_b16 v[54:55], v18 offset:42272
    v_mfma_f32_16x16x32_bf16 v[164:167], v[88:91], v[44:47], v[164:167]
    ds_read_b128 v[32:35], v6 offset:22528
    v_mfma_f32_16x16x32_bf16 v[168:171], v[88:91], v[48:51], v[168:171]
    v_smfmac_f32_16x16x64_bf16 v[80:83], v[68:71], v[84:91], v0
    s_waitcnt lgkmcnt(4)
    v_mfma_f32_16x16x32_bf16 v[172:175], v[64:67], v[36:39], v[172:175]
    ds_read_b64_tr_b16 v[56:57], v17 offset:41024
    v_mfma_f32_16x16x32_bf16 v[176:179], v[64:67], v[40:43], v[176:179]
    ds_read_b64_tr_b16 v[58:59], v17 offset:42304
    v_mfma_f32_16x16x32_bf16 v[180:183], v[64:67], v[44:47], v[180:183]
    v_mfma_f32_16x16x32_bf16 v[184:187], v[64:67], v[48:51], v[184:187]
    s_waitcnt lgkmcnt(3)
    v_mfma_f32_16x16x32_bf16 v[188:191], v[52:55], v[36:39], v[188:191]
    ds_read_b64_tr_b16 v[60:61], v18 offset:41056
    v_mfma_f32_16x16x32_bf16 v[192:195], v[52:55], v[40:43], v[192:195]
    ds_read_b64_tr_b16 v[62:63], v18 offset:42336
    v_mfma_f32_16x16x32_bf16 v[196:199], v[52:55], v[44:47], v[196:199]
    v_mfma_f32_16x16x32_bf16 v[200:203], v[52:55], v[48:51], v[200:203]
    s_waitcnt lgkmcnt(2)
    v_mfma_f32_16x16x32_bf16 v[204:207], v[56:59], v[36:39], v[204:207]
    ds_read_b64_tr_b16 v[64:65], v252 offset:41088
    v_mfma_f32_16x16x32_bf16 v[208:211], v[56:59], v[40:43], v[208:211]
    ds_read_b64_tr_b16 v[66:67], v252 offset:42368
    v_mfma_f32_16x16x32_bf16 v[212:215], v[56:59], v[44:47], v[212:215]
    v_mfma_f32_16x16x32_bf16 v[216:219], v[56:59], v[48:51], v[216:219]
    s_waitcnt lgkmcnt(2)
    v_mfma_f32_16x16x32_bf16 v[220:223], v[60:63], v[36:39], v[220:223]
    ds_read_b64_tr_b16 v[52:53], v11 offset:0
    v_mfma_f32_16x16x32_bf16 v[224:227], v[60:63], v[40:43], v[224:227]
    ds_read_b64_tr_b16 v[54:55], v11 offset:1280
    v_mfma_f32_16x16x32_bf16 v[228:231], v[60:63], v[44:47], v[228:231]
    v_mfma_f32_16x16x32_bf16 v[232:235], v[60:63], v[48:51], v[232:235]
    s_waitcnt lgkmcnt(2)
    v_mfma_f32_16x16x32_bf16 v[236:239], v[64:67], v[36:39], v[236:239]
    ds_read_b64_tr_b16 v[56:57], v12 offset:32
    v_mfma_f32_16x16x32_bf16 v[240:243], v[64:67], v[40:43], v[240:243]
    ds_read_b64_tr_b16 v[58:59], v12 offset:1312
    v_mfma_f32_16x16x32_bf16 v[244:247], v[64:67], v[44:47], v[244:247]
    v_mfma_f32_16x16x32_bf16 v[248:251], v[64:67], v[48:51], v[248:251]
    s_barrier
    s_waitcnt lgkmcnt(2)
    v_mfma_f32_16x16x32_bf16 v[92:95], v[52:55], v[20:23], v[92:95]
    ds_read_b64_tr_b16 v[60:61], v11 offset:64
    v_mfma_f32_16x16x32_bf16 v[96:99], v[52:55], v[24:27], v[96:99]
    ds_read_b64_tr_b16 v[62:63], v11 offset:1344
    v_mfma_f32_16x16x32_bf16 v[100:103], v[52:55], v[28:31], v[100:103]
    v_mfma_f32_16x16x32_bf16 v[104:107], v[52:55], v[32:35], v[104:107]
    s_waitcnt lgkmcnt(2)
    v_mfma_f32_16x16x32_bf16 v[108:111], v[56:59], v[20:23], v[108:111]
    ds_read_b64_tr_b16 v[64:65], v12 offset:96
    v_mfma_f32_16x16x32_bf16 v[112:115], v[56:59], v[24:27], v[112:115]
    ds_read_b64_tr_b16 v[66:67], v12 offset:1376
    v_mfma_f32_16x16x32_bf16 v[116:119], v[56:59], v[28:31], v[116:119]
    ds_read_b128 v[36:39], v254 offset:16384
    v_mfma_f32_16x16x32_bf16 v[120:123], v[56:59], v[32:35], v[120:123]
    v_smfmac_f32_16x16x64_bf16 v[72:75], v[68:71], v[52:59], v0
    s_waitcnt lgkmcnt(3)
    v_mfma_f32_16x16x32_bf16 v[124:127], v[60:63], v[20:23], v[124:127]
    ds_read_b64_tr_b16 v[84:85], v2 offset:128
    v_mfma_f32_16x16x32_bf16 v[128:131], v[60:63], v[24:27], v[128:131]
    ds_read_b64_tr_b16 v[86:87], v2 offset:1408
    v_mfma_f32_16x16x32_bf16 v[132:135], v[60:63], v[28:31], v[132:135]
    ds_read_b128 v[40:43], v254 offset:18432
    v_mfma_f32_16x16x32_bf16 v[136:139], v[60:63], v[32:35], v[136:139]
    s_waitcnt lgkmcnt(4)
PGS_g_2:
    s_cbranch_execz PGS_g_3
    v_mfma_f32_16x16x32_bf16 v[140:143], v[64:67], v[20:23], v[140:143]
    ds_read_b64_tr_b16 v[56:57], v15 offset:0
    v_mfma_f32_16x16x32_bf16 v[144:147], v[64:67], v[24:27], v[144:147]
    ds_read_b64_tr_b16 v[58:59], v15 offset:1280
    v_mfma_f32_16x16x32_bf16 v[148:151], v[64:67], v[28:31], v[148:151]
    ds_read_b128 v[44:47], v254 offset:20480
    v_mfma_f32_16x16x32_bf16 v[152:155], v[64:67], v[32:35], v[152:155]
    v_smfmac_f32_16x16x64_bf16 v[76:79], v[68:71], v[60:67], v0
    s_waitcnt lgkmcnt(4)
    v_mfma_f32_16x16x32_bf16 v[156:159], v[84:87], v[20:23], v[156:159]
    ds_read_b64_tr_b16 v[60:61], v16 offset:32
    v_mfma_f32_16x16x32_bf16 v[160:163], v[84:87], v[24:27], v[160:163]
    ds_read_b64_tr_b16 v[62:63], v16 offset:1312
    v_mfma_f32_16x16x32_bf16 v[164:167], v[84:87], v[28:31], v[164:167]
    ds_read_b128 v[48:51], v254 offset:22528
    v_mfma_f32_16x16x32_bf16 v[168:171], v[84:87], v[32:35], v[168:171]
    s_waitcnt lgkmcnt(4)
    v_mfma_f32_16x16x32_bf16 v[172:175], v[56:59], v[20:23], v[172:175]
    ds_read_b64_tr_b16 v[64:65], v15 offset:64
    v_mfma_f32_16x16x32_bf16 v[176:179], v[56:59], v[24:27], v[176:179]
    ds_read_b64_tr_b16 v[66:67], v15 offset:1344
    v_mfma_f32_16x16x32_bf16 v[180:183], v[56:59], v[28:31], v[180:183]
    v_mfma_f32_16x16x32_bf16 v[184:187], v[56:59], v[32:35], v[184:187]
    s_waitcnt lgkmcnt(3)
    v_mfma_f32_16x16x32_bf16 v[188:191], v[60:63], v[20:23], v[188:191]
    ds_read_b64_tr_b16 v[52:53], v16 offset:96
    v_mfma_f32_16x16x32_bf16 v[192:195], v[60:63], v[24:27], v[192:195]
    ds_read_b64_tr_b16 v[54:55], v16 offset:1376
    v_mfma_f32_16x16x32_bf16 v[196:199], v[60:63], v[28:31], v[196:199]
    v_mfma_f32_16x16x32_bf16 v[200:203], v[60:63], v[32:35], v[200:203]
    s_waitcnt lgkmcnt(2)
    v_mfma_f32_16x16x32_bf16 v[204:207], v[64:67], v[20:23], v[204:207]
    ds_read_b64_tr_b16 v[56:57], v5 offset:128
    v_mfma_f32_16x16x32_bf16 v[208:211], v[64:67], v[24:27], v[208:211]
    ds_read_b64_tr_b16 v[58:59], v5 offset:1408
    v_mfma_f32_16x16x32_bf16 v[212:215], v[64:67], v[28:31], v[212:215]
    v_mfma_f32_16x16x32_bf16 v[216:219], v[64:67], v[32:35], v[216:219]
    s_waitcnt lgkmcnt(2)
    v_mfma_f32_16x16x32_bf16 v[220:223], v[52:55], v[20:23], v[220:223]
    ds_read_b64_tr_b16 v[60:61], v11 offset:20480
    v_mfma_f32_16x16x32_bf16 v[224:227], v[52:55], v[24:27], v[224:227]
    ds_read_b64_tr_b16 v[62:63], v11 offset:21760
    v_mfma_f32_16x16x32_bf16 v[228:231], v[52:55], v[28:31], v[228:231]
    v_mfma_f32_16x16x32_bf16 v[232:235], v[52:55], v[32:35], v[232:235]
    s_waitcnt lgkmcnt(2)
    v_mfma_f32_16x16x32_bf16 v[236:239], v[56:59], v[20:23], v[236:239]
    ds_read_b64_tr_b16 v[64:65], v12 offset:20512
    v_mfma_f32_16x16x32_bf16 v[240:243], v[56:59], v[24:27], v[240:243]
    ds_read_b64_tr_b16 v[66:67], v12 offset:21792
    v_mfma_f32_16x16x32_bf16 v[244:247], v[56:59], v[28:31], v[244:247]
    v_mfma_f32_16x16x32_bf16 v[248:251], v[56:59], v[32:35], v[248:251]
    s_waitcnt lgkmcnt(2)
    v_mfma_f32_16x16x32_bf16 v[92:95], v[60:63], v[36:39], v[92:95]
    ds_read_b64_tr_b16 v[52:53], v11 offset:20544
    v_mfma_f32_16x16x32_bf16 v[96:99], v[60:63], v[40:43], v[96:99]
    ds_read_b64_tr_b16 v[54:55], v11 offset:21824
    v_mfma_f32_16x16x32_bf16 v[100:103], v[60:63], v[44:47], v[100:103]
    v_mfma_f32_16x16x32_bf16 v[104:107], v[60:63], v[48:51], v[104:107]
    s_waitcnt lgkmcnt(2)
    v_mfma_f32_16x16x32_bf16 v[108:111], v[64:67], v[36:39], v[108:111]
    ds_read_b64_tr_b16 v[56:57], v12 offset:20576
    v_mfma_f32_16x16x32_bf16 v[112:115], v[64:67], v[40:43], v[112:115]
    ds_read_b64_tr_b16 v[58:59], v12 offset:21856
    v_mfma_f32_16x16x32_bf16 v[116:119], v[64:67], v[44:47], v[116:119]
    v_mfma_f32_16x16x32_bf16 v[120:123], v[64:67], v[48:51], v[120:123]
    v_smfmac_f32_16x16x64_bf16 v[72:75], v[68:71], v[60:67], v0
    s_waitcnt lgkmcnt(2)
    v_mfma_f32_16x16x32_bf16 v[124:127], v[52:55], v[36:39], v[124:127]
    ds_read_b64_tr_b16 v[88:89], v2 offset:20608
    v_mfma_f32_16x16x32_bf16 v[128:131], v[52:55], v[40:43], v[128:131]
    ds_read_b64_tr_b16 v[90:91], v2 offset:21888
    v_mfma_f32_16x16x32_bf16 v[132:135], v[52:55], v[44:47], v[132:135]
    v_mfma_f32_16x16x32_bf16 v[136:139], v[52:55], v[48:51], v[136:139]
    s_waitcnt lgkmcnt(2)
    v_mfma_f32_16x16x32_bf16 v[140:143], v[56:59], v[36:39], v[140:143]
    ds_read_b64_tr_b16 v[64:65], v15 offset:20480
    v_mfma_f32_16x16x32_bf16 v[144:147], v[56:59], v[40:43], v[144:147]
    ds_read_b64_tr_b16 v[66:67], v15 offset:21760
    v_mfma_f32_16x16x32_bf16 v[148:151], v[56:59], v[44:47], v[148:151]
    v_mfma_f32_16x16x32_bf16 v[152:155], v[56:59], v[48:51], v[152:155]
    v_smfmac_f32_16x16x64_bf16 v[76:79], v[68:71], v[52:59], v0
    s_waitcnt lgkmcnt(2)
    v_mfma_f32_16x16x32_bf16 v[156:159], v[88:91], v[36:39], v[156:159]
    ds_read_b64_tr_b16 v[52:53], v16 offset:20512
    v_mfma_f32_16x16x32_bf16 v[160:163], v[88:91], v[40:43], v[160:163]
    ds_read_b64_tr_b16 v[54:55], v16 offset:21792
    v_mfma_f32_16x16x32_bf16 v[164:167], v[88:91], v[44:47], v[164:167]
    v_mfma_f32_16x16x32_bf16 v[168:171], v[88:91], v[48:51], v[168:171]
    v_smfmac_f32_16x16x64_bf16 v[80:83], v[68:71], v[84:91], v0
    s_waitcnt lgkmcnt(2)
    v_mfma_f32_16x16x32_bf16 v[172:175], v[64:67], v[36:39], v[172:175]
    ds_read_b64_tr_b16 v[56:57], v15 offset:20544
    v_mfma_f32_16x16x32_bf16 v[176:179], v[64:67], v[40:43], v[176:179]
    ds_read_b64_tr_b16 v[58:59], v15 offset:21824
    v_mfma_f32_16x16x32_bf16 v[180:183], v[64:67], v[44:47], v[180:183]
    v_mfma_f32_16x16x32_bf16 v[184:187], v[64:67], v[48:51], v[184:187]
    s_waitcnt lgkmcnt(2)
    v_mfma_f32_16x16x32_bf16 v[188:191], v[52:55], v[36:39], v[188:191]
    ds_read_b64_tr_b16 v[60:61], v16 offset:20576
    v_and_b32 v20, 15, v1
    s_mul_i32 s30, s3, 320
    v_mfma_f32_16x16x32_bf16 v[192:195], v[52:55], v[40:43], v[192:195]
    ds_read_b64_tr_b16 v[62:63], v16 offset:21856
    s_add_u32 s30, s30, 156672
    v_add_f32 v72, v72, v73
    v_mfma_f32_16x16x32_bf16 v[196:199], v[52:55], v[44:47], v[196:199]
    v_add_f32 v74, v74, v75
    v_lshl_add_u32 v20, v20, 2, s30
    v_mfma_f32_16x16x32_bf16 v[200:203], v[52:55], v[48:51], v[200:203]
    s_waitcnt lgkmcnt(2)
    v_mfma_f32_16x16x32_bf16 v[204:207], v[56:59], v[36:39], v[204:207]
    ds_read_b64_tr_b16 v[64:65], v5 offset:20608
    v_add_f32 v76, v76, v77
    v_add_f32 v78, v78, v79
    v_mfma_f32_16x16x32_bf16 v[208:211], v[56:59], v[40:43], v[208:211]
    ds_read_b64_tr_b16 v[66:67], v5 offset:21888
    v_add_f32 v80, v80, v81
    v_add_f32 v82, v82, v83
    v_mfma_f32_16x16x32_bf16 v[212:215], v[56:59], v[44:47], v[212:215]
    v_add_f32 v80, v80, v82
    v_mfma_f32_16x16x32_bf16 v[216:219], v[56:59], v[48:51], v[216:219]
    s_waitcnt lgkmcnt(2)
    v_mfma_f32_16x16x32_bf16 v[220:223], v[60:63], v[36:39], v[220:223]
    s_mov_b64 exec, 0xffff
    ds_write2_b32 v20, v72, v74 offset0:0 offset1:16
    s_mov_b64 exec, -1
    v_mfma_f32_16x16x32_bf16 v[224:227], v[60:63], v[40:43], v[224:227]
    s_mov_b64 exec, 0xffff
    ds_write2_b32 v20, v76, v78 offset0:32 offset1:48
    s_mov_b64 exec, -1
    v_mfma_f32_16x16x32_bf16 v[228:231], v[60:63], v[44:47], v[228:231]
    s_mov_b64 exec, 0xffff
    ds_write_b32 v20, v80 offset:256
    s_mov_b64 exec, -1
    v_mfma_f32_16x16x32_bf16 v[232:235], v[60:63], v[48:51], v[232:235]
    s_waitcnt lgkmcnt(3)
    v_mfma_f32_16x16x32_bf16 v[236:239], v[64:67], v[36:39], v[236:239]
    v_mfma_f32_16x16x32_bf16 v[240:243], v[64:67], v[40:43], v[240:243]
    v_mfma_f32_16x16x32_bf16 v[244:247], v[64:67], v[44:47], v[244:247]
    v_mfma_f32_16x16x32_bf16 v[248:251], v[64:67], v[48:51], v[248:251]
    s_lshr_b32 s34, s25, 5
    s_lshl_b32 s34, s34, 10
    s_waitcnt lgkmcnt(0)
    s_barrier
    ds_read_b64 v[40:41], v7 offset:0
    ds_read_b64 v[42:43], v7 offset:128
    ds_read_b64 v[44:45], v7 offset:256
    ds_read_b64 v[46:47], v7 offset:384
    ds_read_b128 v[20:23], v10 offset:0
    ds_read_b128 v[72:75], v8 offset:0
    ds_read_b128 v[24:27], v10 offset:64
    ds_read_b128 v[76:79], v8 offset:64
    ds_read_b128 v[28:31], v10 offset:128
    ds_read_b128 v[80:83], v8 offset:128
    ds_read_b128 v[32:35], v10 offset:192
    ds_read_b128 v[84:87], v8 offset:192
    ds_read_b128 v[36:39], v10 offset:256
    ds_read_b128 v[88:91], v8 offset:256
    s_waitcnt lgkmcnt(0)
    v_lshlrev_b32 v5, 3, v1
    v_sub_u32 v5, v9, v5
    s_mul_i32 s35, s33, 3072
    v_add_u32 v9, s35, v9
    s_lshl_b32 s35, s33, 9
    v_add_u32 v5, s35, v5
    s_add_u32 s35, s34, 0
    s_add_u32 s36, s34, 4096
    v_pk_fma_f32 v[92:93], v[72:73], v[40:41], v[92:93] op_sel:[0,1,0] op_sel_hi:[1,1,1]
    v_pk_fma_f32 v[94:95], v[74:75], v[40:41], v[94:95] op_sel:[0,1,0] op_sel_hi:[1,1,1]
    v_pk_fma_f32 v[172:173], v[20:21], v[40:41], v[172:173] op_sel:[0,1,0] op_sel_hi:[1,1,1]
    v_pk_fma_f32 v[174:175], v[22:23], v[40:41], v[174:175] op_sel:[0,1,0] op_sel_hi:[1,1,1]
    v_pk_mul_f32 v[92:93], v[92:93], v[40:41] op_sel:[0,0] op_sel_hi:[1,0]
    v_pk_mul_f32 v[94:95], v[94:95], v[40:41] op_sel:[0,0] op_sel_hi:[1,0]
    v_pk_mul_f32 v[172:173], v[172:173], v[40:41] op_sel:[0,0] op_sel_hi:[1,0]
    v_pk_mul_f32 v[174:175], v[174:175], v[40:41] op_sel:[0,0] op_sel_hi:[1,0]
    v_cvt_pk_bf16_f32 v92, 0, v92
    v_cvt_pk_bf16_f32 v93, 0, v93
    v_cvt_pk_bf16_f32 v94, 0, v94
    v_cvt_pk_bf16_f32 v95, 0, v95
    v_cvt_pk_bf16_f32 v172, 0, v172
    v_cvt_pk_bf16_f32 v173, 0, v173
    v_cvt_pk_bf16_f32 v174, 0, v174
    v_cvt_pk_bf16_f32 v175, 0, v175
    v_pk_mul_f32 v[92:93], v[92:93], v[172:173]
    v_pk_mul_f32 v[94:95], v[94:95], v[174:175]
    v_cvt_pk_bf16_f32 v52, v92, v93
    v_cvt_pk_bf16_f32 v53, v94, v95
    v_pk_fma_f32 v[108:109], v[76:77], v[40:41], v[108:109] op_sel:[0,1,0] op_sel_hi:[1,1,1]
    v_pk_fma_f32 v[110:111], v[78:79], v[40:41], v[110:111] op_sel:[0,1,0] op_sel_hi:[1,1,1]
    v_pk_fma_f32 v[188:189], v[24:25], v[40:41], v[188:189] op_sel:[0,1,0] op_sel_hi:[1,1,1]
    v_pk_fma_f32 v[190:191], v[26:27], v[40:41], v[190:191] op_sel:[0,1,0] op_sel_hi:[1,1,1]
    v_pk_mul_f32 v[108:109], v[108:109], v[40:41] op_sel:[0,0] op_sel_hi:[1,0]
    v_pk_mul_f32 v[110:111], v[110:111], v[40:41] op_sel:[0,0] op_sel_hi:[1,0]
    v_pk_mul_f32 v[188:189], v[188:189], v[40:41] op_sel:[0,0] op_sel_hi:[1,0]
    v_pk_mul_f32 v[190:191], v[190:191], v[40:41] op_sel:[0,0] op_sel_hi:[1,0]
    v_cvt_pk_bf16_f32 v108, 0, v108
    v_cvt_pk_bf16_f32 v109, 0, v109
    v_cvt_pk_bf16_f32 v110, 0, v110
    v_cvt_pk_bf16_f32 v111, 0, v111
    v_cvt_pk_bf16_f32 v188, 0, v188
    v_cvt_pk_bf16_f32 v189, 0, v189
    v_cvt_pk_bf16_f32 v190, 0, v190
    v_cvt_pk_bf16_f32 v191, 0, v191
    v_pk_mul_f32 v[108:109], v[108:109], v[188:189]
    v_pk_mul_f32 v[110:111], v[110:111], v[190:191]
    v_cvt_pk_bf16_f32 v54, v108, v109
    v_cvt_pk_bf16_f32 v55, v110, v111
    buffer_store_dwordx4 v[52:55], v9, s[20:23], s35 offen offset:0 sc1
    v_pk_fma_f32 v[124:125], v[80:81], v[40:41], v[124:125] op_sel:[0,1,0] op_sel_hi:[1,1,1]
    v_pk_fma_f32 v[126:127], v[82:83], v[40:41], v[126:127] op_sel:[0,1,0] op_sel_hi:[1,1,1]
    v_pk_fma_f32 v[204:205], v[28:29], v[40:41], v[204:205] op_sel:[0,1,0] op_sel_hi:[1,1,1]
    v_pk_fma_f32 v[206:207], v[30:31], v[40:41], v[206:207] op_sel:[0,1,0] op_sel_hi:[1,1,1]
    v_pk_mul_f32 v[124:125], v[124:125], v[40:41] op_sel:[0,0] op_sel_hi:[1,0]
    v_pk_mul_f32 v[126:127], v[126:127], v[40:41] op_sel:[0,0] op_sel_hi:[1,0]
    v_pk_mul_f32 v[204:205], v[204:205], v[40:41] op_sel:[0,0] op_sel_hi:[1,0]
    v_pk_mul_f32 v[206:207], v[206:207], v[40:41] op_sel:[0,0] op_sel_hi:[1,0]
    v_cvt_pk_bf16_f32 v124, 0, v124
    v_cvt_pk_bf16_f32 v125, 0, v125
    v_cvt_pk_bf16_f32 v126, 0, v126
    v_cvt_pk_bf16_f32 v127, 0, v127
    v_cvt_pk_bf16_f32 v204, 0, v204
    v_cvt_pk_bf16_f32 v205, 0, v205
    v_cvt_pk_bf16_f32 v206, 0, v206
    v_cvt_pk_bf16_f32 v207, 0, v207
    v_pk_mul_f32 v[124:125], v[124:125], v[204:205]
    v_pk_mul_f32 v[126:127], v[126:127], v[206:207]
    v_cvt_pk_bf16_f32 v56, v124, v125
    v_cvt_pk_bf16_f32 v57, v126, v127
    v_pk_fma_f32 v[140:141], v[84:85], v[40:41], v[140:141] op_sel:[0,1,0] op_sel_hi:[1,1,1]
    v_pk_fma_f32 v[142:143], v[86:87], v[40:41], v[142:143] op_sel:[0,1,0] op_sel_hi:[1,1,1]
    v_pk_fma_f32 v[220:221], v[32:33], v[40:41], v[220:221] op_sel:[0,1,0] op_sel_hi:[1,1,1]
    v_pk_fma_f32 v[222:223], v[34:35], v[40:41], v[222:223] op_sel:[0,1,0] op_sel_hi:[1,1,1]
    v_pk_mul_f32 v[140:141], v[140:141], v[40:41] op_sel:[0,0] op_sel_hi:[1,0]
    v_pk_mul_f32 v[142:143], v[142:143], v[40:41] op_sel:[0,0] op_sel_hi:[1,0]
    v_pk_mul_f32 v[220:221], v[220:221], v[40:41] op_sel:[0,0] op_sel_hi:[1,0]
    v_pk_mul_f32 v[222:223], v[222:223], v[40:41] op_sel:[0,0] op_sel_hi:[1,0]
    v_cvt_pk_bf16_f32 v140, 0, v140
    v_cvt_pk_bf16_f32 v141, 0, v141
    v_cvt_pk_bf16_f32 v142, 0, v142
    v_cvt_pk_bf16_f32 v143, 0, v143
    v_cvt_pk_bf16_f32 v220, 0, v220
    v_cvt_pk_bf16_f32 v221, 0, v221
    v_cvt_pk_bf16_f32 v222, 0, v222
    v_cvt_pk_bf16_f32 v223, 0, v223
    v_pk_mul_f32 v[140:141], v[140:141], v[220:221]
    v_pk_mul_f32 v[142:143], v[142:143], v[222:223]
    v_cvt_pk_bf16_f32 v58, v140, v141
    v_cvt_pk_bf16_f32 v59, v142, v143
    buffer_store_dwordx4 v[56:59], v9, s[20:23], s35 offen offset:1024 sc1
    v_pk_fma_f32 v[156:157], v[88:89], v[40:41], v[156:157] op_sel:[0,1,0] op_sel_hi:[1,1,1]
    v_pk_fma_f32 v[158:159], v[90:91], v[40:41], v[158:159] op_sel:[0,1,0] op_sel_hi:[1,1,1]
    v_pk_fma_f32 v[236:237], v[36:37], v[40:41], v[236:237] op_sel:[0,1,0] op_sel_hi:[1,1,1]
    v_pk_fma_f32 v[238:239], v[38:39], v[40:41], v[238:239] op_sel:[0,1,0] op_sel_hi:[1,1,1]
    v_pk_mul_f32 v[156:157], v[156:157], v[40:41] op_sel:[0,0] op_sel_hi:[1,0]
    v_pk_mul_f32 v[158:159], v[158:159], v[40:41] op_sel:[0,0] op_sel_hi:[1,0]
    v_pk_mul_f32 v[236:237], v[236:237], v[40:41] op_sel:[0,0] op_sel_hi:[1,0]
    v_pk_mul_f32 v[238:239], v[238:239], v[40:41] op_sel:[0,0] op_sel_hi:[1,0]
    v_cvt_pk_bf16_f32 v156, 0, v156
    v_cvt_pk_bf16_f32 v157, 0, v157
    v_cvt_pk_bf16_f32 v158, 0, v158
    v_cvt_pk_bf16_f32 v159, 0, v159
    v_cvt_pk_bf16_f32 v236, 0, v236
    v_cvt_pk_bf16_f32 v237, 0, v237
    v_cvt_pk_bf16_f32 v238, 0, v238
    v_cvt_pk_bf16_f32 v239, 0, v239
    v_pk_mul_f32 v[156:157], v[156:157], v[236:237]
    v_pk_mul_f32 v[158:159], v[158:159], v[238:239]
    v_cvt_pk_bf16_f32 v60, v156, v157
    v_cvt_pk_bf16_f32 v61, v158, v159
    buffer_store_dwordx2 v[60:61], v5, s[20:23], s35 offen offset:2048 sc1
    s_add_u32 s35, s34, 55296
    s_add_u32 s36, s34, 59392
    v_pk_fma_f32 v[96:97], v[72:73], v[42:43], v[96:97] op_sel:[0,1,0] op_sel_hi:[1,1,1]
    v_pk_fma_f32 v[98:99], v[74:75], v[42:43], v[98:99] op_sel:[0,1,0] op_sel_hi:[1,1,1]
    v_pk_fma_f32 v[176:177], v[20:21], v[42:43], v[176:177] op_sel:[0,1,0] op_sel_hi:[1,1,1]
    v_pk_fma_f32 v[178:179], v[22:23], v[42:43], v[178:179] op_sel:[0,1,0] op_sel_hi:[1,1,1]
    v_pk_mul_f32 v[96:97], v[96:97], v[42:43] op_sel:[0,0] op_sel_hi:[1,0]
    v_pk_mul_f32 v[98:99], v[98:99], v[42:43] op_sel:[0,0] op_sel_hi:[1,0]
    v_pk_mul_f32 v[176:177], v[176:177], v[42:43] op_sel:[0,0] op_sel_hi:[1,0]
    v_pk_mul_f32 v[178:179], v[178:179], v[42:43] op_sel:[0,0] op_sel_hi:[1,0]
    v_cvt_pk_bf16_f32 v96, 0, v96
    v_cvt_pk_bf16_f32 v97, 0, v97
    v_cvt_pk_bf16_f32 v98, 0, v98
    v_cvt_pk_bf16_f32 v99, 0, v99
    v_cvt_pk_bf16_f32 v176, 0, v176
    v_cvt_pk_bf16_f32 v177, 0, v177
    v_cvt_pk_bf16_f32 v178, 0, v178
    v_cvt_pk_bf16_f32 v179, 0, v179
    v_pk_mul_f32 v[96:97], v[96:97], v[176:177]
    v_pk_mul_f32 v[98:99], v[98:99], v[178:179]
    v_cvt_pk_bf16_f32 v64, v96, v97
    v_cvt_pk_bf16_f32 v65, v98, v99
    v_pk_fma_f32 v[112:113], v[76:77], v[42:43], v[112:113] op_sel:[0,1,0] op_sel_hi:[1,1,1]
    v_pk_fma_f32 v[114:115], v[78:79], v[42:43], v[114:115] op_sel:[0,1,0] op_sel_hi:[1,1,1]
    v_pk_fma_f32 v[192:193], v[24:25], v[42:43], v[192:193] op_sel:[0,1,0] op_sel_hi:[1,1,1]
    v_pk_fma_f32 v[194:195], v[26:27], v[42:43], v[194:195] op_sel:[0,1,0] op_sel_hi:[1,1,1]
    v_pk_mul_f32 v[112:113], v[112:113], v[42:43] op_sel:[0,0] op_sel_hi:[1,0]
    v_pk_mul_f32 v[114:115], v[114:115], v[42:43] op_sel:[0,0] op_sel_hi:[1,0]
    v_pk_mul_f32 v[192:193], v[192:193], v[42:43] op_sel:[0,0] op_sel_hi:[1,0]
    v_pk_mul_f32 v[194:195], v[194:195], v[42:43] op_sel:[0,0] op_sel_hi:[1,0]
    v_cvt_pk_bf16_f32 v112, 0, v112
    v_cvt_pk_bf16_f32 v113, 0, v113
    v_cvt_pk_bf16_f32 v114, 0, v114
    v_cvt_pk_bf16_f32 v115, 0, v115
    v_cvt_pk_bf16_f32 v192, 0, v192
    v_cvt_pk_bf16_f32 v193, 0, v193
    v_cvt_pk_bf16_f32 v194, 0, v194
    v_cvt_pk_bf16_f32 v195, 0, v195
    v_pk_mul_f32 v[112:113], v[112:113], v[192:193]
    v_pk_mul_f32 v[114:115], v[114:115], v[194:195]
    v_cvt_pk_bf16_f32 v66, v112, v113
    v_cvt_pk_bf16_f32 v67, v114, v115
    buffer_store_dwordx4 v[64:67], v9, s[20:23], s35 offen offset:0 sc1
    v_pk_fma_f32 v[128:129], v[80:81], v[42:43], v[128:129] op_sel:[0,1,0] op_sel_hi:[1,1,1]
    v_pk_fma_f32 v[130:131], v[82:83], v[42:43], v[130:131] op_sel:[0,1,0] op_sel_hi:[1,1,1]
    v_pk_fma_f32 v[208:209], v[28:29], v[42:43], v[208:209] op_sel:[0,1,0] op_sel_hi:[1,1,1]
    v_pk_fma_f32 v[210:211], v[30:31], v[42:43], v[210:211] op_sel:[0,1,0] op_sel_hi:[1,1,1]
    v_pk_mul_f32 v[128:129], v[128:129], v[42:43] op_sel:[0,0] op_sel_hi:[1,0]
    v_pk_mul_f32 v[130:131], v[130:131], v[42:43] op_sel:[0,0] op_sel_hi:[1,0]
    v_pk_mul_f32 v[208:209], v[208:209], v[42:43] op_sel:[0,0] op_sel_hi:[1,0]
    v_pk_mul_f32 v[210:211], v[210:211], v[42:43] op_sel:[0,0] op_sel_hi:[1,0]
    v_cvt_pk_bf16_f32 v128, 0, v128
    v_cvt_pk_bf16_f32 v129, 0, v129
    v_cvt_pk_bf16_f32 v130, 0, v130
    v_cvt_pk_bf16_f32 v131, 0, v131
    v_cvt_pk_bf16_f32 v208, 0, v208
    v_cvt_pk_bf16_f32 v209, 0, v209
    v_cvt_pk_bf16_f32 v210, 0, v210
    v_cvt_pk_bf16_f32 v211, 0, v211
    v_pk_mul_f32 v[128:129], v[128:129], v[208:209]
    v_pk_mul_f32 v[130:131], v[130:131], v[210:211]
    v_cvt_pk_bf16_f32 v48, v128, v129
    v_cvt_pk_bf16_f32 v49, v130, v131
    v_pk_fma_f32 v[144:145], v[84:85], v[42:43], v[144:145] op_sel:[0,1,0] op_sel_hi:[1,1,1]
    v_pk_fma_f32 v[146:147], v[86:87], v[42:43], v[146:147] op_sel:[0,1,0] op_sel_hi:[1,1,1]
    v_pk_fma_f32 v[224:225], v[32:33], v[42:43], v[224:225] op_sel:[0,1,0] op_sel_hi:[1,1,1]
    v_pk_fma_f32 v[226:227], v[34:35], v[42:43], v[226:227] op_sel:[0,1,0] op_sel_hi:[1,1,1]
    v_pk_mul_f32 v[144:145], v[144:145], v[42:43] op_sel:[0,0] op_sel_hi:[1,0]
    v_pk_mul_f32 v[146:147], v[146:147], v[42:43] op_sel:[0,0] op_sel_hi:[1,0]
    v_pk_mul_f32 v[224:225], v[224:225], v[42:43] op_sel:[0,0] op_sel_hi:[1,0]
    v_pk_mul_f32 v[226:227], v[226:227], v[42:43] op_sel:[0,0] op_sel_hi:[1,0]
    v_cvt_pk_bf16_f32 v144, 0, v144
    v_cvt_pk_bf16_f32 v145, 0, v145
    v_cvt_pk_bf16_f32 v146, 0, v146
    v_cvt_pk_bf16_f32 v147, 0, v147
    v_cvt_pk_bf16_f32 v224, 0, v224
    v_cvt_pk_bf16_f32 v225, 0, v225
    v_cvt_pk_bf16_f32 v226, 0, v226
    v_cvt_pk_bf16_f32 v227, 0, v227
    v_pk_mul_f32 v[144:145], v[144:145], v[224:225]
    v_pk_mul_f32 v[146:147], v[146:147], v[226:227]
    v_cvt_pk_bf16_f32 v50, v144, v145
    v_cvt_pk_bf16_f32 v51, v146, v147
    buffer_store_dwordx4 v[48:51], v9, s[20:23], s35 offen offset:1024 sc1
    v_pk_fma_f32 v[160:161], v[88:89], v[42:43], v[160:161] op_sel:[0,1,0] op_sel_hi:[1,1,1]
    v_pk_fma_f32 v[162:163], v[90:91], v[42:43], v[162:163] op_sel:[0,1,0] op_sel_hi:[1,1,1]
    v_pk_fma_f32 v[240:241], v[36:37], v[42:43], v[240:241] op_sel:[0,1,0] op_sel_hi:[1,1,1]
    v_pk_fma_f32 v[242:243], v[38:39], v[42:43], v[242:243] op_sel:[0,1,0] op_sel_hi:[1,1,1]
    v_pk_mul_f32 v[160:161], v[160:161], v[42:43] op_sel:[0,0] op_sel_hi:[1,0]
    v_pk_mul_f32 v[162:163], v[162:163], v[42:43] op_sel:[0,0] op_sel_hi:[1,0]
    v_pk_mul_f32 v[240:241], v[240:241], v[42:43] op_sel:[0,0] op_sel_hi:[1,0]
    v_pk_mul_f32 v[242:243], v[242:243], v[42:43] op_sel:[0,0] op_sel_hi:[1,0]
    v_cvt_pk_bf16_f32 v160, 0, v160
    v_cvt_pk_bf16_f32 v161, 0, v161
    v_cvt_pk_bf16_f32 v162, 0, v162
    v_cvt_pk_bf16_f32 v163, 0, v163
    v_cvt_pk_bf16_f32 v240, 0, v240
    v_cvt_pk_bf16_f32 v241, 0, v241
    v_cvt_pk_bf16_f32 v242, 0, v242
    v_cvt_pk_bf16_f32 v243, 0, v243
    v_pk_mul_f32 v[160:161], v[160:161], v[240:241]
    v_pk_mul_f32 v[162:163], v[162:163], v[242:243]
    v_cvt_pk_bf16_f32 v52, v160, v161
    v_cvt_pk_bf16_f32 v53, v162, v163
    buffer_store_dwordx2 v[52:53], v5, s[20:23], s35 offen offset:2048 sc1
    s_add_u32 s35, s34, 110592
    s_add_u32 s36, s34, 114688
    v_pk_fma_f32 v[100:101], v[72:73], v[44:45], v[100:101] op_sel:[0,1,0] op_sel_hi:[1,1,1]
    v_pk_fma_f32 v[102:103], v[74:75], v[44:45], v[102:103] op_sel:[0,1,0] op_sel_hi:[1,1,1]
    v_pk_fma_f32 v[180:181], v[20:21], v[44:45], v[180:181] op_sel:[0,1,0] op_sel_hi:[1,1,1]
    v_pk_fma_f32 v[182:183], v[22:23], v[44:45], v[182:183] op_sel:[0,1,0] op_sel_hi:[1,1,1]
    v_pk_mul_f32 v[100:101], v[100:101], v[44:45] op_sel:[0,0] op_sel_hi:[1,0]
    v_pk_mul_f32 v[102:103], v[102:103], v[44:45] op_sel:[0,0] op_sel_hi:[1,0]
    v_pk_mul_f32 v[180:181], v[180:181], v[44:45] op_sel:[0,0] op_sel_hi:[1,0]
    v_pk_mul_f32 v[182:183], v[182:183], v[44:45] op_sel:[0,0] op_sel_hi:[1,0]
    v_cvt_pk_bf16_f32 v100, 0, v100
    v_cvt_pk_bf16_f32 v101, 0, v101
    v_cvt_pk_bf16_f32 v102, 0, v102
    v_cvt_pk_bf16_f32 v103, 0, v103
    v_cvt_pk_bf16_f32 v180, 0, v180
    v_cvt_pk_bf16_f32 v181, 0, v181
    v_cvt_pk_bf16_f32 v182, 0, v182
    v_cvt_pk_bf16_f32 v183, 0, v183
    v_pk_mul_f32 v[100:101], v[100:101], v[180:181]
    v_pk_mul_f32 v[102:103], v[102:103], v[182:183]
    v_cvt_pk_bf16_f32 v56, v100, v101
    v_cvt_pk_bf16_f32 v57, v102, v103
    v_pk_fma_f32 v[116:117], v[76:77], v[44:45], v[116:117] op_sel:[0,1,0] op_sel_hi:[1,1,1]
    v_pk_fma_f32 v[118:119], v[78:79], v[44:45], v[118:119] op_sel:[0,1,0] op_sel_hi:[1,1,1]
    v_pk_fma_f32 v[196:197], v[24:25], v[44:45], v[196:197] op_sel:[0,1,0] op_sel_hi:[1,1,1]
    v_pk_fma_f32 v[198:199], v[26:27], v[44:45], v[198:199] op_sel:[0,1,0] op_sel_hi:[1,1,1]
    v_pk_mul_f32 v[116:117], v[116:117], v[44:45] op_sel:[0,0] op_sel_hi:[1,0]
    v_pk_mul_f32 v[118:119], v[118:119], v[44:45] op_sel:[0,0] op_sel_hi:[1,0]
    v_pk_mul_f32 v[196:197], v[196:197], v[44:45] op_sel:[0,0] op_sel_hi:[1,0]
    v_pk_mul_f32 v[198:199], v[198:199], v[44:45] op_sel:[0,0] op_sel_hi:[1,0]
    v_cvt_pk_bf16_f32 v116, 0, v116
    v_cvt_pk_bf16_f32 v117, 0, v117
    v_cvt_pk_bf16_f32 v118, 0, v118
    v_cvt_pk_bf16_f32 v119, 0, v119
    v_cvt_pk_bf16_f32 v196, 0, v196
    v_cvt_pk_bf16_f32 v197, 0, v197
    v_cvt_pk_bf16_f32 v198, 0, v198
    v_cvt_pk_bf16_f32 v199, 0, v199
    v_pk_mul_f32 v[116:117], v[116:117], v[196:197]
    v_pk_mul_f32 v[118:119], v[118:119], v[198:199]
    v_cvt_pk_bf16_f32 v58, v116, v117
    v_cvt_pk_bf16_f32 v59, v118, v119
    buffer_store_dwordx4 v[56:59], v9, s[20:23], s35 offen offset:0 sc1
    v_pk_fma_f32 v[132:133], v[80:81], v[44:45], v[132:133] op_sel:[0,1,0] op_sel_hi:[1,1,1]
    v_pk_fma_f32 v[134:135], v[82:83], v[44:45], v[134:135] op_sel:[0,1,0] op_sel_hi:[1,1,1]
    v_pk_fma_f32 v[212:213], v[28:29], v[44:45], v[212:213] op_sel:[0,1,0] op_sel_hi:[1,1,1]
    v_pk_fma_f32 v[214:215], v[30:31], v[44:45], v[214:215] op_sel:[0,1,0] op_sel_hi:[1,1,1]
    v_pk_mul_f32 v[132:133], v[132:133], v[44:45] op_sel:[0,0] op_sel_hi:[1,0]
    v_pk_mul_f32 v[134:135], v[134:135], v[44:45] op_sel:[0,0] op_sel_hi:[1,0]
    v_pk_mul_f32 v[212:213], v[212:213], v[44:45] op_sel:[0,0] op_sel_hi:[1,0]
    v_pk_mul_f32 v[214:215], v[214:215], v[44:45] op_sel:[0,0] op_sel_hi:[1,0]
    v_cvt_pk_bf16_f32 v132, 0, v132
    v_cvt_pk_bf16_f32 v133, 0, v133
    v_cvt_pk_bf16_f32 v134, 0, v134
    v_cvt_pk_bf16_f32 v135, 0, v135
    v_cvt_pk_bf16_f32 v212, 0, v212
    v_cvt_pk_bf16_f32 v213, 0, v213
    v_cvt_pk_bf16_f32 v214, 0, v214
    v_cvt_pk_bf16_f32 v215, 0, v215
    v_pk_mul_f32 v[132:133], v[132:133], v[212:213]
    v_pk_mul_f32 v[134:135], v[134:135], v[214:215]
    v_cvt_pk_bf16_f32 v60, v132, v133
    v_cvt_pk_bf16_f32 v61, v134, v135
    v_pk_fma_f32 v[148:149], v[84:85], v[44:45], v[148:149] op_sel:[0,1,0] op_sel_hi:[1,1,1]
    v_pk_fma_f32 v[150:151], v[86:87], v[44:45], v[150:151] op_sel:[0,1,0] op_sel_hi:[1,1,1]
    v_pk_fma_f32 v[228:229], v[32:33], v[44:45], v[228:229] op_sel:[0,1,0] op_sel_hi:[1,1,1]
    v_pk_fma_f32 v[230:231], v[34:35], v[44:45], v[230:231] op_sel:[0,1,0] op_sel_hi:[1,1,1]
    v_pk_mul_f32 v[148:149], v[148:149], v[44:45] op_sel:[0,0] op_sel_hi:[1,0]
    v_pk_mul_f32 v[150:151], v[150:151], v[44:45] op_sel:[0,0] op_sel_hi:[1,0]
    v_pk_mul_f32 v[228:229], v[228:229], v[44:45] op_sel:[0,0] op_sel_hi:[1,0]
    v_pk_mul_f32 v[230:231], v[230:231], v[44:45] op_sel:[0,0] op_sel_hi:[1,0]
    v_cvt_pk_bf16_f32 v148, 0, v148
    v_cvt_pk_bf16_f32 v149, 0, v149
    v_cvt_pk_bf16_f32 v150, 0, v150
    v_cvt_pk_bf16_f32 v151, 0, v151
    v_cvt_pk_bf16_f32 v228, 0, v228
    v_cvt_pk_bf16_f32 v229, 0, v229
    v_cvt_pk_bf16_f32 v230, 0, v230
    v_cvt_pk_bf16_f32 v231, 0, v231
    v_pk_mul_f32 v[148:149], v[148:149], v[228:229]
    v_pk_mul_f32 v[150:151], v[150:151], v[230:231]
    v_cvt_pk_bf16_f32 v62, v148, v149
    v_cvt_pk_bf16_f32 v63, v150, v151
    buffer_store_dwordx4 v[60:63], v9, s[20:23], s35 offen offset:1024 sc1
    v_pk_fma_f32 v[164:165], v[88:89], v[44:45], v[164:165] op_sel:[0,1,0] op_sel_hi:[1,1,1]
    v_pk_fma_f32 v[166:167], v[90:91], v[44:45], v[166:167] op_sel:[0,1,0] op_sel_hi:[1,1,1]
    v_pk_fma_f32 v[244:245], v[36:37], v[44:45], v[244:245] op_sel:[0,1,0] op_sel_hi:[1,1,1]
    v_pk_fma_f32 v[246:247], v[38:39], v[44:45], v[246:247] op_sel:[0,1,0] op_sel_hi:[1,1,1]
    v_pk_mul_f32 v[164:165], v[164:165], v[44:45] op_sel:[0,0] op_sel_hi:[1,0]
    v_pk_mul_f32 v[166:167], v[166:167], v[44:45] op_sel:[0,0] op_sel_hi:[1,0]
    v_pk_mul_f32 v[244:245], v[244:245], v[44:45] op_sel:[0,0] op_sel_hi:[1,0]
    v_pk_mul_f32 v[246:247], v[246:247], v[44:45] op_sel:[0,0] op_sel_hi:[1,0]
    v_cvt_pk_bf16_f32 v164, 0, v164
    v_cvt_pk_bf16_f32 v165, 0, v165
    v_cvt_pk_bf16_f32 v166, 0, v166
    v_cvt_pk_bf16_f32 v167, 0, v167
    v_cvt_pk_bf16_f32 v244, 0, v244
    v_cvt_pk_bf16_f32 v245, 0, v245
    v_cvt_pk_bf16_f32 v246, 0, v246
    v_cvt_pk_bf16_f32 v247, 0, v247
    v_pk_mul_f32 v[164:165], v[164:165], v[244:245]
    v_pk_mul_f32 v[166:167], v[166:167], v[246:247]
    v_cvt_pk_bf16_f32 v64, v164, v165
    v_cvt_pk_bf16_f32 v65, v166, v167
    buffer_store_dwordx2 v[64:65], v5, s[20:23], s35 offen offset:2048 sc1
    s_add_u32 s35, s34, 165888
    s_add_u32 s36, s34, 169984
    v_pk_fma_f32 v[104:105], v[72:73], v[46:47], v[104:105] op_sel:[0,1,0] op_sel_hi:[1,1,1]
    v_pk_fma_f32 v[106:107], v[74:75], v[46:47], v[106:107] op_sel:[0,1,0] op_sel_hi:[1,1,1]
    v_pk_fma_f32 v[184:185], v[20:21], v[46:47], v[184:185] op_sel:[0,1,0] op_sel_hi:[1,1,1]
    v_pk_fma_f32 v[186:187], v[22:23], v[46:47], v[186:187] op_sel:[0,1,0] op_sel_hi:[1,1,1]
    v_pk_mul_f32 v[104:105], v[104:105], v[46:47] op_sel:[0,0] op_sel_hi:[1,0]
    v_pk_mul_f32 v[106:107], v[106:107], v[46:47] op_sel:[0,0] op_sel_hi:[1,0]
    v_pk_mul_f32 v[184:185], v[184:185], v[46:47] op_sel:[0,0] op_sel_hi:[1,0]
    v_pk_mul_f32 v[186:187], v[186:187], v[46:47] op_sel:[0,0] op_sel_hi:[1,0]
    v_cvt_pk_bf16_f32 v104, 0, v104
    v_cvt_pk_bf16_f32 v105, 0, v105
    v_cvt_pk_bf16_f32 v106, 0, v106
    v_cvt_pk_bf16_f32 v107, 0, v107
    v_cvt_pk_bf16_f32 v184, 0, v184
    v_cvt_pk_bf16_f32 v185, 0, v185
    v_cvt_pk_bf16_f32 v186, 0, v186
    v_cvt_pk_bf16_f32 v187, 0, v187
    v_pk_mul_f32 v[104:105], v[104:105], v[184:185]
    v_pk_mul_f32 v[106:107], v[106:107], v[186:187]
    v_cvt_pk_bf16_f32 v48, v104, v105
    v_cvt_pk_bf16_f32 v49, v106, v107
    v_pk_fma_f32 v[120:121], v[76:77], v[46:47], v[120:121] op_sel:[0,1,0] op_sel_hi:[1,1,1]
    v_pk_fma_f32 v[122:123], v[78:79], v[46:47], v[122:123] op_sel:[0,1,0] op_sel_hi:[1,1,1]
    v_pk_fma_f32 v[200:201], v[24:25], v[46:47], v[200:201] op_sel:[0,1,0] op_sel_hi:[1,1,1]
    v_pk_fma_f32 v[202:203], v[26:27], v[46:47], v[202:203] op_sel:[0,1,0] op_sel_hi:[1,1,1]
    v_pk_mul_f32 v[120:121], v[120:121], v[46:47] op_sel:[0,0] op_sel_hi:[1,0]
    v_pk_mul_f32 v[122:123], v[122:123], v[46:47] op_sel:[0,0] op_sel_hi:[1,0]
    v_pk_mul_f32 v[200:201], v[200:201], v[46:47] op_sel:[0,0] op_sel_hi:[1,0]
    v_pk_mul_f32 v[202:203], v[202:203], v[46:47] op_sel:[0,0] op_sel_hi:[1,0]
    v_cvt_pk_bf16_f32 v120, 0, v120
    v_cvt_pk_bf16_f32 v121, 0, v121
    v_cvt_pk_bf16_f32 v122, 0, v122
    v_cvt_pk_bf16_f32 v123, 0, v123
    v_cvt_pk_bf16_f32 v200, 0, v200
    v_cvt_pk_bf16_f32 v201, 0, v201
    v_cvt_pk_bf16_f32 v202, 0, v202
    v_cvt_pk_bf16_f32 v203, 0, v203
    v_pk_mul_f32 v[120:121], v[120:121], v[200:201]
    v_pk_mul_f32 v[122:123], v[122:123], v[202:203]
    v_cvt_pk_bf16_f32 v50, v120, v121
    v_cvt_pk_bf16_f32 v51, v122, v123
    buffer_store_dwordx4 v[48:51], v9, s[20:23], s35 offen offset:0 sc1
    v_pk_fma_f32 v[136:137], v[80:81], v[46:47], v[136:137] op_sel:[0,1,0] op_sel_hi:[1,1,1]
    v_pk_fma_f32 v[138:139], v[82:83], v[46:47], v[138:139] op_sel:[0,1,0] op_sel_hi:[1,1,1]
    v_pk_fma_f32 v[216:217], v[28:29], v[46:47], v[216:217] op_sel:[0,1,0] op_sel_hi:[1,1,1]
    v_pk_fma_f32 v[218:219], v[30:31], v[46:47], v[218:219] op_sel:[0,1,0] op_sel_hi:[1,1,1]
    v_pk_mul_f32 v[136:137], v[136:137], v[46:47] op_sel:[0,0] op_sel_hi:[1,0]
    v_pk_mul_f32 v[138:139], v[138:139], v[46:47] op_sel:[0,0] op_sel_hi:[1,0]
    v_pk_mul_f32 v[216:217], v[216:217], v[46:47] op_sel:[0,0] op_sel_hi:[1,0]
    v_pk_mul_f32 v[218:219], v[218:219], v[46:47] op_sel:[0,0] op_sel_hi:[1,0]
PGS_g_3:
    s_cbranch_execz PGS_g_4
    v_cvt_pk_bf16_f32 v136, 0, v136
    v_cvt_pk_bf16_f32 v137, 0, v137
    v_cvt_pk_bf16_f32 v138, 0, v138
    v_cvt_pk_bf16_f32 v139, 0, v139
    v_cvt_pk_bf16_f32 v216, 0, v216
    v_cvt_pk_bf16_f32 v217, 0, v217
    v_cvt_pk_bf16_f32 v218, 0, v218
    v_cvt_pk_bf16_f32 v219, 0, v219
    v_pk_mul_f32 v[136:137], v[136:137], v[216:217]
    v_pk_mul_f32 v[138:139], v[138:139], v[218:219]
    v_cvt_pk_bf16_f32 v52, v136, v137
    v_cvt_pk_bf16_f32 v53, v138, v139
    v_pk_fma_f32 v[152:153], v[84:85], v[46:47], v[152:153] op_sel:[0,1,0] op_sel_hi:[1,1,1]
    v_pk_fma_f32 v[154:155], v[86:87], v[46:47], v[154:155] op_sel:[0,1,0] op_sel_hi:[1,1,1]
    v_pk_fma_f32 v[232:233], v[32:33], v[46:47], v[232:233] op_sel:[0,1,0] op_sel_hi:[1,1,1]
    v_pk_fma_f32 v[234:235], v[34:35], v[46:47], v[234:235] op_sel:[0,1,0] op_sel_hi:[1,1,1]
    v_pk_mul_f32 v[152:153], v[152:153], v[46:47] op_sel:[0,0] op_sel_hi:[1,0]
    v_pk_mul_f32 v[154:155], v[154:155], v[46:47] op_sel:[0,0] op_sel_hi:[1,0]
    v_pk_mul_f32 v[232:233], v[232:233], v[46:47] op_sel:[0,0] op_sel_hi:[1,0]
    v_pk_mul_f32 v[234:235], v[234:235], v[46:47] op_sel:[0,0] op_sel_hi:[1,0]
    v_cvt_pk_bf16_f32 v152, 0, v152
    v_cvt_pk_bf16_f32 v153, 0, v153
    v_cvt_pk_bf16_f32 v154, 0, v154
    v_cvt_pk_bf16_f32 v155, 0, v155
    v_cvt_pk_bf16_f32 v232, 0, v232
    v_cvt_pk_bf16_f32 v233, 0, v233
    v_cvt_pk_bf16_f32 v234, 0, v234
    v_cvt_pk_bf16_f32 v235, 0, v235
    v_pk_mul_f32 v[152:153], v[152:153], v[232:233]
    v_pk_mul_f32 v[154:155], v[154:155], v[234:235]
    v_cvt_pk_bf16_f32 v54, v152, v153
    v_cvt_pk_bf16_f32 v55, v154, v155
    buffer_store_dwordx4 v[52:55], v9, s[20:23], s35 offen offset:1024 sc1
    v_pk_fma_f32 v[168:169], v[88:89], v[46:47], v[168:169] op_sel:[0,1,0] op_sel_hi:[1,1,1]
    v_pk_fma_f32 v[170:171], v[90:91], v[46:47], v[170:171] op_sel:[0,1,0] op_sel_hi:[1,1,1]
    v_pk_fma_f32 v[248:249], v[36:37], v[46:47], v[248:249] op_sel:[0,1,0] op_sel_hi:[1,1,1]
    v_pk_fma_f32 v[250:251], v[38:39], v[46:47], v[250:251] op_sel:[0,1,0] op_sel_hi:[1,1,1]
    v_pk_mul_f32 v[168:169], v[168:169], v[46:47] op_sel:[0,0] op_sel_hi:[1,0]
    v_pk_mul_f32 v[170:171], v[170:171], v[46:47] op_sel:[0,0] op_sel_hi:[1,0]
    v_pk_mul_f32 v[248:249], v[248:249], v[46:47] op_sel:[0,0] op_sel_hi:[1,0]
    v_pk_mul_f32 v[250:251], v[250:251], v[46:47] op_sel:[0,0] op_sel_hi:[1,0]
    v_cvt_pk_bf16_f32 v168, 0, v168
    v_cvt_pk_bf16_f32 v169, 0, v169
    v_cvt_pk_bf16_f32 v170, 0, v170
    v_cvt_pk_bf16_f32 v171, 0, v171
    v_cvt_pk_bf16_f32 v248, 0, v248
    v_cvt_pk_bf16_f32 v249, 0, v249
    v_cvt_pk_bf16_f32 v250, 0, v250
    v_cvt_pk_bf16_f32 v251, 0, v251
    v_pk_mul_f32 v[168:169], v[168:169], v[248:249]
    v_pk_mul_f32 v[170:171], v[170:171], v[250:251]
    v_cvt_pk_bf16_f32 v56, v168, v169
    v_cvt_pk_bf16_f32 v57, v170, v171
    buffer_store_dwordx2 v[56:57], v5, s[20:23], s35 offen offset:2048 sc1
    s_endpgm
M_conv:
    s_load_dwordx4 s[16:19], s[0:1], 32
    s_load_dwordx2 s[4:5], s[0:1], 72
    s_load_dwordx4 s[44:47], s[0:1], 8
    s_load_dwordx2 s[48:49], s[0:1], 24
    s_sub_u32 s24, 32, s43
    s_mul_i32 s24, s24, s42
    s_add_u32 s24, s24, s40
    s_sub_u32 s24, s24, s43
    s_lshl_b32 s25, s41, 5
    s_add_u32 s24, s24, s25
    s_lshl_b32 s24, s24, 3
    s_add_u32 s24, s24, s3
M_conv2:
    s_waitcnt lgkmcnt(0)
    s_mov_b32 s8, s16
    s_mov_b32 s9, s17
    s_mov_b32 s10, 0x280000
    s_mov_b32 s11, 0x00020000
    s_sub_u32 s25, s24, s3
    s_lshl_b32 s25, s25, 3
    s_load_dwordx16 s[84:99], s[48:49], s25
    s_mov_b32 s32, s44
    s_mov_b32 s33, s45
    s_mov_b32 s34, 0x280000
    s_mov_b32 s35, 0x00020000
    s_mov_b32 s36, s46
    s_mov_b32 s37, s47
    s_mov_b32 s38, 0x280000
    s_mov_b32 s39, 0x00020000
    s_add_u32 s20, s6, 0x1000000
    s_addc_u32 s21, s7, 0
    s_mov_b32 s22, 0x280000
    s_mov_b32 s23, 0x00020000
    s_lshr_b32 s25, s24, 1
    s_lshl_b32 s25, s25, 2
    s_load_dword s26, s[18:19], s25
    v_and_b32 v1, 63, v0
    s_lshl_b32 s27, s24, 12
    v_lshl_add_u32 v2, v1, 4, s27
    v_subrev_u32 v13, 64, v2
    v_mov_b32 v5, 0x40000000
    v_cmp_gt_u32 vcc, 4, v1
    s_nop 1
    v_cndmask_b32 v4, v13, v5, vcc
    v_add_u32 v6, 16, v13
    v_cmp_gt_u32 vcc, 3, v1
    s_nop 1
    v_cndmask_b32 v6, v6, v5, vcc
    buffer_load_dwordx4 v[32:35], v4, s[8:11], 0 offen
    buffer_load_dwordx4 v[40:43], v2, s[8:11], 0 offen offset:960
    buffer_load_dwordx4 v[64:67], v2, s[8:11], 0 offen offset:1984
    s_mov_b32 exec_hi, 0x1fff
    buffer_load_dwordx4 v[70:73], v2, s[8:11], 0 offen offset:3008
    s_mov_b64 exec, -1
    s_mov_b64 exec, 0x1fffffff
    buffer_load_dwordx4 v[76:79], v2, s[8:11], 0 offen offset:3648
    s_mov_b64 exec, -1
    s_movk_i32 s50, 56
    s_mov_b32 s51, 1327104
    s_cmp_ge_u32 s24, 108
    s_cselect_b32 s50, 64, s50
    s_cselect_b32 s53, 108, 0
    s_cmp_ge_u32 s24, 216
    s_cselect_b32 s50, 0, s50
    s_cselect_b32 s53, 216, s53
    s_cselect_b32 s51, 768, s51
    s_cmp_ge_u32 s24, 344
    s_cselect_b32 s50, 72, s50
    s_cselect_b32 s53, 344, s53
    s_cselect_b32 s51, 0, s51
    s_load_dwordx2 s[12:13], s[0:1], s50
    s_sub_u32 s52, s24, s53
    s_lshl_b32 s52, s52, 6
    v_add_u32 v55, s52, v1
    v_lshlrev_b32 v56, 7, v55
    v_lshrrev_b32 v57, 2, v55
    v_mul_u32_u24 v57, 0x500, v57
    v_and_b32 v55, 3, v55
    v_lshl_add_u32 v57, v55, 7, v57
    s_cmp_eq_u32 s50, 0
    s_cselect_b64 vcc, -1, 0
    s_mov_b32 s14, 2211840
    s_cselect_b32 s14, 2621440, s14
    s_mov_b32 s15, 0x00020000
    v_cndmask_b32 v56, v56, v57, vcc
    v_add_u32 v56, s51, v56
    s_sub_u32 s25, s24, s3
    s_lshl_b32 s25, s25, 1
    v_mul_u32_u24 v50, 5120, v0
    v_add_u32 v50, s25, v50
    s_cmp_eq_u32 s3, 0
    s_cselect_b32 s25, 0x40000000, -3840
    v_add_u32 v51, s25, v50
    v_lshlrev_b32 v52, 2, v0
    v_sub_u32 v52, 2044, v52
    v_lshrrev_b32 v53, 5, v52
    v_mul_u32_u24 v53, 80, v53
    v_and_b32 v52, 31, v52
    v_lshl_add_u32 v52, v52, 1, v53
    v_add_u32 v53, 81920, v52
    s_mov_b32 s29, 448
    s_mul_i32 s28, s3, 20480
    v_mov_b32 v96, 0
    v_mov_b32 v97, 0
    v_mov_b32 v98, 0
    v_mov_b32 v99, 0
    v_lshl_add_u32 v3, v1, 4, s28
    v_lshrrev_b32 v4, 2, v1
    v_mul_u32_u24 v4, 80, v4
    v_and_b32 v5, 3, v1
    v_lshl_add_u32 v4, v5, 4, v4
    v_add_u32 v4, s28, v4
    v_and_b32 v5, 31, v1
    v_lshrrev_b32 v6, 5, v1
    v_and_b32 v7, 3, v5
    v_mul_u32_u24 v7, 3776, v7
    v_lshrrev_b32 v8, 2, v5
    v_lshl_add_u32 v8, v6, 1, v8
    v_lshl_add_u32 v7, v8, 3, v7
    v_add_u32 v7, 5120, v7
    v_add_u32 v7, s28, v7
    v_add_u32 v14, 2560, v7
    v_sub_u32 v8, 63, v5
    v_mul_u32_u24 v8, 80, v8
    v_lshl_add_u32 v8, v6, 4, v8
    v_add_u32 v8, s28, v8
    v_mov_b32 v15, v8
    v_subrev_u32 v9, 2560, v8
    v_add_u32 v10, 5120, v3
    s_mov_b32 s30, 0xfffff
    s_mov_b32 s31, 0xfffff
    v_mov_b32 v58, 20472
    ds_write_b64 v58, v[96:97]
    s_lshr_b32 s54, s3, 2
    s_lshl_b32 s54, s54, 2
    v_add_u32 v59, s54, v58
    v_mov_b32 v60, 1
    s_waitcnt lgkmcnt(0)
    s_cmp_lt_u32 s3, 4
    s_barrier
    s_cbranch_scc1 CV_b0
    s_mov_b64 exec, 0
    s_branch PGS_c_0
PGR_c:
    s_mov_b64 exec, -1
    s_waitcnt vmcnt(3)
    v_readlane_b32 s50, v40, 0
    v_readlane_b32 s51, v41, 0
    v_mov_b32_dpp v36, v32 wave_shl:1 row_mask:0xf bank_mask:0xf
    v_mov_b32_dpp v37, v33 wave_shl:1 row_mask:0xf bank_mask:0xf
    v_writelane_b32 v36, s50, 63
    v_writelane_b32 v37, s51, 63
    ds_write_b128 v10, v[34:37] offset:11328
    v_alignbit_b32 v196, v33, v32, 16
    v_alignbit_b32 v197, v34, v33, 16
    v_alignbit_b32 v198, v35, v34, 16
    v_alignbit_b32 v199, v36, v35, 16
    ds_write_b128 v10, v[196:199] offset:0
    v_mov_b32 v214, v33
    v_mov_b32 v215, v34
    v_mov_b32 v216, v35
    v_mov_b32 v217, v36
    ds_write_b128 v10, v[214:217] offset:3776
    v_alignbit_b32 v206, v34, v33, 16
    v_alignbit_b32 v207, v35, v34, 16
    v_alignbit_b32 v208, v36, v35, 16
    v_alignbit_b32 v209, v37, v36, 16
    ds_write_b128 v10, v[206:209] offset:7552
    s_waitcnt vmcnt(2)
    v_readlane_b32 s50, v64, 0
    v_readlane_b32 s51, v65, 0
    v_mov_b32_dpp v44, v40 wave_shl:1 row_mask:0xf bank_mask:0xf
    v_mov_b32_dpp v45, v41 wave_shl:1 row_mask:0xf bank_mask:0xf
    v_writelane_b32 v44, s50, 63
    v_writelane_b32 v45, s51, 63
    ds_write_b128 v10, v[42:45] offset:12352
    v_alignbit_b32 v16, v41, v40, 16
    v_alignbit_b32 v17, v42, v41, 16
    v_alignbit_b32 v18, v43, v42, 16
    v_alignbit_b32 v19, v44, v43, 16
    ds_write_b128 v10, v[16:19] offset:1024
    v_mov_b32 v24, v41
    v_mov_b32 v25, v42
    v_mov_b32 v26, v43
    v_mov_b32 v27, v44
    ds_write_b128 v10, v[24:27] offset:4800
    v_alignbit_b32 v20, v42, v41, 16
    v_alignbit_b32 v21, v43, v42, 16
    v_alignbit_b32 v22, v44, v43, 16
    v_alignbit_b32 v23, v45, v44, 16
    ds_write_b128 v10, v[20:23] offset:8576
    s_waitcnt vmcnt(1)
    v_readlane_b32 s50, v70, 0
    v_readlane_b32 s51, v71, 0
    v_mov_b32_dpp v68, v64 wave_shl:1 row_mask:0xf bank_mask:0xf
    v_mov_b32_dpp v69, v65 wave_shl:1 row_mask:0xf bank_mask:0xf
    v_writelane_b32 v68, s50, 63
    v_writelane_b32 v69, s51, 63
    ds_write_b128 v10, v[66:69] offset:13376
    v_alignbit_b32 v196, v65, v64, 16
    v_alignbit_b32 v197, v66, v65, 16
    v_alignbit_b32 v198, v67, v66, 16
    v_alignbit_b32 v199, v68, v67, 16
    ds_write_b128 v10, v[196:199] offset:2048
    v_mov_b32 v214, v65
    v_mov_b32 v215, v66
    v_mov_b32 v216, v67
    v_mov_b32 v217, v68
    ds_write_b128 v10, v[214:217] offset:5824
    v_alignbit_b32 v206, v66, v65, 16
    v_alignbit_b32 v207, v67, v66, 16
    v_alignbit_b32 v208, v68, v67, 16
    v_alignbit_b32 v209, v69, v68, 16
    ds_write_b128 v10, v[206:209] offset:9600
    v_mov_b32_dpp v74, v70 wave_shl:1 row_mask:0xf bank_mask:0xf
    v_mov_b32_dpp v75, v71 wave_shl:1 row_mask:0xf bank_mask:0xf
    s_mov_b32 exec_hi, 0xfff
    ds_write_b128 v10, v[72:75] offset:14400
    s_mov_b32 exec_hi, -1
    v_alignbit_b32 v16, v71, v70, 16
    v_alignbit_b32 v17, v72, v71, 16
    v_alignbit_b32 v18, v73, v72, 16
    v_alignbit_b32 v19, v74, v73, 16
    s_mov_b32 exec_hi, 0xfff
    ds_write_b128 v10, v[16:19] offset:3072
    s_mov_b32 exec_hi, -1
    v_mov_b32 v24, v71
    v_mov_b32 v25, v72
    v_mov_b32 v26, v73
    v_mov_b32 v27, v74
    s_mov_b32 exec_hi, 0xfff
    ds_write_b128 v10, v[24:27] offset:6848
    s_mov_b32 exec_hi, -1
    v_alignbit_b32 v20, v72, v71, 16
    v_alignbit_b32 v21, v73, v72, 16
    v_alignbit_b32 v22, v74, v73, 16
    v_alignbit_b32 v23, v75, v74, 16
    s_mov_b32 exec_hi, 0xfff
    ds_write_b128 v10, v[20:23] offset:10624
    s_mov_b32 exec_hi, -1
    s_barrier
CV_b0:
    buffer_load_dwordx4 v[144:147], v50, s[32:35], 0 offen offset:0
    buffer_load_dwordx4 v[148:151], v50, s[32:35], 0 offen offset:1280
    buffer_load_dwordx4 v[152:155], v50, s[32:35], 0 offen offset:2560
    buffer_load_dwordx4 v[156:159], v50, s[32:35], 0 offen offset:3840
    s_mov_b64 exec, 1
    buffer_load_dwordx4 v[132:135], v51, s[32:35], 0 offen offset:0
    buffer_load_dwordx4 v[136:139], v51, s[32:35], 0 offen offset:1280
    buffer_load_dwordx4 v[140:143], v51, s[32:35], 0 offen offset:2560
    s_mov_b64 exec, -1
    buffer_load_dwordx4 v[160:163], v50, s[36:39], 0 offen offset:0
    buffer_load_dwordx4 v[164:167], v50, s[36:39], 0 offen offset:1280
    buffer_load_dwordx4 v[168:171], v50, s[36:39], 0 offen offset:2560
    buffer_load_dwordx4 v[172:175], v50, s[36:39], 0 offen offset:3840
    s_cbranch_scc0 CV_b2
    s_barrier
    s_waitcnt vmcnt(14)
    v_readlane_b32 s50, v40, 0
    v_readlane_b32 s51, v41, 0
    v_mov_b32_dpp v36, v32 wave_shl:1 row_mask:0xf bank_mask:0xf
    v_mov_b32_dpp v37, v33 wave_shl:1 row_mask:0xf bank_mask:0xf
    v_writelane_b32 v36, s50, 63
    v_writelane_b32 v37, s51, 63
    ds_write_b128 v10, v[34:37] offset:11328
    v_alignbit_b32 v196, v33, v32, 16
    v_alignbit_b32 v197, v34, v33, 16
    v_alignbit_b32 v198, v35, v34, 16
    v_alignbit_b32 v199, v36, v35, 16
    ds_write_b128 v10, v[196:199] offset:0
    v_mov_b32 v214, v33
    v_mov_b32 v215, v34
    v_mov_b32 v216, v35
    v_mov_b32 v217, v36
    ds_write_b128 v10, v[214:217] offset:3776
    v_alignbit_b32 v206, v34, v33, 16
    v_alignbit_b32 v207, v35, v34, 16
    v_alignbit_b32 v208, v36, v35, 16
    v_alignbit_b32 v209, v37, v36, 16
    ds_write_b128 v10, v[206:209] offset:7552
    s_waitcnt vmcnt(13)
    v_readlane_b32 s50, v64, 0
    v_readlane_b32 s51, v65, 0
    v_mov_b32_dpp v44, v40 wave_shl:1 row_mask:0xf bank_mask:0xf
    v_mov_b32_dpp v45, v41 wave_shl:1 row_mask:0xf bank_mask:0xf
    v_writelane_b32 v44, s50, 63
    v_writelane_b32 v45, s51, 63
    ds_write_b128 v10, v[42:45] offset:12352
    v_alignbit_b32 v16, v41, v40, 16
    v_alignbit_b32 v17, v42, v41, 16
    v_alignbit_b32 v18, v43, v42, 16
    v_alignbit_b32 v19, v44, v43, 16
    ds_write_b128 v10, v[16:19] offset:1024
    v_mov_b32 v24, v41
    v_mov_b32 v25, v42
    v_mov_b32 v26, v43
    v_mov_b32 v27, v44
    ds_write_b128 v10, v[24:27] offset:4800
    v_alignbit_b32 v20, v42, v41, 16
    v_alignbit_b32 v21, v43, v42, 16
    v_alignbit_b32 v22, v44, v43, 16
    v_alignbit_b32 v23, v45, v44, 16
    ds_write_b128 v10, v[20:23] offset:8576
    s_waitcnt vmcnt(12)
    v_readlane_b32 s50, v70, 0
    v_readlane_b32 s51, v71, 0
    v_mov_b32_dpp v68, v64 wave_shl:1 row_mask:0xf bank_mask:0xf
    v_mov_b32_dpp v69, v65 wave_shl:1 row_mask:0xf bank_mask:0xf
    v_writelane_b32 v68, s50, 63
    v_writelane_b32 v69, s51, 63
    ds_write_b128 v10, v[66:69] offset:13376
    v_alignbit_b32 v196, v65, v64, 16
    v_alignbit_b32 v197, v66, v65, 16
    v_alignbit_b32 v198, v67, v66, 16
    v_alignbit_b32 v199, v68, v67, 16
    ds_write_b128 v10, v[196:199] offset:2048
    v_mov_b32 v214, v65
    v_mov_b32 v215, v66
    v_mov_b32 v216, v67
    v_mov_b32 v217, v68
    ds_write_b128 v10, v[214:217] offset:5824
    v_alignbit_b32 v206, v66, v65, 16
    v_alignbit_b32 v207, v67, v66, 16
    v_alignbit_b32 v208, v68, v67, 16
    v_alignbit_b32 v209, v69, v68, 16
    ds_write_b128 v10, v[206:209] offset:9600
    v_mov_b32_dpp v74, v70 wave_shl:1 row_mask:0xf bank_mask:0xf
    v_mov_b32_dpp v75, v71 wave_shl:1 row_mask:0xf bank_mask:0xf
    s_mov_b32 exec_hi, 0xfff
    ds_write_b128 v10, v[72:75] offset:14400
    s_mov_b32 exec_hi, -1
    v_alignbit_b32 v16, v71, v70, 16
    v_alignbit_b32 v17, v72, v71, 16
    v_alignbit_b32 v18, v73, v72, 16
    v_alignbit_b32 v19, v74, v73, 16
    s_mov_b32 exec_hi, 0xfff
    ds_write_b128 v10, v[16:19] offset:3072
    s_mov_b32 exec_hi, -1
    v_mov_b32 v24, v71
    v_mov_b32 v25, v72
    v_mov_b32 v26, v73
    v_mov_b32 v27, v74
    s_mov_b32 exec_hi, 0xfff
    ds_write_b128 v10, v[24:27] offset:6848
    s_mov_b32 exec_hi, -1
    v_alignbit_b32 v20, v72, v71, 16
    v_alignbit_b32 v21, v73, v72, 16
    v_alignbit_b32 v22, v74, v73, 16
    v_alignbit_b32 v23, v75, v74, 16
    s_mov_b32 exec_hi, 0xfff
    ds_write_b128 v10, v[20:23] offset:10624
    s_mov_b32 exec_hi, -1
CV_b2:
    s_mov_b32 s49, 0x3f803f80
    s_setprio 3
    s_waitcnt vmcnt(4) lgkmcnt(0)
    v_mov_b32_dpp v132, v148 wave_shr:1 row_mask:0xf bank_mask:0xf
    v_mov_b32_dpp v133, v149 wave_shr:1 row_mask:0xf bank_mask:0xf
    v_mov_b32_dpp v134, v150 wave_shr:1 row_mask:0xf bank_mask:0xf
    v_mov_b32_dpp v135, v151 wave_shr:1 row_mask:0xf bank_mask:0xf
    v_mov_b32_dpp v136, v152 wave_shr:1 row_mask:0xf bank_mask:0xf
    v_mov_b32_dpp v137, v153 wave_shr:1 row_mask:0xf bank_mask:0xf
    v_mov_b32_dpp v138, v154 wave_shr:1 row_mask:0xf bank_mask:0xf
    v_mov_b32_dpp v139, v155 wave_shr:1 row_mask:0xf bank_mask:0xf
    v_mov_b32_dpp v140, v156 wave_shr:1 row_mask:0xf bank_mask:0xf
    v_mov_b32_dpp v141, v157 wave_shr:1 row_mask:0xf bank_mask:0xf
    v_mov_b32_dpp v142, v158 wave_shr:1 row_mask:0xf bank_mask:0xf
    v_mov_b32_dpp v143, v159 wave_shr:1 row_mask:0xf bank_mask:0xf
    s_mov_b32 s50, 0x05040100
    s_mov_b32 s51, 0x07060302
    s_cbranch_scc1 CV_kd
    s_mov_b32 s49, 0xffff0000
    v_lshlrev_b32 v182, 16, v144
    v_and_b32 v183, s49, v144
    s_lshl_b32 s40, s84, 16
    v_lshlrev_b32 v184, 16, v148
    v_and_b32 v185, s49, v148
    s_and_b32 s41, s84, s49
    v_lshlrev_b32 v186, 16, v152
    v_and_b32 v187, s49, v152
    s_lshl_b32 s42, s85, 16
    v_lshlrev_b32 v188, 16, v156
    v_and_b32 v189, s49, v156
    s_and_b32 s43, s85, s49
    v_lshlrev_b32 v176, 16, v132
    v_and_b32 v177, s49, v132
    s_lshl_b32 s44, s86, 16
    v_lshlrev_b32 v178, 16, v136
    v_and_b32 v179, s49, v136
    s_and_b32 s45, s86, s49
    v_lshlrev_b32 v180, 16, v140
    v_and_b32 v181, s49, v140
    s_lshl_b32 s46, s87, 16
    s_and_b32 s47, s87, s49
    v_mul_f32 v222, s43, v176
    v_mul_f32 v223, s47, v177
    v_mul_f32 v224, s43, v178
    v_mul_f32 v225, s47, v179
    v_mul_f32 v226, s43, v180
    v_mul_f32 v227, s47, v181
    v_mul_f32 v228, s43, v182
    v_mul_f32 v229, s47, v183
    v_fmac_f32 v222, s42, v178
    v_fmac_f32 v223, s46, v179
    v_fmac_f32 v224, s42, v180
    v_fmac_f32 v225, s46, v181
    v_fmac_f32 v226, s42, v182
    v_fmac_f32 v227, s46, v183
    v_fmac_f32 v228, s42, v184
    v_fmac_f32 v229, s46, v185
    v_fmac_f32 v222, s41, v180
    v_fmac_f32 v223, s45, v181
    v_fmac_f32 v224, s41, v182
    v_fmac_f32 v225, s45, v183
    v_fmac_f32 v226, s41, v184
    v_fmac_f32 v227, s45, v185
    v_fmac_f32 v228, s41, v186
    v_fmac_f32 v229, s45, v187
    v_fmac_f32 v222, s40, v182
    v_fmac_f32 v223, s44, v183
    v_fmac_f32 v224, s40, v184
    v_fmac_f32 v225, s44, v185
    v_fmac_f32 v226, s40, v186
    v_fmac_f32 v227, s44, v187
    v_fmac_f32 v228, s40, v188
    v_fmac_f32 v229, s44, v189
    v_lshlrev_b32 v196, 16, v145
    v_and_b32 v197, s49, v145
    s_lshl_b32 s32, s88, 16
    v_lshlrev_b32 v198, 16, v149
    v_and_b32 v199, s49, v149
    s_and_b32 s33, s88, s49
    v_lshlrev_b32 v200, 16, v153
    v_and_b32 v201, s49, v153
    s_lshl_b32 s34, s89, 16
    v_lshlrev_b32 v202, 16, v157
    v_and_b32 v203, s49, v157
    s_and_b32 s35, s89, s49
    v_lshlrev_b32 v190, 16, v133
    v_and_b32 v191, s49, v133
    s_lshl_b32 s36, s90, 16
    v_lshlrev_b32 v192, 16, v137
    v_and_b32 v193, s49, v137
    s_and_b32 s37, s90, s49
    v_lshlrev_b32 v194, 16, v141
    v_and_b32 v195, s49, v141
    s_lshl_b32 s38, s91, 16
    s_and_b32 s39, s91, s49
    v_mul_f32 v230, s35, v190
    v_mul_f32 v231, s39, v191
    v_mul_f32 v232, s35, v192
    v_mul_f32 v233, s39, v193
    v_mul_f32 v234, s35, v194
    v_mul_f32 v235, s39, v195
    v_mul_f32 v236, s35, v196
    v_mul_f32 v237, s39, v197
    v_fmac_f32 v230, s34, v192
    v_fmac_f32 v231, s38, v193
    v_fmac_f32 v232, s34, v194
    v_fmac_f32 v233, s38, v195
    v_fmac_f32 v234, s34, v196
    v_fmac_f32 v235, s38, v197
    v_fmac_f32 v236, s34, v198
    v_fmac_f32 v237, s38, v199
    v_fmac_f32 v230, s33, v194
    v_fmac_f32 v231, s37, v195
    v_fmac_f32 v232, s33, v196
    v_fmac_f32 v233, s37, v197
    v_fmac_f32 v234, s33, v198
    v_fmac_f32 v235, s37, v199
    v_fmac_f32 v236, s33, v200
    v_fmac_f32 v237, s37, v201
    v_fmac_f32 v230, s32, v196
    v_fmac_f32 v231, s36, v197
    v_fmac_f32 v232, s32, v198
    v_fmac_f32 v233, s36, v199
    v_fmac_f32 v234, s32, v200
    v_fmac_f32 v235, s36, v201
    v_fmac_f32 v236, s32, v202
    v_fmac_f32 v237, s36, v203
    v_lshlrev_b32 v182, 16, v146
    v_and_b32 v183, s49, v146
    s_lshl_b32 s40, s92, 16
    v_lshlrev_b32 v184, 16, v150
    v_and_b32 v185, s49, v150
    s_and_b32 s41, s92, s49
    v_lshlrev_b32 v186, 16, v154
    v_and_b32 v187, s49, v154
    s_lshl_b32 s42, s93, 16
    v_lshlrev_b32 v188, 16, v158
    v_and_b32 v189, s49, v158
    s_and_b32 s43, s93, s49
    v_lshlrev_b32 v176, 16, v134
    v_and_b32 v177, s49, v134
    s_lshl_b32 s44, s94, 16
    v_lshlrev_b32 v178, 16, v138
    v_and_b32 v179, s49, v138
    s_and_b32 s45, s94, s49
    v_lshlrev_b32 v180, 16, v142
    v_and_b32 v181, s49, v142
    s_lshl_b32 s46, s95, 16
    s_and_b32 s47, s95, s49
    v_mul_f32 v238, s43, v176
    v_mul_f32 v239, s47, v177
    v_mul_f32 v240, s43, v178
    v_mul_f32 v241, s47, v179
    v_mul_f32 v242, s43, v180
    v_mul_f32 v243, s47, v181
    v_mul_f32 v244, s43, v182
    v_mul_f32 v245, s47, v183
    v_fmac_f32 v238, s42, v178
    v_fmac_f32 v239, s46, v179
    v_fmac_f32 v240, s42, v180
    v_fmac_f32 v241, s46, v181
    v_fmac_f32 v242, s42, v182
    v_fmac_f32 v243, s46, v183
    v_fmac_f32 v244, s42, v184
    v_fmac_f32 v245, s46, v185
    v_fmac_f32 v238, s41, v180
    v_fmac_f32 v239, s45, v181
    v_fmac_f32 v240, s41, v182
    v_fmac_f32 v241, s45, v183
    v_fmac_f32 v242, s41, v184
    v_fmac_f32 v243, s45, v185
    v_fmac_f32 v244, s41, v186
    v_fmac_f32 v245, s45, v187
    v_fmac_f32 v238, s40, v182
    v_fmac_f32 v239, s44, v183
    v_fmac_f32 v240, s40, v184
    v_fmac_f32 v241, s44, v185
    v_fmac_f32 v242, s40, v186
    v_fmac_f32 v243, s44, v187
    v_fmac_f32 v244, s40, v188
    v_fmac_f32 v245, s44, v189
    v_lshlrev_b32 v196, 16, v147
    v_and_b32 v197, s49, v147
    s_lshl_b32 s32, s96, 16
    v_lshlrev_b32 v198, 16, v151
    v_and_b32 v199, s49, v151
    s_and_b32 s33, s96, s49
    v_lshlrev_b32 v200, 16, v155
    v_and_b32 v201, s49, v155
    s_lshl_b32 s34, s97, 16
    v_lshlrev_b32 v202, 16, v159
    v_and_b32 v203, s49, v159
    s_and_b32 s35, s97, s49
    v_lshlrev_b32 v190, 16, v135
    v_and_b32 v191, s49, v135
    s_lshl_b32 s36, s98, 16
    v_lshlrev_b32 v192, 16, v139
    v_and_b32 v193, s49, v139
    s_and_b32 s37, s98, s49
    v_lshlrev_b32 v194, 16, v143
    v_and_b32 v195, s49, v143
    s_lshl_b32 s38, s99, 16
    s_and_b32 s39, s99, s49
    v_mul_f32 v246, s35, v190
    v_mul_f32 v247, s39, v191
    v_mul_f32 v248, s35, v192
    v_mul_f32 v249, s39, v193
    v_mul_f32 v250, s35, v194
    v_mul_f32 v251, s39, v195
    v_mul_f32 v252, s35, v196
    v_mul_f32 v253, s39, v197
    v_fmac_f32 v246, s34, v192
    v_fmac_f32 v247, s38, v193
    v_fmac_f32 v248, s34, v194
    v_fmac_f32 v249, s38, v195
    v_fmac_f32 v250, s34, v196
    v_fmac_f32 v251, s38, v197
    v_fmac_f32 v252, s34, v198
    v_fmac_f32 v253, s38, v199
    v_fmac_f32 v246, s33, v194
    v_fmac_f32 v247, s37, v195
    v_fmac_f32 v248, s33, v196
    v_fmac_f32 v249, s37, v197
    v_fmac_f32 v250, s33, v198
    v_fmac_f32 v251, s37, v199
    v_fmac_f32 v252, s33, v200
    v_fmac_f32 v253, s37, v201
    v_fmac_f32 v246, s32, v196
    v_fmac_f32 v247, s36, v197
    v_fmac_f32 v248, s32, v198
    v_fmac_f32 v249, s36, v199
    v_fmac_f32 v250, s32, v200
    v_fmac_f32 v251, s36, v201
    v_fmac_f32 v252, s32, v202
    v_fmac_f32 v253, s36, v203
    s_branch CV_ke
CV_kd:
    v_perm_b32 v190, v132, v136, s50
    v_perm_b32 v191, v136, v140, s50
    v_perm_b32 v192, v140, v144, s50
    v_perm_b32 v193, v144, v148, s50
    v_perm_b32 v194, v148, v152, s50
    v_perm_b32 v195, v152, v156, s50
    v_perm_b32 v196, v132, v136, s51
    v_perm_b32 v197, v136, v140, s51
    v_perm_b32 v198, v140, v144, s51
    v_perm_b32 v199, v144, v148, s51
    v_perm_b32 v200, v148, v152, s51
    v_perm_b32 v201, v152, v156, s51
    v_dot2_f32_bf16 v222, v190, s85, 0
    v_dot2_f32_bf16 v223, v196, s87, 0
    v_dot2_f32_bf16 v224, v191, s85, 0
    v_dot2_f32_bf16 v225, v197, s87, 0
    v_dot2_f32_bf16 v226, v192, s85, 0
    v_dot2_f32_bf16 v227, v198, s87, 0
    v_dot2_f32_bf16 v228, v193, s85, 0
    v_dot2_f32_bf16 v229, v199, s87, 0
    v_dot2_f32_bf16 v222, v192, s84, v222
    v_dot2_f32_bf16 v223, v198, s86, v223
    v_dot2_f32_bf16 v224, v193, s84, v224
    v_dot2_f32_bf16 v225, v199, s86, v225
    v_dot2_f32_bf16 v226, v194, s84, v226
    v_dot2_f32_bf16 v227, v200, s86, v227
    v_dot2_f32_bf16 v228, v195, s84, v228
    v_dot2_f32_bf16 v229, v201, s86, v229
    v_perm_b32 v190, v133, v137, s50
    v_perm_b32 v191, v137, v141, s50
    v_perm_b32 v192, v141, v145, s50
    v_perm_b32 v193, v145, v149, s50
    v_perm_b32 v194, v149, v153, s50
    v_perm_b32 v195, v153, v157, s50
    v_perm_b32 v196, v133, v137, s51
    v_perm_b32 v197, v137, v141, s51
    v_perm_b32 v198, v141, v145, s51
    v_perm_b32 v199, v145, v149, s51
    v_perm_b32 v200, v149, v153, s51
    v_perm_b32 v201, v153, v157, s51
    v_dot2_f32_bf16 v230, v190, s89, 0
    v_dot2_f32_bf16 v231, v196, s91, 0
    v_dot2_f32_bf16 v232, v191, s89, 0
    v_dot2_f32_bf16 v233, v197, s91, 0
    v_dot2_f32_bf16 v234, v192, s89, 0
    v_dot2_f32_bf16 v235, v198, s91, 0
    v_dot2_f32_bf16 v236, v193, s89, 0
    v_dot2_f32_bf16 v237, v199, s91, 0
PGS_c_0:
    s_cbranch_execz PGS_c_1
    v_dot2_f32_bf16 v230, v192, s88, v230
    v_dot2_f32_bf16 v231, v198, s90, v231
    v_dot2_f32_bf16 v232, v193, s88, v232
    v_dot2_f32_bf16 v233, v199, s90, v233
    v_dot2_f32_bf16 v234, v194, s88, v234
    v_dot2_f32_bf16 v235, v200, s90, v235
    v_dot2_f32_bf16 v236, v195, s88, v236
    v_dot2_f32_bf16 v237, v201, s90, v237
    v_perm_b32 v190, v134, v138, s50
    v_perm_b32 v191, v138, v142, s50
    v_perm_b32 v192, v142, v146, s50
    v_perm_b32 v193, v146, v150, s50
    v_perm_b32 v194, v150, v154, s50
    v_perm_b32 v195, v154, v158, s50
    v_perm_b32 v196, v134, v138, s51
    v_perm_b32 v197, v138, v142, s51
    v_perm_b32 v198, v142, v146, s51
    v_perm_b32 v199, v146, v150, s51
    v_perm_b32 v200, v150, v154, s51
    v_perm_b32 v201, v154, v158, s51
    v_dot2_f32_bf16 v238, v190, s93, 0
    v_dot2_f32_bf16 v239, v196, s95, 0
    v_dot2_f32_bf16 v240, v191, s93, 0
    v_dot2_f32_bf16 v241, v197, s95, 0
    v_dot2_f32_bf16 v242, v192, s93, 0
    v_dot2_f32_bf16 v243, v198, s95, 0
    v_dot2_f32_bf16 v244, v193, s93, 0
    v_dot2_f32_bf16 v245, v199, s95, 0
    v_dot2_f32_bf16 v238, v192, s92, v238
    v_dot2_f32_bf16 v239, v198, s94, v239
    v_dot2_f32_bf16 v240, v193, s92, v240
    v_dot2_f32_bf16 v241, v199, s94, v241
    v_dot2_f32_bf16 v242, v194, s92, v242
    v_dot2_f32_bf16 v243, v200, s94, v243
    v_dot2_f32_bf16 v244, v195, s92, v244
    v_dot2_f32_bf16 v245, v201, s94, v245
    v_perm_b32 v190, v135, v139, s50
    v_perm_b32 v191, v139, v143, s50
    v_perm_b32 v192, v143, v147, s50
    v_perm_b32 v193, v147, v151, s50
    v_perm_b32 v194, v151, v155, s50
    v_perm_b32 v195, v155, v159, s50
    v_perm_b32 v196, v135, v139, s51
    v_perm_b32 v197, v139, v143, s51
    v_perm_b32 v198, v143, v147, s51
    v_perm_b32 v199, v147, v151, s51
    v_perm_b32 v200, v151, v155, s51
    v_perm_b32 v201, v155, v159, s51
    v_dot2_f32_bf16 v246, v190, s97, 0
    v_dot2_f32_bf16 v247, v196, s99, 0
    v_dot2_f32_bf16 v248, v191, s97, 0
    v_dot2_f32_bf16 v249, v197, s99, 0
    v_dot2_f32_bf16 v250, v192, s97, 0
    v_dot2_f32_bf16 v251, v198, s99, 0
    v_dot2_f32_bf16 v252, v193, s97, 0
    v_dot2_f32_bf16 v253, v199, s99, 0
    v_dot2_f32_bf16 v246, v192, s96, v246
    v_dot2_f32_bf16 v247, v198, s98, v247
    v_dot2_f32_bf16 v248, v193, s96, v248
    v_dot2_f32_bf16 v249, v199, s98, v249
    v_dot2_f32_bf16 v250, v194, s96, v250
    v_dot2_f32_bf16 v251, v200, s98, v251
    v_dot2_f32_bf16 v252, v195, s96, v252
    v_dot2_f32_bf16 v253, v201, s98, v253
CV_ke:
    s_waitcnt vmcnt(0)
    v_lshlrev_b32 v176, 16, v160
    v_and_b32 v177, 0xffff0000, v160
    v_lshlrev_b32 v178, 16, v164
    v_and_b32 v179, 0xffff0000, v164
    v_lshlrev_b32 v180, 16, v168
    v_and_b32 v181, 0xffff0000, v168
    v_lshlrev_b32 v182, 16, v172
    v_and_b32 v183, 0xffff0000, v172
    v_mul_f32 v222, v222, v176
    v_mul_f32 v223, v223, v177
    v_mul_f32 v224, v224, v178
    v_mul_f32 v225, v225, v179
    v_mul_f32 v226, v226, v180
    v_mul_f32 v227, v227, v181
    v_mul_f32 v228, v228, v182
    v_mul_f32 v229, v229, v183
    v_lshlrev_b32 v176, 16, v161
    v_and_b32 v177, 0xffff0000, v161
    v_lshlrev_b32 v178, 16, v165
    v_and_b32 v179, 0xffff0000, v165
    v_lshlrev_b32 v180, 16, v169
    v_and_b32 v181, 0xffff0000, v169
    v_lshlrev_b32 v182, 16, v173
    v_and_b32 v183, 0xffff0000, v173
    v_mul_f32 v230, v230, v176
    v_mul_f32 v231, v231, v177
    v_mul_f32 v232, v232, v178
    v_mul_f32 v233, v233, v179
    v_mul_f32 v234, v234, v180
    v_mul_f32 v235, v235, v181
    v_mul_f32 v236, v236, v182
    v_mul_f32 v237, v237, v183
    v_lshlrev_b32 v176, 16, v162
    v_and_b32 v177, 0xffff0000, v162
    v_lshlrev_b32 v178, 16, v166
    v_and_b32 v179, 0xffff0000, v166
    v_lshlrev_b32 v180, 16, v170
    v_and_b32 v181, 0xffff0000, v170
    v_lshlrev_b32 v182, 16, v174
    v_and_b32 v183, 0xffff0000, v174
    v_mul_f32 v238, v238, v176
    v_mul_f32 v239, v239, v177
    v_mul_f32 v240, v240, v178
    v_mul_f32 v241, v241, v179
    v_mul_f32 v242, v242, v180
    v_mul_f32 v243, v243, v181
    v_mul_f32 v244, v244, v182
    v_mul_f32 v245, v245, v183
    v_lshlrev_b32 v176, 16, v163
    v_and_b32 v177, 0xffff0000, v163
    v_lshlrev_b32 v178, 16, v167
    v_and_b32 v179, 0xffff0000, v167
    v_lshlrev_b32 v180, 16, v171
    v_and_b32 v181, 0xffff0000, v171
    v_lshlrev_b32 v182, 16, v175
    v_and_b32 v183, 0xffff0000, v175
    v_mul_f32 v246, v246, v176
    v_mul_f32 v247, v247, v177
    v_mul_f32 v248, v248, v178
    v_mul_f32 v249, v249, v179
    v_mul_f32 v250, v250, v180
    v_mul_f32 v251, v251, v181
    v_mul_f32 v252, v252, v182
    v_mul_f32 v253, v253, v183
    s_nop 1
    v_cvt_pk_bf16_f32 v191, v224, v222
    v_cvt_pk_bf16_f32 v190, v228, v226
    v_cvt_pk_bf16_f32 v193, v225, v223
    v_cvt_pk_bf16_f32 v192, v229, v227
    ds_write_b64 v52, v[190:191] offset:0
    ds_write_b64 v52, v[192:193] offset:20480
    v_cvt_pk_bf16_f32 v195, v232, v230
    v_cvt_pk_bf16_f32 v194, v236, v234
    v_cvt_pk_bf16_f32 v197, v233, v231
    v_cvt_pk_bf16_f32 v196, v237, v235
    ds_write_b64 v52, v[194:195] offset:40960
    ds_write_b64 v52, v[196:197] offset:61440
    v_cvt_pk_bf16_f32 v199, v240, v238
    v_cvt_pk_bf16_f32 v198, v244, v242
    v_cvt_pk_bf16_f32 v201, v241, v239
    v_cvt_pk_bf16_f32 v200, v245, v243
    ds_write_b64 v53, v[198:199] offset:0
    ds_write_b64 v53, v[200:201] offset:20480
    v_cvt_pk_bf16_f32 v203, v248, v246
    v_cvt_pk_bf16_f32 v202, v252, v250
    v_cvt_pk_bf16_f32 v205, v249, v247
    v_cvt_pk_bf16_f32 v204, v253, v251
    ds_write_b64 v53, v[202:203] offset:40960
    ds_write_b64 v53, v[204:205] offset:61440
    s_waitcnt lgkmcnt(0)
    s_mov_b64 exec, 1
    ds_add_u32 v59, v60
    s_mov_b64 exec, -1
CV_p1:
    ds_read_b32 v61, v58 offset:0
    s_waitcnt lgkmcnt(0)
    v_readfirstlane_b32 s54, v61
    s_cmp_lt_u32 s54, 4
    s_cbranch_scc0 CV_p1d
    s_sleep 1
    s_branch CV_p1
CV_p1d:
    ds_read_b128 v[180:183], v8 offset:0
    ds_read_b128 v[188:191], v8 offset:32
    v_cmp_ne_u32 vcc, 0, v5
    s_nop 1
    v_cndmask_b32 v218, 0, -1, vcc
    ds_read_b64 v[132:133], v7 offset:0
    ds_read_b64 v[134:135], v7 offset:8
    ds_read_b64 v[136:137], v7 offset:2048
    ds_read_b64 v[138:139], v7 offset:2056
    ds_read_b64 v[140:141], v7 offset:32
    ds_read_b64 v[142:143], v7 offset:40
    ds_read_b64 v[144:145], v7 offset:2080
    ds_read_b64 v[146:147], v7 offset:2088
    s_setprio 3
    s_waitcnt lgkmcnt(8)
    s_waitcnt lgkmcnt(4)
    v_mfma_f32_32x32x16_bf16 v[100:115], v[132:135], v[180:183], 0
    ds_read_b64 v[148:149], v7 offset:64
    ds_read_b64 v[150:151], v7 offset:72
    v_and_b32_dpp v184, v180, v218 wave_shr:1 row_mask:0xf bank_mask:0xf bound_ctrl:0
    v_and_b32_dpp v185, v181, v218 wave_shr:1 row_mask:0xf bank_mask:0xf bound_ctrl:0
    s_cmp_lt_u32 s3, 4
    s_cbranch_scc1 CV_cpscc1
    buffer_load_dword v254, v56, s[12:15], 0 offen
CV_cpscc1:
    v_mfma_f32_32x32x16_bf16 v[116:131], v[136:139], v[180:183], 0
    ds_read_b64 v[152:153], v7 offset:2112
    ds_read_b64 v[154:155], v7 offset:2120
    v_and_b32_dpp v186, v182, v218 wave_shr:1 row_mask:0xf bank_mask:0xf bound_ctrl:0
    v_and_b32_dpp v187, v183, v218 wave_shr:1 row_mask:0xf bank_mask:0xf bound_ctrl:0
    s_waitcnt lgkmcnt(4)
    v_mfma_f32_32x32x16_bf16 v[100:115], v[140:143], v[188:191], v[100:115]
    ds_read_b64 v[156:157], v7 offset:96
    ds_read_b64 v[158:159], v7 offset:104
    v_and_b32_dpp v192, v188, v218 wave_shr:1 row_mask:0xf bank_mask:0xf bound_ctrl:0
    v_and_b32_dpp v193, v189, v218 wave_shr:1 row_mask:0xf bank_mask:0xf bound_ctrl:0
    v_mfma_f32_32x32x16_bf16 v[116:131], v[144:147], v[188:191], v[116:131]
    ds_read_b64 v[160:161], v7 offset:2144
    ds_read_b64 v[162:163], v7 offset:2152
    v_and_b32_dpp v194, v190, v218 wave_shr:1 row_mask:0xf bank_mask:0xf bound_ctrl:0
    v_and_b32_dpp v195, v191, v218 wave_shr:1 row_mask:0xf bank_mask:0xf bound_ctrl:0
    s_waitcnt lgkmcnt(4)
    v_mfma_f32_32x32x16_bf16 v[100:115], v[148:151], v[184:187], v[100:115]
    ds_read_b64 v[164:165], v7 offset:128
    ds_read_b64 v[166:167], v7 offset:136
    v_and_b32_dpp v180, v184, v218 wave_shr:1 row_mask:0xf bank_mask:0xf bound_ctrl:0
    v_and_b32_dpp v181, v185, v218 wave_shr:1 row_mask:0xf bank_mask:0xf bound_ctrl:0
    s_lshr_b32 s48, s24, 3
    v_mfma_f32_32x32x16_bf16 v[116:131], v[152:155], v[184:187], v[116:131]
    ds_read_b64 v[168:169], v7 offset:2176
    ds_read_b64 v[170:171], v7 offset:2184
    v_and_b32_dpp v182, v186, v218 wave_shr:1 row_mask:0xf bank_mask:0xf bound_ctrl:0
    v_and_b32_dpp v183, v187, v218 wave_shr:1 row_mask:0xf bank_mask:0xf bound_ctrl:0
    s_lshl_b32 s48, s48, 2
    s_waitcnt lgkmcnt(4)
    v_mfma_f32_32x32x16_bf16 v[100:115], v[156:159], v[192:195], v[100:115]
    ds_read_b64 v[172:173], v7 offset:160
    ds_read_b64 v[174:175], v7 offset:168
    v_and_b32_dpp v188, v192, v218 wave_shr:1 row_mask:0xf bank_mask:0xf bound_ctrl:0
    v_and_b32_dpp v189, v193, v218 wave_shr:1 row_mask:0xf bank_mask:0xf bound_ctrl:0
    s_add_u32 s48, s48, s3
    v_mfma_f32_32x32x16_bf16 v[116:131], v[160:163], v[192:195], v[116:131]
    ds_read_b64 v[176:177], v7 offset:2208
    ds_read_b64 v[178:179], v7 offset:2216
    v_and_b32_dpp v190, v194, v218 wave_shr:1 row_mask:0xf bank_mask:0xf bound_ctrl:0
    v_and_b32_dpp v191, v195, v218 wave_shr:1 row_mask:0xf bank_mask:0xf bound_ctrl:0
    s_cmp_ge_u32 s3, 4
    s_cselect_b32 s48, 999, s48
    s_waitcnt lgkmcnt(4)
    v_mfma_f32_32x32x16_bf16 v[100:115], v[164:167], v[180:183], v[100:115]
    ds_read_b64 v[132:133], v7 offset:192
    ds_read_b64 v[134:135], v7 offset:200
    v_and_b32_dpp v184, v180, v218 wave_shr:1 row_mask:0xf bank_mask:0xf bound_ctrl:0
    v_and_b32_dpp v185, v181, v218 wave_shr:1 row_mask:0xf bank_mask:0xf bound_ctrl:0
    s_mul_i32 s17, s48, 0xCCCD
    v_mfma_f32_32x32x16_bf16 v[116:131], v[168:171], v[180:183], v[116:131]
    ds_read_b64 v[136:137], v7 offset:2240
    ds_read_b64 v[138:139], v7 offset:2248
    v_and_b32_dpp v186, v182, v218 wave_shr:1 row_mask:0xf bank_mask:0xf bound_ctrl:0
    v_and_b32_dpp v187, v183, v218 wave_shr:1 row_mask:0xf bank_mask:0xf bound_ctrl:0
    s_lshr_b32 s17, s17, 19
    s_waitcnt lgkmcnt(4)
    v_mfma_f32_32x32x16_bf16 v[100:115], v[172:175], v[188:191], v[100:115]
    ds_read_b64 v[140:141], v7 offset:224
    ds_read_b64 v[142:143], v7 offset:232
    v_and_b32_dpp v192, v188, v218 wave_shr:1 row_mask:0xf bank_mask:0xf bound_ctrl:0
    v_and_b32_dpp v193, v189, v218 wave_shr:1 row_mask:0xf bank_mask:0xf bound_ctrl:0
    s_mul_i32 s18, s17, 10
    v_mfma_f32_32x32x16_bf16 v[116:131], v[176:179], v[188:191], v[116:131]
    ds_read_b64 v[144:145], v7 offset:2272
    ds_read_b64 v[146:147], v7 offset:2280
    v_and_b32_dpp v194, v190, v218 wave_shr:1 row_mask:0xf bank_mask:0xf bound_ctrl:0
    v_and_b32_dpp v195, v191, v218 wave_shr:1 row_mask:0xf bank_mask:0xf bound_ctrl:0
    s_sub_u32 s18, s48, s18
    s_waitcnt lgkmcnt(4)
    v_mfma_f32_32x32x16_bf16 v[100:115], v[132:135], v[184:187], v[100:115]
    ds_read_b64 v[148:149], v7 offset:256
    ds_read_b64 v[150:151], v7 offset:264
    v_and_b32_dpp v180, v184, v218 wave_shr:1 row_mask:0xf bank_mask:0xf bound_ctrl:0
    v_and_b32_dpp v181, v185, v218 wave_shr:1 row_mask:0xf bank_mask:0xf bound_ctrl:0
    v_and_b32 v55, 7, v1
    v_mfma_f32_32x32x16_bf16 v[116:131], v[136:139], v[184:187], v[116:131]
    ds_read_b64 v[152:153], v7 offset:2304
    ds_read_b64 v[154:155], v7 offset:2312
    v_and_b32_dpp v182, v186, v218 wave_shr:1 row_mask:0xf bank_mask:0xf bound_ctrl:0
    v_and_b32_dpp v183, v187, v218 wave_shr:1 row_mask:0xf bank_mask:0xf bound_ctrl:0
    v_bfe_u32 v54, v1, 3, 2
    s_waitcnt lgkmcnt(4)
    v_mfma_f32_32x32x16_bf16 v[100:115], v[140:143], v[192:195], v[100:115]
    ds_read_b64 v[156:157], v7 offset:288
    ds_read_b64 v[158:159], v7 offset:296
    v_and_b32_dpp v188, v192, v218 wave_shr:1 row_mask:0xf bank_mask:0xf bound_ctrl:0
    v_and_b32_dpp v189, v193, v218 wave_shr:1 row_mask:0xf bank_mask:0xf bound_ctrl:0
    s_lshl_b32 s18, s18, 7
    v_mfma_f32_32x32x16_bf16 v[116:131], v[144:147], v[192:195], v[116:131]
    ds_read_b64 v[160:161], v7 offset:2336
    ds_read_b64 v[162:163], v7 offset:2344
    v_and_b32_dpp v190, v194, v218 wave_shr:1 row_mask:0xf bank_mask:0xf bound_ctrl:0
    v_and_b32_dpp v191, v195, v218 wave_shr:1 row_mask:0xf bank_mask:0xf bound_ctrl:0
    s_mul_i32 s17, s17, 81920
    s_waitcnt lgkmcnt(4)
    v_mfma_f32_32x32x16_bf16 v[100:115], v[148:151], v[180:183], v[100:115]
    ds_read_b64 v[164:165], v7 offset:320
    ds_read_b64 v[166:167], v7 offset:328
    v_and_b32_dpp v184, v180, v218 wave_shr:1 row_mask:0xf bank_mask:0xf bound_ctrl:0
    v_and_b32_dpp v185, v181, v218 wave_shr:1 row_mask:0xf bank_mask:0xf bound_ctrl:0
    v_mfma_f32_32x32x16_bf16 v[116:131], v[152:155], v[180:183], v[116:131]
    ds_read_b64 v[168:169], v7 offset:2368
    ds_read_b64 v[170:171], v7 offset:2376
    v_and_b32_dpp v186, v182, v218 wave_shr:1 row_mask:0xf bank_mask:0xf bound_ctrl:0
    v_and_b32_dpp v187, v183, v218 wave_shr:1 row_mask:0xf bank_mask:0xf bound_ctrl:0
    s_add_u32 s17, s17, s18
    s_waitcnt lgkmcnt(4)
    v_mfma_f32_32x32x16_bf16 v[100:115], v[156:159], v[188:191], v[100:115]
    ds_read_b64 v[172:173], v7 offset:352
    ds_read_b64 v[174:175], v7 offset:360
    v_and_b32_dpp v192, v188, v218 wave_shr:1 row_mask:0xf bank_mask:0xf bound_ctrl:0
    v_and_b32_dpp v193, v189, v218 wave_shr:1 row_mask:0xf bank_mask:0xf bound_ctrl:0
    v_lshl_add_u32 v52, v6, 3, v54
    v_mfma_f32_32x32x16_bf16 v[116:131], v[160:163], v[188:191], v[116:131]
    ds_read_b64 v[176:177], v7 offset:2400
    ds_read_b64 v[178:179], v7 offset:2408
    v_and_b32_dpp v194, v190, v218 wave_shr:1 row_mask:0xf bank_mask:0xf bound_ctrl:0
    v_and_b32_dpp v195, v191, v218 wave_shr:1 row_mask:0xf bank_mask:0xf bound_ctrl:0
    v_mul_u32_u24 v52, 5120, v52
    s_waitcnt lgkmcnt(4)
    v_mfma_f32_32x32x16_bf16 v[100:115], v[164:167], v[184:187], v[100:115]
    ds_read_b64 v[132:133], v7 offset:384
    ds_read_b64 v[134:135], v7 offset:392
    v_and_b32_dpp v180, v184, v218 wave_shr:1 row_mask:0xf bank_mask:0xf bound_ctrl:0
    v_and_b32_dpp v181, v185, v218 wave_shr:1 row_mask:0xf bank_mask:0xf bound_ctrl:0
    v_lshl_add_u32 v52, v55, 4, v52
    v_mfma_f32_32x32x16_bf16 v[116:131], v[168:171], v[184:187], v[116:131]
    ds_read_b64 v[136:137], v7 offset:2432
    ds_read_b64 v[138:139], v7 offset:2440
    v_and_b32_dpp v182, v186, v218 wave_shr:1 row_mask:0xf bank_mask:0xf bound_ctrl:0
    v_and_b32_dpp v183, v187, v218 wave_shr:1 row_mask:0xf bank_mask:0xf bound_ctrl:0
    s_add_u32 s18, s17, 0x5000
    s_waitcnt lgkmcnt(4)
    v_mfma_f32_32x32x16_bf16 v[100:115], v[172:175], v[192:195], v[100:115]
    ds_read_b64 v[140:141], v7 offset:416
    ds_read_b64 v[142:143], v7 offset:424
    v_and_b32_dpp v188, v192, v218 wave_shr:1 row_mask:0xf bank_mask:0xf bound_ctrl:0
    v_and_b32_dpp v189, v193, v218 wave_shr:1 row_mask:0xf bank_mask:0xf bound_ctrl:0
    s_mov_b32 s36, s4
    v_mfma_f32_32x32x16_bf16 v[116:131], v[176:179], v[192:195], v[116:131]
    ds_read_b64 v[144:145], v7 offset:2464
    ds_read_b64 v[146:147], v7 offset:2472
    v_and_b32_dpp v190, v194, v218 wave_shr:1 row_mask:0xf bank_mask:0xf bound_ctrl:0
    v_and_b32_dpp v191, v195, v218 wave_shr:1 row_mask:0xf bank_mask:0xf bound_ctrl:0
    s_mov_b32 s37, s5
    s_waitcnt lgkmcnt(4)
    v_mfma_f32_32x32x16_bf16 v[100:115], v[132:135], v[180:183], v[100:115]
    ds_read_b64 v[148:149], v7 offset:448
    ds_read_b64 v[150:151], v7 offset:456
    v_and_b32_dpp v184, v180, v218 wave_shr:1 row_mask:0xf bank_mask:0xf bound_ctrl:0
    v_and_b32_dpp v185, v181, v218 wave_shr:1 row_mask:0xf bank_mask:0xf bound_ctrl:0
    s_cmp_lt_u32 s48, 270
    s_cselect_b32 s38, 0x21c000, 0
    v_mfma_f32_32x32x16_bf16 v[116:131], v[136:139], v[180:183], v[116:131]
    ds_read_b64 v[152:153], v7 offset:2496
    ds_read_b64 v[154:155], v7 offset:2504
    v_and_b32_dpp v186, v182, v218 wave_shr:1 row_mask:0xf bank_mask:0xf bound_ctrl:0
    v_and_b32_dpp v187, v183, v218 wave_shr:1 row_mask:0xf bank_mask:0xf bound_ctrl:0
    s_mov_b32 s39, 0x00020000
    s_waitcnt lgkmcnt(4)
    v_mfma_f32_32x32x16_bf16 v[100:115], v[140:143], v[188:191], v[100:115]
    ds_read_b64 v[156:157], v7 offset:480
    ds_read_b64 v[158:159], v7 offset:488
    v_and_b32_dpp v192, v188, v218 wave_shr:1 row_mask:0xf bank_mask:0xf bound_ctrl:0
    v_and_b32_dpp v193, v189, v218 wave_shr:1 row_mask:0xf bank_mask:0xf bound_ctrl:0
    v_mfma_f32_32x32x16_bf16 v[116:131], v[144:147], v[188:191], v[116:131]
    ds_read_b64 v[160:161], v7 offset:2528
    ds_read_b64 v[162:163], v7 offset:2536
    v_and_b32_dpp v194, v190, v218 wave_shr:1 row_mask:0xf bank_mask:0xf bound_ctrl:0
    v_and_b32_dpp v195, v191, v218 wave_shr:1 row_mask:0xf bank_mask:0xf bound_ctrl:0
    s_waitcnt lgkmcnt(4)
    v_mfma_f32_32x32x16_bf16 v[100:115], v[148:151], v[184:187], v[100:115]
    ds_read_b64 v[164:165], v7 offset:512
    ds_read_b64 v[166:167], v7 offset:520
    v_and_b32_dpp v180, v184, v218 wave_shr:1 row_mask:0xf bank_mask:0xf bound_ctrl:0
    v_and_b32_dpp v181, v185, v218 wave_shr:1 row_mask:0xf bank_mask:0xf bound_ctrl:0
    v_mfma_f32_32x32x16_bf16 v[116:131], v[152:155], v[184:187], v[116:131]
    ds_read_b64 v[168:169], v7 offset:2560
    ds_read_b64 v[170:171], v7 offset:2568
    v_and_b32_dpp v182, v186, v218 wave_shr:1 row_mask:0xf bank_mask:0xf bound_ctrl:0
    v_and_b32_dpp v183, v187, v218 wave_shr:1 row_mask:0xf bank_mask:0xf bound_ctrl:0
    s_waitcnt lgkmcnt(4)
    v_mfma_f32_32x32x16_bf16 v[100:115], v[156:159], v[192:195], v[100:115]
    ds_read_b64 v[172:173], v7 offset:544
    ds_read_b64 v[174:175], v7 offset:552
    v_and_b32_dpp v188, v192, v218 wave_shr:1 row_mask:0xf bank_mask:0xf bound_ctrl:0
    v_and_b32_dpp v189, v193, v218 wave_shr:1 row_mask:0xf bank_mask:0xf bound_ctrl:0
    v_mfma_f32_32x32x16_bf16 v[116:131], v[160:163], v[192:195], v[116:131]
    ds_read_b64 v[176:177], v7 offset:2592
    ds_read_b64 v[178:179], v7 offset:2600
    v_and_b32_dpp v190, v194, v218 wave_shr:1 row_mask:0xf bank_mask:0xf bound_ctrl:0
    v_and_b32_dpp v191, v195, v218 wave_shr:1 row_mask:0xf bank_mask:0xf bound_ctrl:0
    s_waitcnt lgkmcnt(4)
    v_mfma_f32_32x32x16_bf16 v[100:115], v[164:167], v[180:183], v[100:115]
    ds_read_b64 v[132:133], v7 offset:576
    ds_read_b64 v[134:135], v7 offset:584
    v_and_b32_dpp v184, v180, v218 wave_shr:1 row_mask:0xf bank_mask:0xf bound_ctrl:0
    v_and_b32_dpp v185, v181, v218 wave_shr:1 row_mask:0xf bank_mask:0xf bound_ctrl:0
    v_mfma_f32_32x32x16_bf16 v[116:131], v[168:171], v[180:183], v[116:131]
    ds_read_b64 v[136:137], v7 offset:2624
    ds_read_b64 v[138:139], v7 offset:2632
    v_and_b32_dpp v186, v182, v218 wave_shr:1 row_mask:0xf bank_mask:0xf bound_ctrl:0
    v_and_b32_dpp v187, v183, v218 wave_shr:1 row_mask:0xf bank_mask:0xf bound_ctrl:0
    s_waitcnt lgkmcnt(4)
    v_mfma_f32_32x32x16_bf16 v[100:115], v[172:175], v[188:191], v[100:115]
    ds_read_b64 v[140:141], v7 offset:608
    ds_read_b64 v[142:143], v7 offset:616
    v_and_b32_dpp v192, v188, v218 wave_shr:1 row_mask:0xf bank_mask:0xf bound_ctrl:0
    v_and_b32_dpp v193, v189, v218 wave_shr:1 row_mask:0xf bank_mask:0xf bound_ctrl:0
    v_mfma_f32_32x32x16_bf16 v[116:131], v[176:179], v[188:191], v[116:131]
    ds_read_b64 v[144:145], v7 offset:2656
    ds_read_b64 v[146:147], v7 offset:2664
    v_and_b32_dpp v194, v190, v218 wave_shr:1 row_mask:0xf bank_mask:0xf bound_ctrl:0
    v_and_b32_dpp v195, v191, v218 wave_shr:1 row_mask:0xf bank_mask:0xf bound_ctrl:0
    s_waitcnt lgkmcnt(4)
    v_mfma_f32_32x32x16_bf16 v[100:115], v[132:135], v[184:187], v[100:115]
    ds_read_b64 v[148:149], v7 offset:640
    ds_read_b64 v[150:151], v7 offset:648
    v_and_b32_dpp v180, v184, v218 wave_shr:1 row_mask:0xf bank_mask:0xf bound_ctrl:0
    v_and_b32_dpp v181, v185, v218 wave_shr:1 row_mask:0xf bank_mask:0xf bound_ctrl:0
    v_mfma_f32_32x32x16_bf16 v[116:131], v[136:139], v[184:187], v[116:131]
    ds_read_b64 v[152:153], v7 offset:2688
    ds_read_b64 v[154:155], v7 offset:2696
    v_and_b32_dpp v182, v186, v218 wave_shr:1 row_mask:0xf bank_mask:0xf bound_ctrl:0
    v_and_b32_dpp v183, v187, v218 wave_shr:1 row_mask:0xf bank_mask:0xf bound_ctrl:0
    s_waitcnt lgkmcnt(4)
    v_mfma_f32_32x32x16_bf16 v[100:115], v[140:143], v[192:195], v[100:115]
    ds_read_b64 v[156:157], v7 offset:672
    ds_read_b64 v[158:159], v7 offset:680
    v_and_b32_dpp v188, v192, v218 wave_shr:1 row_mask:0xf bank_mask:0xf bound_ctrl:0
    v_and_b32_dpp v189, v193, v218 wave_shr:1 row_mask:0xf bank_mask:0xf bound_ctrl:0
    v_mfma_f32_32x32x16_bf16 v[116:131], v[144:147], v[192:195], v[116:131]
    ds_read_b64 v[160:161], v7 offset:2720
    ds_read_b64 v[162:163], v7 offset:2728
    v_and_b32_dpp v190, v194, v218 wave_shr:1 row_mask:0xf bank_mask:0xf bound_ctrl:0
    v_and_b32_dpp v191, v195, v218 wave_shr:1 row_mask:0xf bank_mask:0xf bound_ctrl:0
    s_waitcnt lgkmcnt(4)
    v_mfma_f32_32x32x16_bf16 v[100:115], v[148:151], v[180:183], v[100:115]
    ds_read_b64 v[164:165], v7 offset:704
    ds_read_b64 v[166:167], v7 offset:712
    v_and_b32_dpp v184, v180, v218 wave_shr:1 row_mask:0xf bank_mask:0xf bound_ctrl:0
    v_and_b32_dpp v185, v181, v218 wave_shr:1 row_mask:0xf bank_mask:0xf bound_ctrl:0
    v_mfma_f32_32x32x16_bf16 v[116:131], v[152:155], v[180:183], v[116:131]
    ds_read_b64 v[168:169], v7 offset:2752
    ds_read_b64 v[170:171], v7 offset:2760
    v_and_b32_dpp v186, v182, v218 wave_shr:1 row_mask:0xf bank_mask:0xf bound_ctrl:0
    v_and_b32_dpp v187, v183, v218 wave_shr:1 row_mask:0xf bank_mask:0xf bound_ctrl:0
    s_waitcnt lgkmcnt(4)
    v_mfma_f32_32x32x16_bf16 v[100:115], v[156:159], v[188:191], v[100:115]
    ds_read_b64 v[172:173], v7 offset:736
    ds_read_b64 v[174:175], v7 offset:744
    v_and_b32_dpp v192, v188, v218 wave_shr:1 row_mask:0xf bank_mask:0xf bound_ctrl:0
    v_and_b32_dpp v193, v189, v218 wave_shr:1 row_mask:0xf bank_mask:0xf bound_ctrl:0
    v_mfma_f32_32x32x16_bf16 v[116:131], v[160:163], v[188:191], v[116:131]
    ds_read_b64 v[176:177], v7 offset:2784
    ds_read_b64 v[178:179], v7 offset:2792
    v_and_b32_dpp v194, v190, v218 wave_shr:1 row_mask:0xf bank_mask:0xf bound_ctrl:0
    v_and_b32_dpp v195, v191, v218 wave_shr:1 row_mask:0xf bank_mask:0xf bound_ctrl:0
    s_waitcnt lgkmcnt(4)
    v_mfma_f32_32x32x16_bf16 v[100:115], v[164:167], v[184:187], v[100:115]
    ds_read_b64 v[132:133], v7 offset:768
    ds_read_b64 v[134:135], v7 offset:776
    v_and_b32_dpp v180, v184, v218 wave_shr:1 row_mask:0xf bank_mask:0xf bound_ctrl:0
    v_and_b32_dpp v181, v185, v218 wave_shr:1 row_mask:0xf bank_mask:0xf bound_ctrl:0
    v_mfma_f32_32x32x16_bf16 v[116:131], v[168:171], v[184:187], v[116:131]
    ds_read_b64 v[136:137], v7 offset:2816
    ds_read_b64 v[138:139], v7 offset:2824
    v_and_b32_dpp v182, v186, v218 wave_shr:1 row_mask:0xf bank_mask:0xf bound_ctrl:0
    v_and_b32_dpp v183, v187, v218 wave_shr:1 row_mask:0xf bank_mask:0xf bound_ctrl:0
    s_waitcnt lgkmcnt(4)
    v_mfma_f32_32x32x16_bf16 v[100:115], v[172:175], v[192:195], v[100:115]
    ds_read_b64 v[140:141], v7 offset:800
    ds_read_b64 v[142:143], v7 offset:808
    v_and_b32_dpp v188, v192, v218 wave_shr:1 row_mask:0xf bank_mask:0xf bound_ctrl:0
    v_and_b32_dpp v189, v193, v218 wave_shr:1 row_mask:0xf bank_mask:0xf bound_ctrl:0
    v_mfma_f32_32x32x16_bf16 v[116:131], v[176:179], v[192:195], v[116:131]
    ds_read_b64 v[144:145], v7 offset:2848
    ds_read_b64 v[146:147], v7 offset:2856
    v_and_b32_dpp v190, v194, v218 wave_shr:1 row_mask:0xf bank_mask:0xf bound_ctrl:0
    v_and_b32_dpp v191, v195, v218 wave_shr:1 row_mask:0xf bank_mask:0xf bound_ctrl:0
    s_waitcnt lgkmcnt(4)
    v_mfma_f32_32x32x16_bf16 v[100:115], v[132:135], v[180:183], v[100:115]
    ds_read_b64 v[148:149], v7 offset:832
    ds_read_b64 v[150:151], v7 offset:840
    v_and_b32_dpp v184, v180, v218 wave_shr:1 row_mask:0xf bank_mask:0xf bound_ctrl:0
    v_and_b32_dpp v185, v181, v218 wave_shr:1 row_mask:0xf bank_mask:0xf bound_ctrl:0
    s_mov_b32 s30, 0xfffffff
    s_mov_b32 s31, 0
    v_mov_b32_dpp v80, v76 wave_shl:1 row_mask:0xf bank_mask:0xf bound_ctrl:0
    v_mov_b32_dpp v81, v77 wave_shl:1 row_mask:0xf bank_mask:0xf bound_ctrl:0
    v_mfma_f32_32x32x16_bf16 v[116:131], v[136:139], v[180:183], v[116:131]
    ds_read_b64 v[152:153], v7 offset:2880
    ds_read_b64 v[154:155], v7 offset:2888
    v_and_b32_dpp v186, v182, v218 wave_shr:1 row_mask:0xf bank_mask:0xf bound_ctrl:0
    v_and_b32_dpp v187, v183, v218 wave_shr:1 row_mask:0xf bank_mask:0xf bound_ctrl:0
    v_alignbit_b32 v196, v77, v76, 16
    v_alignbit_b32 v197, v78, v77, 16
    s_waitcnt lgkmcnt(4)
    v_mfma_f32_32x32x16_bf16 v[100:115], v[140:143], v[188:191], v[100:115]
    ds_read_b64 v[156:157], v7 offset:864
    ds_read_b64 v[158:159], v7 offset:872
    v_and_b32_dpp v192, v188, v218 wave_shr:1 row_mask:0xf bank_mask:0xf bound_ctrl:0
    v_and_b32_dpp v193, v189, v218 wave_shr:1 row_mask:0xf bank_mask:0xf bound_ctrl:0
    v_alignbit_b32 v198, v79, v78, 16
    s_mov_b64 exec, s[30:31]
    ds_write_b128 v10, v[78:81] offset:13440
    s_mov_b64 exec, -1
    v_mfma_f32_32x32x16_bf16 v[116:131], v[144:147], v[188:191], v[116:131]
    ds_read_b64 v[160:161], v7 offset:2912
    ds_read_b64 v[162:163], v7 offset:2920
    v_and_b32_dpp v194, v190, v218 wave_shr:1 row_mask:0xf bank_mask:0xf bound_ctrl:0
    v_and_b32_dpp v195, v191, v218 wave_shr:1 row_mask:0xf bank_mask:0xf bound_ctrl:0
    v_alignbit_b32 v199, v80, v79, 16
    v_mov_b32 v214, v77
    s_waitcnt lgkmcnt(5)
    v_mfma_f32_32x32x16_bf16 v[100:115], v[148:151], v[184:187], v[100:115]
    ds_read_b64 v[164:165], v7 offset:896
    ds_read_b64 v[166:167], v7 offset:904
    v_and_b32_dpp v180, v184, v218 wave_shr:1 row_mask:0xf bank_mask:0xf bound_ctrl:0
    v_and_b32_dpp v181, v185, v218 wave_shr:1 row_mask:0xf bank_mask:0xf bound_ctrl:0
    s_mov_b64 exec, s[30:31]
    ds_write_b128 v10, v[196:199] offset:2112
    s_mov_b64 exec, -1
    v_mov_b32 v215, v78
    v_mfma_f32_32x32x16_bf16 v[116:131], v[152:155], v[184:187], v[116:131]
    ds_read_b64 v[168:169], v7 offset:2944
    ds_read_b64 v[170:171], v7 offset:2952
    v_and_b32_dpp v182, v186, v218 wave_shr:1 row_mask:0xf bank_mask:0xf bound_ctrl:0
    v_and_b32_dpp v183, v187, v218 wave_shr:1 row_mask:0xf bank_mask:0xf bound_ctrl:0
    v_mov_b32 v216, v79
    v_mov_b32 v217, v80
    s_waitcnt lgkmcnt(5)
    v_mfma_f32_32x32x16_bf16 v[100:115], v[156:159], v[192:195], v[100:115]
    ds_read_b64 v[172:173], v7 offset:928
    ds_read_b64 v[174:175], v7 offset:936
    v_and_b32_dpp v188, v192, v218 wave_shr:1 row_mask:0xf bank_mask:0xf bound_ctrl:0
    v_and_b32_dpp v189, v193, v218 wave_shr:1 row_mask:0xf bank_mask:0xf bound_ctrl:0
    s_mov_b64 exec, s[30:31]
    ds_write_b128 v10, v[214:217] offset:5888
    s_mov_b64 exec, -1
    v_mfma_f32_32x32x16_bf16 v[116:131], v[160:163], v[192:195], v[116:131]
    ds_read_b64 v[176:177], v7 offset:2976
    ds_read_b64 v[178:179], v7 offset:2984
    v_and_b32_dpp v190, v194, v218 wave_shr:1 row_mask:0xf bank_mask:0xf bound_ctrl:0
    v_and_b32_dpp v191, v195, v218 wave_shr:1 row_mask:0xf bank_mask:0xf bound_ctrl:0
    v_alignbit_b32 v206, v78, v77, 16
    v_alignbit_b32 v207, v79, v78, 16
    s_waitcnt lgkmcnt(5)
    v_mfma_f32_32x32x16_bf16 v[100:115], v[164:167], v[180:183], v[100:115]
    ds_read_b64 v[132:133], v7 offset:960
    ds_read_b64 v[134:135], v7 offset:968
    v_and_b32_dpp v184, v180, v218 wave_shr:1 row_mask:0xf bank_mask:0xf bound_ctrl:0
    v_and_b32_dpp v185, v181, v218 wave_shr:1 row_mask:0xf bank_mask:0xf bound_ctrl:0
    v_and_b32 v48, 15, v1
    v_sub_u32 v48, 63, v48
    v_mul_u32_u24 v48, 80, v48
    v_lshl_add_u32 v48, v6, 4, v48
    v_alignbit_b32 v208, v80, v79, 16
    v_alignbit_b32 v209, v81, v80, 16
    v_mfma_f32_32x32x16_bf16 v[116:131], v[168:171], v[180:183], v[116:131]
    ds_read_b64 v[136:137], v7 offset:3008
    ds_read_b64 v[138:139], v7 offset:3016
    v_and_b32_dpp v186, v182, v218 wave_shr:1 row_mask:0xf bank_mask:0xf bound_ctrl:0
    v_and_b32_dpp v187, v183, v218 wave_shr:1 row_mask:0xf bank_mask:0xf bound_ctrl:0
    v_bfe_u32 v49, v1, 4, 1
    v_lshl_add_u32 v48, v49, 5, v48
    v_add_u32 v48, s28, v48
    s_mov_b64 exec, s[30:31]
    ds_write_b128 v10, v[206:209] offset:9664
    s_mov_b64 exec, -1
    s_waitcnt lgkmcnt(5)
    v_mfma_f32_32x32x16_bf16 v[100:115], v[172:175], v[188:191], v[100:115]
    ds_read_b64 v[140:141], v7 offset:992
    ds_read_b64 v[142:143], v7 offset:1000
    v_and_b32_dpp v192, v188, v218 wave_shr:1 row_mask:0xf bank_mask:0xf bound_ctrl:0
    v_and_b32_dpp v193, v189, v218 wave_shr:1 row_mask:0xf bank_mask:0xf bound_ctrl:0
    ds_read_b128 v[200:203], v48
    v_and_b32 v49, 15, v1
    v_lshlrev_b32 v49, 4, v49
    v_lshl_add_u32 v49, v6, 8, v49
    v_add_u32 v49, s28, v49
    s_cmp_lt_u32 s3, 4
    s_cbranch_scc0 CV_cpscc0
    buffer_load_dword v254, v56, s[12:15], 0 offen
CV_cpscc0:
    v_mfma_f32_32x32x16_bf16 v[116:131], v[176:179], v[188:191], v[116:131]
PGS_c_1:
    s_cbranch_execz PGS_c_2
    ds_read_b64 v[144:145], v7 offset:3040
    ds_read_b64 v[146:147], v7 offset:3048
    v_and_b32_dpp v194, v190, v218 wave_shr:1 row_mask:0xf bank_mask:0xf bound_ctrl:0
    v_and_b32_dpp v195, v191, v218 wave_shr:1 row_mask:0xf bank_mask:0xf bound_ctrl:0
    s_waitcnt lgkmcnt(6)
    v_mfma_f32_32x32x16_bf16 v[100:115], v[132:135], v[184:187], v[100:115]
    ds_read_b64 v[148:149], v7 offset:1024
    ds_read_b64 v[150:151], v7 offset:1032
    v_mfma_f32_32x32x16_bf16 v[116:131], v[136:139], v[184:187], v[116:131]
    ds_read_b64 v[152:153], v7 offset:3072
    ds_read_b64 v[154:155], v7 offset:3080
    s_waitcnt lgkmcnt(4)
    v_mfma_f32_32x32x16_bf16 v[100:115], v[140:143], v[192:195], v[100:115]
    ds_read_b64 v[156:157], v7 offset:1056
    ds_read_b64 v[158:159], v7 offset:1064
    v_mfma_f32_32x32x16_bf16 v[116:131], v[144:147], v[192:195], v[116:131]
    ds_read_b64 v[160:161], v7 offset:3104
    ds_read_b64 v[162:163], v7 offset:3112
    s_waitcnt lgkmcnt(4)
    v_mfma_f32_16x16x32_bf16 v[180:183], v[148:151], v[200:203], 0
    ds_read_b64 v[164:165], v7 offset:1088
    ds_read_b64 v[166:167], v7 offset:1096
    v_mfma_f32_16x16x32_bf16 v[188:191], v[152:155], v[200:203], 0
    ds_read_b64 v[168:169], v7 offset:3136
    ds_read_b64 v[170:171], v7 offset:3144
    v_mov_b32_dpp v210, v200 row_shr:1 row_mask:0xf bank_mask:0xf bound_ctrl:0
    v_mov_b32_dpp v211, v201 row_shr:1 row_mask:0xf bank_mask:0xf bound_ctrl:0
    s_waitcnt lgkmcnt(4)
    v_mfma_f32_16x16x32_bf16 v[184:187], v[156:159], v[200:203], 0
    ds_read_b64 v[172:173], v7 offset:1120
    ds_read_b64 v[174:175], v7 offset:1128
    v_mov_b32_dpp v212, v202 row_shr:1 row_mask:0xf bank_mask:0xf bound_ctrl:0
    v_mov_b32_dpp v213, v203 row_shr:1 row_mask:0xf bank_mask:0xf bound_ctrl:0
    v_mfma_f32_16x16x32_bf16 v[192:195], v[160:163], v[200:203], 0
    ds_read_b64 v[176:177], v7 offset:3168
    ds_read_b64 v[178:179], v7 offset:3176
    s_waitcnt lgkmcnt(4)
    v_mfma_f32_16x16x32_bf16 v[180:183], v[164:167], v[210:213], v[180:183]
    ds_read_b64 v[132:133], v7 offset:1152
    ds_read_b64 v[134:135], v7 offset:1160
    v_mfma_f32_16x16x32_bf16 v[188:191], v[168:171], v[210:213], v[188:191]
    ds_read_b64 v[136:137], v7 offset:3200
    ds_read_b64 v[138:139], v7 offset:3208
    v_mov_b32_dpp v200, v210 row_shr:1 row_mask:0xf bank_mask:0xf bound_ctrl:0
    v_mov_b32_dpp v201, v211 row_shr:1 row_mask:0xf bank_mask:0xf bound_ctrl:0
    s_waitcnt lgkmcnt(4)
    v_mfma_f32_16x16x32_bf16 v[184:187], v[172:175], v[210:213], v[184:187]
    ds_read_b64 v[140:141], v7 offset:1184
    ds_read_b64 v[142:143], v7 offset:1192
    v_mov_b32_dpp v202, v212 row_shr:1 row_mask:0xf bank_mask:0xf bound_ctrl:0
    v_mov_b32_dpp v203, v213 row_shr:1 row_mask:0xf bank_mask:0xf bound_ctrl:0
    v_mfma_f32_16x16x32_bf16 v[192:195], v[176:179], v[210:213], v[192:195]
    ds_read_b64 v[144:145], v7 offset:3232
    ds_read_b64 v[146:147], v7 offset:3240
    s_waitcnt lgkmcnt(4)
    v_mfma_f32_16x16x32_bf16 v[180:183], v[132:135], v[200:203], v[180:183]
    ds_read_b64 v[148:149], v7 offset:1216
    ds_read_b64 v[150:151], v7 offset:1224
    v_mfma_f32_16x16x32_bf16 v[188:191], v[136:139], v[200:203], v[188:191]
    ds_read_b64 v[152:153], v7 offset:3264
    ds_read_b64 v[154:155], v7 offset:3272
    v_mov_b32_dpp v210, v200 row_shr:1 row_mask:0xf bank_mask:0xf bound_ctrl:0
    v_mov_b32_dpp v211, v201 row_shr:1 row_mask:0xf bank_mask:0xf bound_ctrl:0
    s_waitcnt lgkmcnt(4)
    v_mfma_f32_16x16x32_bf16 v[184:187], v[140:143], v[200:203], v[184:187]
    ds_read_b64 v[156:157], v7 offset:1248
    ds_read_b64 v[158:159], v7 offset:1256
    v_mov_b32_dpp v212, v202 row_shr:1 row_mask:0xf bank_mask:0xf bound_ctrl:0
    v_mov_b32_dpp v213, v203 row_shr:1 row_mask:0xf bank_mask:0xf bound_ctrl:0
    v_mfma_f32_16x16x32_bf16 v[192:195], v[144:147], v[200:203], v[192:195]
    ds_read_b64 v[160:161], v7 offset:3296
    ds_read_b64 v[162:163], v7 offset:3304
    s_waitcnt lgkmcnt(4)
    v_mfma_f32_16x16x32_bf16 v[180:183], v[148:151], v[210:213], v[180:183]
    ds_read_b64 v[164:165], v7 offset:1280
    ds_read_b64 v[166:167], v7 offset:1288
    v_mfma_f32_16x16x32_bf16 v[188:191], v[152:155], v[210:213], v[188:191]
    ds_read_b64 v[168:169], v7 offset:3328
    ds_read_b64 v[170:171], v7 offset:3336
    v_mov_b32_dpp v200, v210 row_shr:1 row_mask:0xf bank_mask:0xf bound_ctrl:0
    v_mov_b32_dpp v201, v211 row_shr:1 row_mask:0xf bank_mask:0xf bound_ctrl:0
    s_waitcnt lgkmcnt(4)
    v_mfma_f32_16x16x32_bf16 v[184:187], v[156:159], v[210:213], v[184:187]
    ds_read_b64 v[172:173], v7 offset:1312
    ds_read_b64 v[174:175], v7 offset:1320
    v_mov_b32_dpp v202, v212 row_shr:1 row_mask:0xf bank_mask:0xf bound_ctrl:0
    v_mov_b32_dpp v203, v213 row_shr:1 row_mask:0xf bank_mask:0xf bound_ctrl:0
    v_mfma_f32_16x16x32_bf16 v[192:195], v[160:163], v[210:213], v[192:195]
    ds_read_b64 v[176:177], v7 offset:3360
    ds_read_b64 v[178:179], v7 offset:3368
    s_waitcnt lgkmcnt(4)
    v_mfma_f32_16x16x32_bf16 v[180:183], v[164:167], v[200:203], v[180:183]
    ds_read_b64 v[132:133], v7 offset:1344
    ds_read_b64 v[134:135], v7 offset:1352
    v_mfma_f32_16x16x32_bf16 v[188:191], v[168:171], v[200:203], v[188:191]
    ds_read_b64 v[136:137], v7 offset:3392
    ds_read_b64 v[138:139], v7 offset:3400
    v_mov_b32_dpp v210, v200 row_shr:1 row_mask:0xf bank_mask:0xf bound_ctrl:0
    v_mov_b32_dpp v211, v201 row_shr:1 row_mask:0xf bank_mask:0xf bound_ctrl:0
    s_waitcnt lgkmcnt(4)
    v_mfma_f32_16x16x32_bf16 v[184:187], v[172:175], v[200:203], v[184:187]
    ds_read_b64 v[140:141], v7 offset:1376
    ds_read_b64 v[142:143], v7 offset:1384
    v_mov_b32_dpp v212, v202 row_shr:1 row_mask:0xf bank_mask:0xf bound_ctrl:0
    v_mov_b32_dpp v213, v203 row_shr:1 row_mask:0xf bank_mask:0xf bound_ctrl:0
    v_mfma_f32_16x16x32_bf16 v[192:195], v[176:179], v[200:203], v[192:195]
    ds_read_b64 v[144:145], v7 offset:3424
    ds_read_b64 v[146:147], v7 offset:3432
    s_waitcnt lgkmcnt(4)
    v_mfma_f32_16x16x32_bf16 v[180:183], v[132:135], v[210:213], v[180:183]
    ds_read_b64 v[148:149], v7 offset:1408
    ds_read_b64 v[150:151], v7 offset:1416
    v_mfma_f32_16x16x32_bf16 v[188:191], v[136:139], v[210:213], v[188:191]
    ds_read_b64 v[152:153], v7 offset:3456
    ds_read_b64 v[154:155], v7 offset:3464
    v_mov_b32_dpp v200, v210 row_shr:1 row_mask:0xf bank_mask:0xf bound_ctrl:0
    v_mov_b32_dpp v201, v211 row_shr:1 row_mask:0xf bank_mask:0xf bound_ctrl:0
    s_waitcnt lgkmcnt(4)
    v_mfma_f32_16x16x32_bf16 v[184:187], v[140:143], v[210:213], v[184:187]
    ds_read_b64 v[156:157], v7 offset:1440
    ds_read_b64 v[158:159], v7 offset:1448
    v_mov_b32_dpp v202, v212 row_shr:1 row_mask:0xf bank_mask:0xf bound_ctrl:0
    v_mov_b32_dpp v203, v213 row_shr:1 row_mask:0xf bank_mask:0xf bound_ctrl:0
    v_mfma_f32_16x16x32_bf16 v[192:195], v[144:147], v[210:213], v[192:195]
    ds_read_b64 v[160:161], v7 offset:3488
    ds_read_b64 v[162:163], v7 offset:3496
    s_waitcnt lgkmcnt(4)
    v_mfma_f32_16x16x32_bf16 v[180:183], v[148:151], v[200:203], v[180:183]
    ds_read_b64 v[164:165], v7 offset:1472
    ds_read_b64 v[166:167], v7 offset:1480
    v_mfma_f32_16x16x32_bf16 v[188:191], v[152:155], v[200:203], v[188:191]
    ds_read_b64 v[168:169], v7 offset:3520
    ds_read_b64 v[170:171], v7 offset:3528
    v_mov_b32_dpp v210, v200 row_shr:1 row_mask:0xf bank_mask:0xf bound_ctrl:0
    v_mov_b32_dpp v211, v201 row_shr:1 row_mask:0xf bank_mask:0xf bound_ctrl:0
    s_waitcnt lgkmcnt(4)
    v_mfma_f32_16x16x32_bf16 v[184:187], v[156:159], v[200:203], v[184:187]
    ds_read_b64 v[172:173], v7 offset:1504
    ds_read_b64 v[174:175], v7 offset:1512
    v_mov_b32_dpp v212, v202 row_shr:1 row_mask:0xf bank_mask:0xf bound_ctrl:0
    v_mov_b32_dpp v213, v203 row_shr:1 row_mask:0xf bank_mask:0xf bound_ctrl:0
    v_mfma_f32_16x16x32_bf16 v[192:195], v[160:163], v[200:203], v[192:195]
    ds_read_b64 v[176:177], v7 offset:3552
    ds_read_b64 v[178:179], v7 offset:3560
    s_waitcnt lgkmcnt(4)
    v_mfma_f32_16x16x32_bf16 v[180:183], v[164:167], v[210:213], v[180:183]
    ds_read_b64 v[132:133], v7 offset:1536
    ds_read_b64 v[134:135], v7 offset:1544
    v_mfma_f32_16x16x32_bf16 v[188:191], v[168:171], v[210:213], v[188:191]
    ds_read_b64 v[136:137], v7 offset:3584
    ds_read_b64 v[138:139], v7 offset:3592
    v_mov_b32_dpp v200, v210 row_shr:1 row_mask:0xf bank_mask:0xf bound_ctrl:0
    v_mov_b32_dpp v201, v211 row_shr:1 row_mask:0xf bank_mask:0xf bound_ctrl:0
    s_waitcnt lgkmcnt(4)
    v_mfma_f32_16x16x32_bf16 v[184:187], v[172:175], v[210:213], v[184:187]
    ds_read_b64 v[140:141], v7 offset:1568
    ds_read_b64 v[142:143], v7 offset:1576
    v_mov_b32_dpp v202, v212 row_shr:1 row_mask:0xf bank_mask:0xf bound_ctrl:0
    v_mov_b32_dpp v203, v213 row_shr:1 row_mask:0xf bank_mask:0xf bound_ctrl:0
    v_mfma_f32_16x16x32_bf16 v[192:195], v[176:179], v[210:213], v[192:195]
    ds_read_b64 v[144:145], v7 offset:3616
    ds_read_b64 v[146:147], v7 offset:3624
    s_waitcnt lgkmcnt(4)
    v_mfma_f32_16x16x32_bf16 v[180:183], v[132:135], v[200:203], v[180:183]
    ds_read_b64 v[148:149], v7 offset:1600
    ds_read_b64 v[150:151], v7 offset:1608
    v_mfma_f32_16x16x32_bf16 v[188:191], v[136:139], v[200:203], v[188:191]
    ds_read_b64 v[152:153], v7 offset:3648
    ds_read_b64 v[154:155], v7 offset:3656
    v_mov_b32_dpp v210, v200 row_shr:1 row_mask:0xf bank_mask:0xf bound_ctrl:0
    v_mov_b32_dpp v211, v201 row_shr:1 row_mask:0xf bank_mask:0xf bound_ctrl:0
    s_waitcnt lgkmcnt(4)
    v_mfma_f32_16x16x32_bf16 v[184:187], v[140:143], v[200:203], v[184:187]
    ds_read_b64 v[156:157], v7 offset:1632
    ds_read_b64 v[158:159], v7 offset:1640
    v_mov_b32_dpp v212, v202 row_shr:1 row_mask:0xf bank_mask:0xf bound_ctrl:0
    v_mov_b32_dpp v213, v203 row_shr:1 row_mask:0xf bank_mask:0xf bound_ctrl:0
    v_mfma_f32_16x16x32_bf16 v[192:195], v[144:147], v[200:203], v[192:195]
    ds_read_b64 v[160:161], v7 offset:3680
    ds_read_b64 v[162:163], v7 offset:3688
    s_waitcnt lgkmcnt(4)
    v_mfma_f32_16x16x32_bf16 v[180:183], v[148:151], v[210:213], v[180:183]
    ds_read_b64 v[164:165], v7 offset:1664
    ds_read_b64 v[166:167], v7 offset:1672
    v_mfma_f32_16x16x32_bf16 v[188:191], v[152:155], v[210:213], v[188:191]
    ds_read_b64 v[168:169], v7 offset:2112
    ds_read_b64 v[170:171], v7 offset:2120
    v_mov_b32_dpp v200, v210 row_shr:1 row_mask:0xf bank_mask:0xf bound_ctrl:0
    v_mov_b32_dpp v201, v211 row_shr:1 row_mask:0xf bank_mask:0xf bound_ctrl:0
    s_waitcnt lgkmcnt(4)
    v_mfma_f32_16x16x32_bf16 v[184:187], v[156:159], v[210:213], v[184:187]
    ds_read_b64 v[172:173], v7 offset:1696
    ds_read_b64 v[174:175], v7 offset:1704
    v_mov_b32_dpp v202, v212 row_shr:1 row_mask:0xf bank_mask:0xf bound_ctrl:0
    v_mov_b32_dpp v203, v213 row_shr:1 row_mask:0xf bank_mask:0xf bound_ctrl:0
    v_mfma_f32_16x16x32_bf16 v[192:195], v[160:163], v[210:213], v[192:195]
    ds_read_b64 v[176:177], v7 offset:2144
    ds_read_b64 v[178:179], v7 offset:2152
    s_waitcnt lgkmcnt(4)
    v_mfma_f32_16x16x32_bf16 v[180:183], v[164:167], v[200:203], v[180:183]
    ds_read_b64 v[132:133], v7 offset:1728
    ds_read_b64 v[134:135], v7 offset:1736
    v_mfma_f32_16x16x32_bf16 v[188:191], v[168:171], v[200:203], v[188:191]
    ds_read_b64 v[136:137], v7 offset:2176
    ds_read_b64 v[138:139], v7 offset:2184
    v_mov_b32_dpp v210, v200 row_shr:1 row_mask:0xf bank_mask:0xf bound_ctrl:0
    v_mov_b32_dpp v211, v201 row_shr:1 row_mask:0xf bank_mask:0xf bound_ctrl:0
    s_waitcnt lgkmcnt(4)
    v_mfma_f32_16x16x32_bf16 v[184:187], v[172:175], v[200:203], v[184:187]
    ds_read_b64 v[140:141], v7 offset:1760
    ds_read_b64 v[142:143], v7 offset:1768
    v_mov_b32_dpp v212, v202 row_shr:1 row_mask:0xf bank_mask:0xf bound_ctrl:0
    v_mov_b32_dpp v213, v203 row_shr:1 row_mask:0xf bank_mask:0xf bound_ctrl:0
    v_mfma_f32_16x16x32_bf16 v[192:195], v[176:179], v[200:203], v[192:195]
    ds_read_b64 v[144:145], v7 offset:2208
    ds_read_b64 v[146:147], v7 offset:2216
    s_waitcnt lgkmcnt(4)
    v_mfma_f32_16x16x32_bf16 v[180:183], v[132:135], v[210:213], v[180:183]
    ds_read_b64 v[148:149], v7 offset:1792
    ds_read_b64 v[150:151], v7 offset:1800
    v_mfma_f32_16x16x32_bf16 v[188:191], v[136:139], v[210:213], v[188:191]
    ds_read_b64 v[152:153], v7 offset:2240
    ds_read_b64 v[154:155], v7 offset:2248
    v_mov_b32_dpp v200, v210 row_shr:1 row_mask:0xf bank_mask:0xf bound_ctrl:0
    v_mov_b32_dpp v201, v211 row_shr:1 row_mask:0xf bank_mask:0xf bound_ctrl:0
    s_waitcnt lgkmcnt(4)
    v_mfma_f32_16x16x32_bf16 v[184:187], v[140:143], v[210:213], v[184:187]
    ds_read_b64 v[156:157], v7 offset:1824
    ds_read_b64 v[158:159], v7 offset:1832
    v_mov_b32_dpp v202, v212 row_shr:1 row_mask:0xf bank_mask:0xf bound_ctrl:0
    v_mov_b32_dpp v203, v213 row_shr:1 row_mask:0xf bank_mask:0xf bound_ctrl:0
    v_mfma_f32_16x16x32_bf16 v[192:195], v[144:147], v[210:213], v[192:195]
    ds_read_b64 v[160:161], v7 offset:2272
    ds_read_b64 v[162:163], v7 offset:2280
    s_waitcnt lgkmcnt(4)
    v_mfma_f32_16x16x32_bf16 v[180:183], v[148:151], v[200:203], v[180:183]
    ds_read_b64 v[164:165], v7 offset:1856
    ds_read_b64 v[166:167], v7 offset:1864
    v_mfma_f32_16x16x32_bf16 v[188:191], v[152:155], v[200:203], v[188:191]
    ds_read_b64 v[168:169], v7 offset:2304
    ds_read_b64 v[170:171], v7 offset:2312
    v_mov_b32_dpp v210, v200 row_shr:1 row_mask:0xf bank_mask:0xf bound_ctrl:0
    v_mov_b32_dpp v211, v201 row_shr:1 row_mask:0xf bank_mask:0xf bound_ctrl:0
    s_waitcnt lgkmcnt(4)
    v_mfma_f32_16x16x32_bf16 v[184:187], v[156:159], v[200:203], v[184:187]
    ds_read_b64 v[172:173], v7 offset:1888
    ds_read_b64 v[174:175], v7 offset:1896
    v_mov_b32_dpp v212, v202 row_shr:1 row_mask:0xf bank_mask:0xf bound_ctrl:0
    v_mov_b32_dpp v213, v203 row_shr:1 row_mask:0xf bank_mask:0xf bound_ctrl:0
    v_mfma_f32_16x16x32_bf16 v[192:195], v[160:163], v[200:203], v[192:195]
    ds_read_b64 v[176:177], v7 offset:2336
    ds_read_b64 v[178:179], v7 offset:2344
    s_waitcnt lgkmcnt(4)
    v_mfma_f32_16x16x32_bf16 v[180:183], v[164:167], v[210:213], v[180:183]
    ds_read_b64 v[132:133], v7 offset:1920
    ds_read_b64 v[134:135], v7 offset:1928
    v_mfma_f32_16x16x32_bf16 v[188:191], v[168:171], v[210:213], v[188:191]
    ds_read_b64 v[136:137], v7 offset:2368
    ds_read_b64 v[138:139], v7 offset:2376
    v_mov_b32_dpp v200, v210 row_shr:1 row_mask:0xf bank_mask:0xf bound_ctrl:0
    v_mov_b32_dpp v201, v211 row_shr:1 row_mask:0xf bank_mask:0xf bound_ctrl:0
    s_waitcnt lgkmcnt(4)
    v_mfma_f32_16x16x32_bf16 v[184:187], v[172:175], v[210:213], v[184:187]
    ds_read_b64 v[140:141], v7 offset:1952
    ds_read_b64 v[142:143], v7 offset:1960
    v_mov_b32_dpp v202, v212 row_shr:1 row_mask:0xf bank_mask:0xf bound_ctrl:0
    v_mov_b32_dpp v203, v213 row_shr:1 row_mask:0xf bank_mask:0xf bound_ctrl:0
    v_mfma_f32_16x16x32_bf16 v[192:195], v[176:179], v[210:213], v[192:195]
    ds_read_b64 v[144:145], v7 offset:2400
    ds_read_b64 v[146:147], v7 offset:2408
    s_waitcnt lgkmcnt(4)
    v_mfma_f32_16x16x32_bf16 v[180:183], v[132:135], v[200:203], v[180:183]
    ds_read_b64 v[148:149], v7 offset:1984
    ds_read_b64 v[150:151], v7 offset:1992
    v_mfma_f32_16x16x32_bf16 v[188:191], v[136:139], v[200:203], v[188:191]
    ds_read_b64 v[152:153], v7 offset:2432
    ds_read_b64 v[154:155], v7 offset:2440
    v_mov_b32_dpp v210, v200 row_shr:1 row_mask:0xf bank_mask:0xf bound_ctrl:0
    v_mov_b32_dpp v211, v201 row_shr:1 row_mask:0xf bank_mask:0xf bound_ctrl:0
    s_waitcnt lgkmcnt(4)
    v_mfma_f32_16x16x32_bf16 v[184:187], v[140:143], v[200:203], v[184:187]
    ds_read_b64 v[156:157], v7 offset:2016
    ds_read_b64 v[158:159], v7 offset:2024
    v_mov_b32_dpp v212, v202 row_shr:1 row_mask:0xf bank_mask:0xf bound_ctrl:0
    v_mov_b32_dpp v213, v203 row_shr:1 row_mask:0xf bank_mask:0xf bound_ctrl:0
    v_mfma_f32_16x16x32_bf16 v[192:195], v[144:147], v[200:203], v[192:195]
    ds_read_b64 v[160:161], v7 offset:2464
    ds_read_b64 v[162:163], v7 offset:2472
    s_waitcnt lgkmcnt(4)
    v_mfma_f32_16x16x32_bf16 v[180:183], v[148:151], v[210:213], v[180:183]
    v_mfma_f32_16x16x32_bf16 v[188:191], v[152:155], v[210:213], v[188:191]
    s_waitcnt lgkmcnt(0)
    v_mfma_f32_16x16x32_bf16 v[184:187], v[156:159], v[210:213], v[184:187]
    v_mfma_f32_16x16x32_bf16 v[192:195], v[160:163], v[210:213], v[192:195]
    s_cmp_lt_u32 s3, 4
    s_cbranch_scc0 CV_pr7
    s_setprio 0
CV_pr7:
CV_p2:
    ds_read_b32 v61, v58 offset:4
    s_waitcnt lgkmcnt(0)
    v_readfirstlane_b32 s54, v61
    s_cmp_lt_u32 s54, 4
    s_cbranch_scc0 CV_p2d
    s_sleep 1
    s_branch CV_p2
CV_p2d:
    ds_read_b64 v[132:133], v7 offset:0
    ds_read_b64 v[134:135], v7 offset:8
    ds_read_b128 v[136:139], v9 offset:0
    ds_read_b64 v[140:141], v7 offset:32
    ds_read_b64 v[142:143], v7 offset:40
    ds_read_b128 v[144:147], v9 offset:32
    ds_read_b64 v[148:149], v7 offset:64
    ds_read_b64 v[150:151], v7 offset:72
    ds_read_b128 v[152:155], v9 offset:80
    ds_read_b64 v[156:157], v7 offset:96
    ds_read_b64 v[158:159], v7 offset:104
    ds_read_b128 v[160:163], v9 offset:112
    ds_read_b64 v[164:165], v7 offset:128
    ds_read_b64 v[166:167], v7 offset:136
    ds_read_b128 v[168:171], v9 offset:160
    s_waitcnt lgkmcnt(12)
    v_mfma_f32_32x32x16_bf16 v[116:131], v[132:135], v[136:139], v[116:131]
    ds_read_b64 v[172:173], v7 offset:160
    ds_read_b64 v[174:175], v7 offset:168
    ds_read_b128 v[176:179], v9 offset:192
    ds_write_b128 v3, v[180:183] offset:7232
    v_mul_u32_u24 v10, 24, v6
    v_sub_u32 v10, v15, v10
    v_add_u32 v10, 8, v10
    v_subrev_u32 v11, 2560, v10
    buffer_load_dwordx4 v[220:223], v52, s[36:39], s17 offen offset:0
    buffer_load_dwordx4 v[224:227], v52, s[36:39], s17 offen offset:1280
    s_waitcnt lgkmcnt(13)
    v_mfma_f32_32x32x16_bf16 v[116:131], v[140:143], v[144:147], v[116:131]
    ds_read_b64 v[132:133], v7 offset:192
    ds_read_b64 v[134:135], v7 offset:200
    ds_read_b128 v[136:139], v9 offset:240
    ds_write_b128 v3, v[184:187] offset:11008
    v_bfe_u32 v42, v1, 1, 3
    v_mul_u32_u24 v42, 81920, v42
    v_and_b32 v43, 1, v1
    v_lshl_add_u32 v42, v43, 6, v42
    buffer_load_dwordx4 v[228:231], v52, s[36:39], s17 offen offset:2560
    buffer_load_dwordx4 v[232:235], v52, s[36:39], s17 offen offset:3840
    s_waitcnt lgkmcnt(14)
    v_mfma_f32_32x32x16_bf16 v[116:131], v[148:151], v[152:155], v[116:131]
    ds_read_b64 v[140:141], v7 offset:224
    ds_read_b64 v[142:143], v7 offset:232
    ds_read_b128 v[144:147], v9 offset:272
    ds_write_b128 v3, v[188:191] offset:14784
    v_bfe_u32 v43, v1, 4, 1
    v_lshl_add_u32 v42, v43, 5, v42
    v_lshl_add_u32 v42, v6, 4, v42
    s_lshl_b32 s42, s24, 7
    buffer_load_dwordx4 v[236:239], v52, s[36:39], s18 offen offset:0
    buffer_load_dwordx4 v[240:243], v52, s[36:39], s18 offen offset:1280
    s_waitcnt lgkmcnt(15)
    v_mfma_f32_32x32x16_bf16 v[116:131], v[156:159], v[160:163], v[116:131]
    ds_read_b64 v[148:149], v7 offset:256
    ds_read_b64 v[150:151], v7 offset:264
    ds_read_b128 v[152:155], v9 offset:320
    ds_write_b128 v3, v[192:195] offset:18560
    s_and_b32 s25, s24, 1
    s_lshl_b32 s25, s25, 4
    s_lshr_b32 s26, s26, s25
    s_lshl_b32 s26, s26, 16
    buffer_load_dwordx4 v[244:247], v52, s[36:39], s18 offen offset:2560
    buffer_load_dwordx4 v[248:251], v52, s[36:39], s18 offen offset:3840
    s_waitcnt lgkmcnt(15)
    v_mfma_f32_32x32x16_bf16 v[116:131], v[164:167], v[168:171], v[116:131]
    ds_read_b64 v[156:157], v7 offset:288
    ds_read_b64 v[158:159], v7 offset:296
    ds_read_b128 v[160:163], v9 offset:352
    s_mov_b32 s30, 0xffff0000
    s_mov_b32 s31, 0xffff0000
    s_mov_b32 s25, 0xffff0000
    v_bfe_u32 v55, v1, 1, 2
    v_lshl_add_u32 v53, v6, 2, v55
    v_lshl_add_u32 v53, v53, 2, v54
    v_and_b32 v55, 1, v1
    v_lshl_add_u32 v53, v53, 1, v55
    v_lshlrev_b32 v53, 4, v53
    s_lshl_b32 s17, s48, 13
    s_add_u32 s18, s17, 4096
    s_add_u32 s32, s6, 0x500000
    s_addc_u32 s33, s7, 0
    s_mov_b32 s34, 0x21c000
    s_mov_b32 s35, 0x00020000
    s_waitcnt lgkmcnt(15)
    v_mfma_f32_32x32x16_bf16 v[116:131], v[172:175], v[176:179], v[116:131]
    ds_read_b64 v[164:165], v7 offset:320
    ds_read_b64 v[166:167], v7 offset:328
    ds_read_b128 v[168:171], v9 offset:400
    ds_read_b128 v[64:67], v49 offset:7232
    s_waitcnt lgkmcnt(15)
    v_mfma_f32_32x32x16_bf16 v[116:131], v[132:135], v[136:139], v[116:131]
    ds_read_b64 v[172:173], v7 offset:352
    ds_read_b64 v[174:175], v7 offset:360
    ds_read_b128 v[176:179], v9 offset:432
    ds_read_b128 v[68:71], v49 offset:7744
    s_waitcnt lgkmcnt(15)
    v_mfma_f32_32x32x16_bf16 v[116:131], v[140:143], v[144:147], v[116:131]
    ds_read_b64 v[132:133], v7 offset:384
    ds_read_b64 v[134:135], v7 offset:392
    ds_read_b128 v[136:139], v9 offset:480
    ds_read_b128 v[72:75], v49 offset:11008
    s_waitcnt lgkmcnt(15)
    v_mfma_f32_32x32x16_bf16 v[116:131], v[148:151], v[152:155], v[116:131]
    ds_read_b64 v[140:141], v7 offset:416
    ds_read_b64 v[142:143], v7 offset:424
    ds_read_b128 v[144:147], v9 offset:512
    ds_read_b128 v[76:79], v49 offset:11520
    s_cmp_ge_u32 s48, 270
    s_cbranch_scc1 CV_nw2
    s_waitcnt vmcnt(0)
    v_perm_b32 v16, v224, v220, s50
    v_perm_b32 v17, v232, v228, s50
    v_perm_b32 v18, v240, v236, s50
    v_perm_b32 v19, v248, v244, s50
    buffer_store_dwordx4 v[16:19], v53, s[32:35], s17 offen offset:0 sc1
    v_perm_b32 v20, v224, v220, s51
    v_perm_b32 v21, v232, v228, s51
    v_perm_b32 v22, v240, v236, s51
    v_perm_b32 v23, v248, v244, s51
    v_xor_b32 v33, 16, v53
    buffer_store_dwordx4 v[20:23], v33, s[32:35], s17 offen offset:1024 sc1
    v_perm_b32 v24, v225, v221, s50
    v_perm_b32 v25, v233, v229, s50
    v_perm_b32 v26, v241, v237, s50
    v_perm_b32 v27, v249, v245, s50
    v_xor_b32 v34, 32, v53
    buffer_store_dwordx4 v[24:27], v34, s[32:35], s17 offen offset:2048 sc1
    v_perm_b32 v28, v225, v221, s51
    v_perm_b32 v29, v233, v229, s51
    v_perm_b32 v30, v241, v237, s51
    v_perm_b32 v31, v249, v245, s51
    v_xor_b32 v35, 48, v53
    buffer_store_dwordx4 v[28:31], v35, s[32:35], s17 offen offset:3072 sc1
    v_perm_b32 v196, v226, v222, s50
    v_perm_b32 v197, v234, v230, s50
    v_perm_b32 v198, v242, v238, s50
    v_perm_b32 v199, v250, v246, s50
    v_xor_b32 v36, 64, v53
    buffer_store_dwordx4 v[196:199], v36, s[32:35], s18 offen offset:0 sc1
    v_perm_b32 v200, v226, v222, s51
    v_perm_b32 v201, v234, v230, s51
    v_perm_b32 v202, v242, v238, s51
    v_perm_b32 v203, v250, v246, s51
    v_xor_b32 v37, 80, v53
    buffer_store_dwordx4 v[200:203], v37, s[32:35], s18 offen offset:1024 sc1
    v_perm_b32 v204, v227, v223, s50
    v_perm_b32 v205, v235, v231, s50
    v_perm_b32 v206, v243, v239, s50
    v_perm_b32 v207, v251, v247, s50
    v_xor_b32 v38, 96, v53
    buffer_store_dwordx4 v[204:207], v38, s[32:35], s18 offen offset:2048 sc1
    v_perm_b32 v208, v227, v223, s51
    v_perm_b32 v209, v235, v231, s51
    v_perm_b32 v210, v243, v239, s51
    v_perm_b32 v211, v251, v247, s51
    v_xor_b32 v39, 112, v53
    buffer_store_dwordx4 v[208:211], v39, s[32:35], s18 offen offset:3072 sc1
    CV_nw2:
    s_waitcnt lgkmcnt(15)
    v_mfma_f32_32x32x16_bf16 v[116:131], v[156:159], v[160:163], v[116:131]
    ds_read_b64 v[148:149], v7 offset:448
    ds_read_b64 v[150:151], v7 offset:456
    ds_read_b128 v[152:155], v9 offset:560
    ds_read_b128 v[80:83], v49 offset:14784
    s_waitcnt lgkmcnt(15)
    v_mfma_f32_32x32x16_bf16 v[116:131], v[164:167], v[168:171], v[116:131]
    ds_read_b64 v[156:157], v7 offset:480
    ds_read_b64 v[158:159], v7 offset:488
    ds_read_b128 v[160:163], v9 offset:592
    ds_read_b128 v[84:87], v49 offset:15296
    s_waitcnt lgkmcnt(15)
    v_mfma_f32_32x32x16_bf16 v[116:131], v[172:175], v[176:179], v[116:131]
    ds_read_b64 v[164:165], v7 offset:512
    ds_read_b64 v[166:167], v7 offset:520
    ds_read_b128 v[168:171], v9 offset:640
    ds_read_b128 v[88:91], v49 offset:18560
    s_waitcnt lgkmcnt(15)
    v_mfma_f32_32x32x16_bf16 v[116:131], v[132:135], v[136:139], v[116:131]
    ds_read_b64 v[172:173], v7 offset:544
    ds_read_b64 v[174:175], v7 offset:552
    ds_read_b128 v[176:179], v9 offset:672
    ds_read_b128 v[92:95], v49 offset:19072
    s_waitcnt lgkmcnt(15)
    v_mfma_f32_32x32x16_bf16 v[116:131], v[140:143], v[144:147], v[116:131]
    ds_read_b64 v[132:133], v7 offset:576
    ds_read_b64 v[134:135], v7 offset:584
    ds_read_b128 v[136:139], v9 offset:720
    ds_read_b64 v[180:181], v10 offset:48
    ds_read_b64 v[182:183], v10 offset:32
    ds_read_b64 v[184:185], v10 offset:16
    s_waitcnt lgkmcnt(15)
    v_mfma_f32_32x32x16_bf16 v[116:131], v[148:151], v[152:155], v[116:131]
    ds_read_b64 v[140:141], v7 offset:608
    ds_read_b64 v[142:143], v7 offset:616
    ds_read_b128 v[144:147], v9 offset:752
    ds_read_b64 v[186:187], v10 offset:0
    ds_read_b64 v[188:189], v11 offset:48
    ds_read_b64 v[190:191], v11 offset:32
    v_mfma_f32_32x32x16_bf16 v[116:131], v[156:159], v[160:163], v[116:131]
    ds_read_b64 v[148:149], v7 offset:640
    ds_read_b64 v[150:151], v7 offset:648
    ds_read_b128 v[152:155], v9 offset:800
    ds_read_b64 v[192:193], v11 offset:16
    ds_read_b64 v[194:195], v11 offset:0
    s_waitcnt lgkmcnt(15)
    v_mfma_f32_32x32x16_bf16 v[116:131], v[164:167], v[168:171], v[116:131]
    ds_read_b64 v[156:157], v7 offset:672
    ds_read_b64 v[158:159], v7 offset:680
    ds_read_b128 v[160:163], v9 offset:832
    s_mov_b64 exec, s[30:31]
    v_add_f32 v100, v100, v64
    v_add_f32 v101, v101, v65
    v_add_f32 v102, v102, v66
    v_add_f32 v103, v103, v67
    s_mov_b64 exec, -1
    v_mfma_f32_32x32x16_bf16 v[116:131], v[172:175], v[176:179], v[116:131]
    ds_read_b64 v[164:165], v7 offset:704
    ds_read_b64 v[166:167], v7 offset:712
    ds_read_b128 v[168:171], v9 offset:880
    s_mov_b64 exec, s[30:31]
    v_add_f32 v104, v104, v68
    v_add_f32 v105, v105, v69
    v_add_f32 v106, v106, v70
    v_add_f32 v107, v107, v71
    s_mov_b64 exec, -1
    s_waitcnt lgkmcnt(15)
    v_mfma_f32_32x32x16_bf16 v[116:131], v[132:135], v[136:139], v[116:131]
    ds_read_b64 v[172:173], v7 offset:736
    ds_read_b64 v[174:175], v7 offset:744
    ds_read_b128 v[176:179], v9 offset:912
    s_mov_b64 exec, s[30:31]
    v_add_f32 v108, v108, v72
    v_add_f32 v109, v109, v73
    v_add_f32 v110, v110, v74
    v_add_f32 v111, v111, v75
    s_mov_b64 exec, -1
    s_waitcnt lgkmcnt(15)
    v_mfma_f32_32x32x16_bf16 v[116:131], v[140:143], v[144:147], v[116:131]
    ds_read_b64 v[132:133], v7 offset:768
    ds_read_b64 v[134:135], v7 offset:776
    ds_read_b128 v[136:139], v9 offset:960
    s_mov_b64 exec, s[30:31]
    v_add_f32 v112, v112, v76
    v_add_f32 v113, v113, v77
    v_add_f32 v114, v114, v78
    v_add_f32 v115, v115, v79
    s_mov_b64 exec, -1
    s_waitcnt vmcnt(0)
    s_waitcnt lgkmcnt(14)
    v_mfma_f32_32x32x16_bf16 v[116:131], v[148:151], v[152:155], v[116:131]
    ds_read_b64 v[140:141], v7 offset:800
    ds_read_b64 v[142:143], v7 offset:808
    ds_read_b128 v[144:147], v9 offset:992
    v_and_b32 v196, s25, v181
    v_lshlrev_b32 v197, 16, v181
    v_and_b32 v198, s25, v180
    v_lshlrev_b32 v199, 16, v180
    v_mul_f32 v196, s26, v196
    v_mul_f32 v197, s26, v197
    v_mul_f32 v198, s26, v198
    v_mul_f32 v199, s26, v199
    v_cvt_pk_bf16_f32 v196, 0, v196
    v_cvt_pk_bf16_f32 v197, 0, v197
    v_cvt_pk_bf16_f32 v198, 0, v198
    v_cvt_pk_bf16_f32 v199, 0, v199
    s_nop 1
PGS_c_2:
    s_cbranch_execz PGR_c
    s_mov_b64 exec, s[30:31]
    v_add_f32 v116, v116, v80
    v_add_f32 v117, v117, v81
    v_add_f32 v118, v118, v82
    v_add_f32 v119, v119, v83
    v_add_f32 v120, v120, v84
    v_add_f32 v121, v121, v85
    v_add_f32 v122, v122, v86
    v_add_f32 v123, v123, v87
    v_add_f32 v124, v124, v88
    v_add_f32 v125, v125, v89
    v_add_f32 v126, v126, v90
    v_add_f32 v127, v127, v91
    v_add_f32 v128, v128, v92
    v_add_f32 v129, v129, v93
    v_add_f32 v130, v130, v94
    v_add_f32 v131, v131, v95
    s_mov_b64 exec, -1
    s_nop 0
    s_waitcnt lgkmcnt(12)
    v_mfma_f32_32x32x16_bf16 v[116:131], v[156:159], v[160:163], v[116:131]
    ds_read_b64 v[148:149], v7 offset:832
    ds_read_b64 v[150:151], v7 offset:840
    ds_read_b128 v[152:155], v9 offset:1040
    v_and_b32 v200, s25, v183
    v_lshlrev_b32 v201, 16, v183
    v_and_b32 v202, s25, v182
    v_lshlrev_b32 v203, 16, v182
    v_mul_f32 v200, s26, v200
    s_waitcnt lgkmcnt(12)
    v_mfma_f32_32x32x16_bf16 v[116:131], v[164:167], v[168:171], v[116:131]
    ds_read_b64 v[156:157], v7 offset:864
    ds_read_b64 v[158:159], v7 offset:872
    ds_read_b128 v[160:163], v9 offset:1072
    v_mul_f32 v201, s26, v201
    v_mul_f32 v202, s26, v202
    v_mul_f32 v203, s26, v203
    v_cvt_pk_bf16_f32 v200, 0, v200
    v_cvt_pk_bf16_f32 v201, 0, v201
    s_waitcnt lgkmcnt(12)
    v_mfma_f32_32x32x16_bf16 v[116:131], v[172:175], v[176:179], v[116:131]
    ds_read_b64 v[164:165], v7 offset:896
    ds_read_b64 v[166:167], v7 offset:904
    ds_read_b128 v[168:171], v9 offset:1120
    v_cvt_pk_bf16_f32 v202, 0, v202
    v_cvt_pk_bf16_f32 v203, 0, v203
    v_and_b32 v204, s25, v185
    v_lshlrev_b32 v205, 16, v185
    v_and_b32 v206, s25, v184
    s_waitcnt lgkmcnt(12)
    v_mfma_f32_32x32x16_bf16 v[116:131], v[132:135], v[136:139], v[116:131]
    ds_read_b64 v[172:173], v7 offset:928
    ds_read_b64 v[174:175], v7 offset:936
    ds_read_b128 v[176:179], v9 offset:1152
    v_lshlrev_b32 v207, 16, v184
    v_mul_f32 v204, s26, v204
    v_mul_f32 v205, s26, v205
    v_mul_f32 v206, s26, v206
    v_mul_f32 v207, s26, v207
    s_waitcnt lgkmcnt(12)
    v_mfma_f32_32x32x16_bf16 v[116:131], v[140:143], v[144:147], v[116:131]
    ds_read_b64 v[132:133], v7 offset:960
    ds_read_b64 v[134:135], v7 offset:968
    ds_read_b128 v[136:139], v9 offset:1200
    v_cvt_pk_bf16_f32 v204, 0, v204
    v_cvt_pk_bf16_f32 v205, 0, v205
    v_cvt_pk_bf16_f32 v206, 0, v206
    v_cvt_pk_bf16_f32 v207, 0, v207
    v_and_b32 v208, s25, v187
    s_waitcnt lgkmcnt(12)
    v_mfma_f32_32x32x16_bf16 v[116:131], v[148:151], v[152:155], v[116:131]
    ds_read_b64 v[140:141], v7 offset:992
    ds_read_b64 v[142:143], v7 offset:1000
    ds_read_b128 v[144:147], v9 offset:1232
    v_lshlrev_b32 v209, 16, v187
    v_and_b32 v210, s25, v186
    v_lshlrev_b32 v211, 16, v186
    v_mul_f32 v208, s26, v208
    v_mul_f32 v209, s26, v209
    s_waitcnt lgkmcnt(12)
    v_mfma_f32_32x32x16_bf16 v[116:131], v[156:159], v[160:163], v[116:131]
    ds_read_b64 v[148:149], v7 offset:1024
    ds_read_b64 v[150:151], v7 offset:1032
    ds_read_b128 v[152:155], v9 offset:1280
    v_mul_f32 v210, s26, v210
    v_mul_f32 v211, s26, v211
    v_cvt_pk_bf16_f32 v208, 0, v208
    v_cvt_pk_bf16_f32 v209, 0, v209
    v_cvt_pk_bf16_f32 v210, 0, v210
    s_waitcnt lgkmcnt(12)
    v_mfma_f32_32x32x16_bf16 v[116:131], v[164:167], v[168:171], v[116:131]
    ds_read_b64 v[156:157], v7 offset:1056
    ds_read_b64 v[158:159], v7 offset:1064
    ds_read_b128 v[160:163], v9 offset:1312
    v_cvt_pk_bf16_f32 v211, 0, v211
    v_cvt_pk_bf16_f32 v100, 0, v100
    v_cvt_pk_bf16_f32 v101, 0, v101
    v_cvt_pk_bf16_f32 v102, 0, v102
    v_cvt_pk_bf16_f32 v103, 0, v103
    s_waitcnt lgkmcnt(12)
    v_mfma_f32_32x32x16_bf16 v[116:131], v[172:175], v[176:179], v[116:131]
    ds_read_b64 v[164:165], v7 offset:1088
    ds_read_b64 v[166:167], v7 offset:1096
    ds_read_b128 v[168:171], v9 offset:1360
    v_cvt_pk_bf16_f32 v104, 0, v104
    v_cvt_pk_bf16_f32 v105, 0, v105
    v_cvt_pk_bf16_f32 v106, 0, v106
    v_cvt_pk_bf16_f32 v107, 0, v107
    v_cvt_pk_bf16_f32 v108, 0, v108
    s_waitcnt lgkmcnt(12)
    v_mfma_f32_32x32x16_bf16 v[116:131], v[132:135], v[136:139], v[116:131]
    ds_read_b64 v[172:173], v7 offset:1120
    ds_read_b64 v[174:175], v7 offset:1128
    ds_read_b128 v[176:179], v9 offset:1392
    v_cvt_pk_bf16_f32 v109, 0, v109
    v_cvt_pk_bf16_f32 v110, 0, v110
    v_cvt_pk_bf16_f32 v111, 0, v111
    v_cvt_pk_bf16_f32 v112, 0, v112
    v_cvt_pk_bf16_f32 v113, 0, v113
    s_waitcnt lgkmcnt(12)
    v_mfma_f32_32x32x16_bf16 v[116:131], v[140:143], v[144:147], v[116:131]
    ds_read_b64 v[132:133], v7 offset:1152
    ds_read_b64 v[134:135], v7 offset:1160
    ds_read_b128 v[136:139], v9 offset:1440
    v_cvt_pk_bf16_f32 v114, 0, v114
    v_cvt_pk_bf16_f32 v115, 0, v115
    v_add_f32 v100, v196, v100
    v_add_f32 v101, v197, v101
    v_add_f32 v102, v198, v102
    s_waitcnt lgkmcnt(12)
    v_mfma_f32_32x32x16_bf16 v[116:131], v[148:151], v[152:155], v[116:131]
    ds_read_b64 v[140:141], v7 offset:1184
    ds_read_b64 v[142:143], v7 offset:1192
    ds_read_b128 v[144:147], v9 offset:1472
    v_add_f32 v103, v199, v103
    v_add_f32 v104, v200, v104
    v_add_f32 v105, v201, v105
    v_add_f32 v106, v202, v106
    v_add_f32 v107, v203, v107
    s_waitcnt lgkmcnt(12)
    v_mfma_f32_32x32x16_bf16 v[116:131], v[156:159], v[160:163], v[116:131]
    ds_read_b64 v[148:149], v7 offset:1216
    ds_read_b64 v[150:151], v7 offset:1224
    ds_read_b128 v[152:155], v9 offset:1520
    v_add_f32 v108, v204, v108
    v_add_f32 v109, v205, v109
    v_add_f32 v110, v206, v110
    v_add_f32 v111, v207, v111
    v_add_f32 v112, v208, v112
    s_waitcnt lgkmcnt(12)
    v_mfma_f32_32x32x16_bf16 v[116:131], v[164:167], v[168:171], v[116:131]
    ds_read_b64 v[156:157], v7 offset:1248
    ds_read_b64 v[158:159], v7 offset:1256
    ds_read_b128 v[160:163], v9 offset:1552
    v_add_f32 v113, v209, v113
    v_add_f32 v114, v210, v114
    v_add_f32 v115, v211, v115
    v_cvt_pk_bf16_f32 v32, v100, v101
    v_cvt_pk_bf16_f32 v33, v102, v103
    s_waitcnt lgkmcnt(12)
    v_mfma_f32_32x32x16_bf16 v[116:131], v[172:175], v[176:179], v[116:131]
    ds_read_b64 v[164:165], v7 offset:1280
    ds_read_b64 v[166:167], v7 offset:1288
    ds_read_b128 v[168:171], v9 offset:1600
    v_cvt_pk_bf16_f32 v34, v104, v105
    v_cvt_pk_bf16_f32 v35, v106, v107
    v_cvt_pk_bf16_f32 v36, v108, v109
    v_cvt_pk_bf16_f32 v37, v110, v111
    v_cvt_pk_bf16_f32 v38, v112, v113
    s_waitcnt lgkmcnt(12)
    v_mfma_f32_32x32x16_bf16 v[116:131], v[132:135], v[136:139], v[116:131]
    ds_read_b64 v[172:173], v7 offset:1312
    ds_read_b64 v[174:175], v7 offset:1320
    ds_read_b128 v[176:179], v9 offset:1632
    v_cvt_pk_bf16_f32 v39, v114, v115
    s_nop 0
    v_permlane32_swap_b32 v32, v34
    v_permlane32_swap_b32 v33, v35
    v_permlane32_swap_b32 v36, v38
    s_waitcnt lgkmcnt(12)
    v_mfma_f32_32x32x16_bf16 v[116:131], v[140:143], v[144:147], v[116:131]
    ds_read_b64 v[132:133], v7 offset:1344
    ds_read_b64 v[134:135], v7 offset:1352
    ds_read_b128 v[136:139], v9 offset:1680
    v_permlane32_swap_b32 v37, v39
    s_nop 1
    v_permlane16_swap_b32 v32, v36
    v_permlane16_swap_b32 v33, v37
    v_permlane16_swap_b32 v34, v38
    s_waitcnt lgkmcnt(12)
    v_mfma_f32_32x32x16_bf16 v[116:131], v[148:151], v[152:155], v[116:131]
    ds_read_b64 v[140:141], v7 offset:1376
    ds_read_b64 v[142:143], v7 offset:1384
    ds_read_b128 v[144:147], v9 offset:1712
    v_permlane16_swap_b32 v35, v39
    buffer_store_dwordx4 v[32:35], v42, s[20:23], s42 offen sc1
    s_add_u32 s42, s42, 655360
    buffer_store_dwordx4 v[36:39], v42, s[20:23], s42 offen sc1
    s_add_u32 s42, s42, 655360
    s_waitcnt lgkmcnt(12)
    v_mfma_f32_32x32x16_bf16 v[116:131], v[156:159], v[160:163], v[116:131]
    ds_read_b64 v[148:149], v7 offset:1408
    ds_read_b64 v[150:151], v7 offset:1416
    ds_read_b128 v[152:155], v9 offset:1760
    v_and_b32 v212, s25, v189
    v_lshlrev_b32 v213, 16, v189
    v_and_b32 v214, s25, v188
    v_lshlrev_b32 v215, 16, v188
    s_waitcnt lgkmcnt(12)
    v_mfma_f32_32x32x16_bf16 v[116:131], v[164:167], v[168:171], v[116:131]
    ds_read_b64 v[156:157], v7 offset:1440
    ds_read_b64 v[158:159], v7 offset:1448
    ds_read_b128 v[160:163], v9 offset:1792
    v_mul_f32 v212, s26, v212
    v_mul_f32 v213, s26, v213
    v_mul_f32 v214, s26, v214
    v_mul_f32 v215, s26, v215
    v_cvt_pk_bf16_f32 v212, 0, v212
    s_waitcnt lgkmcnt(12)
    v_mfma_f32_32x32x16_bf16 v[116:131], v[172:175], v[176:179], v[116:131]
    ds_read_b64 v[164:165], v7 offset:1472
    ds_read_b64 v[166:167], v7 offset:1480
    ds_read_b128 v[168:171], v9 offset:1840
    v_cvt_pk_bf16_f32 v213, 0, v213
    v_cvt_pk_bf16_f32 v214, 0, v214
    v_cvt_pk_bf16_f32 v215, 0, v215
    v_and_b32 v216, s25, v191
    v_lshlrev_b32 v217, 16, v191
    s_waitcnt lgkmcnt(12)
    v_mfma_f32_32x32x16_bf16 v[116:131], v[132:135], v[136:139], v[116:131]
    ds_read_b64 v[172:173], v7 offset:1504
    ds_read_b64 v[174:175], v7 offset:1512
    ds_read_b128 v[176:179], v9 offset:1872
    v_and_b32 v218, s25, v190
    v_lshlrev_b32 v219, 16, v190
    v_mul_f32 v216, s26, v216
    v_mul_f32 v217, s26, v217
    v_mul_f32 v218, s26, v218
    s_waitcnt lgkmcnt(12)
    v_mfma_f32_32x32x16_bf16 v[116:131], v[140:143], v[144:147], v[116:131]
    ds_read_b64 v[132:133], v7 offset:1536
    ds_read_b64 v[134:135], v7 offset:1544
    ds_read_b128 v[136:139], v9 offset:1920
    v_mul_f32 v219, s26, v219
    v_cvt_pk_bf16_f32 v216, 0, v216
    v_cvt_pk_bf16_f32 v217, 0, v217
    v_cvt_pk_bf16_f32 v218, 0, v218
    v_cvt_pk_bf16_f32 v219, 0, v219
    s_waitcnt lgkmcnt(12)
    v_mfma_f32_32x32x16_bf16 v[116:131], v[148:151], v[152:155], v[116:131]
    ds_read_b64 v[140:141], v7 offset:1568
    ds_read_b64 v[142:143], v7 offset:1576
    ds_read_b128 v[144:147], v9 offset:1952
    v_and_b32 v220, s25, v193
    v_lshlrev_b32 v221, 16, v193
    v_and_b32 v222, s25, v192
    v_lshlrev_b32 v223, 16, v192
    v_mul_f32 v220, s26, v220
    s_waitcnt lgkmcnt(12)
    v_mfma_f32_32x32x16_bf16 v[116:131], v[156:159], v[160:163], v[116:131]
    ds_read_b64 v[148:149], v7 offset:1600
    ds_read_b64 v[150:151], v7 offset:1608
    ds_read_b128 v[152:155], v9 offset:2000
    v_mul_f32 v221, s26, v221
    v_mul_f32 v222, s26, v222
    v_mul_f32 v223, s26, v223
    v_cvt_pk_bf16_f32 v220, 0, v220
    v_cvt_pk_bf16_f32 v221, 0, v221
    s_waitcnt lgkmcnt(12)
    v_mfma_f32_32x32x16_bf16 v[116:131], v[164:167], v[168:171], v[116:131]
    ds_read_b64 v[156:157], v7 offset:1632
    ds_read_b64 v[158:159], v7 offset:1640
    ds_read_b128 v[160:163], v9 offset:2032
    v_cvt_pk_bf16_f32 v222, 0, v222
    v_cvt_pk_bf16_f32 v223, 0, v223
    v_and_b32 v224, s25, v195
    v_lshlrev_b32 v225, 16, v195
    v_and_b32 v226, s25, v194
    s_waitcnt lgkmcnt(12)
    v_mfma_f32_32x32x16_bf16 v[116:131], v[172:175], v[176:179], v[116:131]
    ds_read_b64 v[164:165], v7 offset:1664
    ds_read_b64 v[166:167], v7 offset:1672
    ds_read_b128 v[168:171], v9 offset:2080
    v_lshlrev_b32 v227, 16, v194
    v_mul_f32 v224, s26, v224
    v_mul_f32 v225, s26, v225
    v_mul_f32 v226, s26, v226
    v_mul_f32 v227, s26, v227
    s_waitcnt lgkmcnt(12)
    v_mfma_f32_32x32x16_bf16 v[116:131], v[132:135], v[136:139], v[116:131]
    ds_read_b64 v[172:173], v7 offset:1696
    ds_read_b64 v[174:175], v7 offset:1704
    ds_read_b128 v[176:179], v9 offset:2112
    v_cvt_pk_bf16_f32 v224, 0, v224
    v_cvt_pk_bf16_f32 v225, 0, v225
    v_cvt_pk_bf16_f32 v226, 0, v226
    v_cvt_pk_bf16_f32 v227, 0, v227
    s_waitcnt lgkmcnt(12)
    v_mfma_f32_32x32x16_bf16 v[116:131], v[140:143], v[144:147], v[116:131]
    ds_read_b64 v[132:133], v7 offset:1728
    ds_read_b64 v[134:135], v7 offset:1736
    ds_read_b128 v[136:139], v9 offset:2160
    s_waitcnt lgkmcnt(12)
    v_mfma_f32_32x32x16_bf16 v[116:131], v[148:151], v[152:155], v[116:131]
    ds_read_b64 v[140:141], v7 offset:1760
    ds_read_b64 v[142:143], v7 offset:1768
    ds_read_b128 v[144:147], v9 offset:2192
    s_waitcnt lgkmcnt(12)
    v_mfma_f32_32x32x16_bf16 v[116:131], v[156:159], v[160:163], v[116:131]
    ds_read_b64 v[148:149], v7 offset:1792
    ds_read_b64 v[150:151], v7 offset:1800
    ds_read_b128 v[152:155], v9 offset:2240
    s_waitcnt lgkmcnt(12)
    v_mfma_f32_32x32x16_bf16 v[116:131], v[164:167], v[168:171], v[116:131]
    ds_read_b64 v[156:157], v7 offset:1824
    ds_read_b64 v[158:159], v7 offset:1832
    ds_read_b128 v[160:163], v9 offset:2272
    s_waitcnt lgkmcnt(12)
    v_mfma_f32_32x32x16_bf16 v[116:131], v[172:175], v[176:179], v[116:131]
    ds_read_b64 v[164:165], v7 offset:1856
    ds_read_b64 v[166:167], v7 offset:1864
    ds_read_b128 v[168:171], v9 offset:2320
    s_waitcnt lgkmcnt(12)
    v_mfma_f32_32x32x16_bf16 v[116:131], v[132:135], v[136:139], v[116:131]
    ds_read_b64 v[172:173], v7 offset:1888
    ds_read_b64 v[174:175], v7 offset:1896
    ds_read_b128 v[176:179], v9 offset:2352
    s_waitcnt lgkmcnt(12)
    v_mfma_f32_32x32x16_bf16 v[116:131], v[140:143], v[144:147], v[116:131]
    ds_read_b64 v[132:133], v7 offset:1920
    ds_read_b64 v[134:135], v7 offset:1928
    ds_read_b128 v[136:139], v9 offset:2400
    s_waitcnt lgkmcnt(12)
    v_mfma_f32_32x32x16_bf16 v[116:131], v[148:151], v[152:155], v[116:131]
    ds_read_b64 v[140:141], v7 offset:1952
    ds_read_b64 v[142:143], v7 offset:1960
    ds_read_b128 v[144:147], v9 offset:2432
    s_waitcnt lgkmcnt(12)
    v_mfma_f32_32x32x16_bf16 v[116:131], v[156:159], v[160:163], v[116:131]
    ds_read_b64 v[148:149], v7 offset:1984
    ds_read_b64 v[150:151], v7 offset:1992
    ds_read_b128 v[152:155], v9 offset:2480
    s_waitcnt lgkmcnt(12)
    v_mfma_f32_32x32x16_bf16 v[116:131], v[164:167], v[168:171], v[116:131]
    ds_read_b64 v[156:157], v7 offset:2016
    ds_read_b64 v[158:159], v7 offset:2024
    ds_read_b128 v[160:163], v9 offset:2512
    s_waitcnt lgkmcnt(12)
    v_mfma_f32_32x32x16_bf16 v[116:131], v[172:175], v[176:179], v[116:131]
    s_waitcnt lgkmcnt(9)
    v_mfma_f32_32x32x16_bf16 v[116:131], v[132:135], v[136:139], v[116:131]
    s_waitcnt lgkmcnt(6)
    v_mfma_f32_32x32x16_bf16 v[116:131], v[140:143], v[144:147], v[116:131]
    s_waitcnt lgkmcnt(3)
    v_mfma_f32_32x32x16_bf16 v[116:131], v[148:151], v[152:155], v[116:131]
    s_waitcnt lgkmcnt(0)
    v_mfma_f32_32x32x16_bf16 v[116:131], v[156:159], v[160:163], v[116:131]
    s_nop 7
    s_nop 4
    v_cvt_pk_bf16_f32 v116, 0, v116
    v_cvt_pk_bf16_f32 v117, 0, v117
    v_cvt_pk_bf16_f32 v118, 0, v118
    v_cvt_pk_bf16_f32 v119, 0, v119
    v_cvt_pk_bf16_f32 v120, 0, v120
    v_cvt_pk_bf16_f32 v121, 0, v121
    v_cvt_pk_bf16_f32 v122, 0, v122
    v_cvt_pk_bf16_f32 v123, 0, v123
    v_cvt_pk_bf16_f32 v124, 0, v124
    v_cvt_pk_bf16_f32 v125, 0, v125
    v_cvt_pk_bf16_f32 v126, 0, v126
    v_cvt_pk_bf16_f32 v127, 0, v127
    v_cvt_pk_bf16_f32 v128, 0, v128
    v_cvt_pk_bf16_f32 v129, 0, v129
    v_cvt_pk_bf16_f32 v130, 0, v130
    v_cvt_pk_bf16_f32 v131, 0, v131
    v_add_f32 v116, v212, v116
    v_add_f32 v117, v213, v117
    v_add_f32 v118, v214, v118
    v_add_f32 v119, v215, v119
    v_add_f32 v120, v216, v120
    v_add_f32 v121, v217, v121
    v_add_f32 v122, v218, v122
    v_add_f32 v123, v219, v123
    v_add_f32 v124, v220, v124
    v_add_f32 v125, v221, v125
    v_add_f32 v126, v222, v126
    v_add_f32 v127, v223, v127
    v_add_f32 v128, v224, v128
    v_add_f32 v129, v225, v129
    v_add_f32 v130, v226, v130
    v_add_f32 v131, v227, v131
    v_cvt_pk_bf16_f32 v44, v116, v117
    v_cvt_pk_bf16_f32 v45, v118, v119
    v_cvt_pk_bf16_f32 v46, v120, v121
    v_cvt_pk_bf16_f32 v47, v122, v123
    v_cvt_pk_bf16_f32 v48, v124, v125
    v_cvt_pk_bf16_f32 v49, v126, v127
    v_cvt_pk_bf16_f32 v50, v128, v129
    v_cvt_pk_bf16_f32 v51, v130, v131
    s_nop 0
    v_permlane32_swap_b32 v44, v46
    v_permlane32_swap_b32 v45, v47
    v_permlane32_swap_b32 v48, v50
    v_permlane32_swap_b32 v49, v51
    s_nop 1
    v_permlane16_swap_b32 v44, v48
    v_permlane16_swap_b32 v45, v49
    v_permlane16_swap_b32 v46, v50
    v_permlane16_swap_b32 v47, v51
    buffer_store_dwordx4 v[44:47], v42, s[20:23], s42 offen sc1
    s_add_u32 s42, s42, 655360
    buffer_store_dwordx4 v[48:51], v42, s[20:23], s42 offen sc1
    s_endpgm
M_wdt:
    s_waitcnt lgkmcnt(0)
    s_sub_u32 s26, s3, 6
    s_mul_i32 s27, s26, 176
    s_sub_u32 s27, s24, s27
    s_lshl_b32 s26, s26, 3
    s_add_u32 s26, s26, 56
    s_load_dwordx2 s[28:29], s[0:1], s26
    s_mul_i32 s27, s27, 12800
    s_mov_b32 s30, 2211840
    s_mov_b32 s31, 0x00020000
    v_and_b32 v1, 63, v0
    v_lshlrev_b32 v1, 4, v1
    s_waitcnt lgkmcnt(0)
    buffer_load_dwordx4 v[100:103], v1, s[28:31], s27 offen
    s_add_u32 s27, s27, 1024
    buffer_load_dwordx4 v[104:107], v1, s[28:31], s27 offen
    s_add_u32 s27, s27, 1024
    buffer_load_dwordx4 v[108:111], v1, s[28:31], s27 offen
    s_add_u32 s27, s27, 1024
    buffer_load_dwordx4 v[112:115], v1, s[28:31], s27 offen
    s_add_u32 s27, s27, 1024
    buffer_load_dwordx4 v[116:119], v1, s[28:31], s27 offen
    s_add_u32 s27, s27, 1024
    buffer_load_dwordx4 v[120:123], v1, s[28:31], s27 offen
    s_add_u32 s27, s27, 1024
    buffer_load_dwordx4 v[124:127], v1, s[28:31], s27 offen
    s_add_u32 s27, s27, 1024
    buffer_load_dwordx4 v[128:131], v1, s[28:31], s27 offen
    s_add_u32 s27, s27, 1024
    buffer_load_dwordx4 v[132:135], v1, s[28:31], s27 offen
    s_add_u32 s27, s27, 1024
    buffer_load_dwordx4 v[136:139], v1, s[28:31], s27 offen
    s_add_u32 s27, s27, 1024
    buffer_load_dwordx4 v[140:143], v1, s[28:31], s27 offen
    s_add_u32 s27, s27, 1024
    buffer_load_dwordx4 v[144:147], v1, s[28:31], s27 offen
    s_add_u32 s27, s27, 1024
    buffer_load_dwordx4 v[148:151], v1, s[28:31], s27 offen
    s_add_u32 s27, s27, 1024
    s_cmp_ge_u32 s24, 270
    s_cbranch_scc1 M_exitb
    s_load_dwordx2 s[4:5], s[0:1], 72
    s_mul_i32 s17, s24, 0xCCCD
    s_lshr_b32 s17, s17, 19
    s_mul_i32 s18, s17, 10
    s_sub_u32 s18, s24, s18
    v_and_b32 v1, 7, v0
    v_bfe_u32 v2, v0, 3, 2
    v_bfe_u32 v6, v0, 5, 1
    s_lshl_b32 s18, s18, 6
    v_lshl_add_u32 v1, v1, 3, s18
    s_lshl_b32 s19, s17, 1
    v_add_u32 v6, s19, v6
    v_lshlrev_b32 v7, 5, v6
    v_lshl_add_u32 v7, v2, 2, v7
    v_mul_u32_u24 v3, 0x500, v7
    v_lshl_add_u32 v3, v1, 1, v3
    v_add_u32 v4, 0x5000, v3
    s_waitcnt lgkmcnt(0)
    s_mov_b32 s8, s4
    s_mov_b32 s9, s5
    s_mov_b32 s10, 0x21c000
    s_mov_b32 s11, 0x00020000
    s_add_u32 s12, s6, 0x500000
    s_addc_u32 s13, s7, 0
    s_mov_b32 s14, 0x21c000
    s_mov_b32 s15, 0x00020000
    buffer_load_dwordx4 v[8:11], v3, s[8:11], 0 offen offset:0
    buffer_load_dwordx4 v[12:15], v3, s[8:11], 0 offen offset:1280
    buffer_load_dwordx4 v[16:19], v3, s[8:11], 0 offen offset:2560
    buffer_load_dwordx4 v[20:23], v3, s[8:11], 0 offen offset:3840
    buffer_load_dwordx4 v[24:27], v4, s[8:11], 0 offen offset:0
    buffer_load_dwordx4 v[28:31], v4, s[8:11], 0 offen offset:1280
    buffer_load_dwordx4 v[32:35], v4, s[8:11], 0 offen offset:2560
    buffer_load_dwordx4 v[36:39], v4, s[8:11], 0 offen offset:3840
    s_mov_b32 s20, 0x05040100
    s_mov_b32 s21, 0x07060302
    v_lshrrev_b32 v5, 4, v1
    v_mul_u32_u24 v5, 54, v5
    v_add_u32 v5, v5, v6
    v_lshlrev_b32 v5, 10, v5
    v_lshl_add_u32 v5, v2, 8, v5
    v_and_b32 v7, 15, v1
    v_lshl_add_u32 v5, v7, 4, v5
    s_barrier
    s_barrier
    s_barrier
    s_barrier
    s_waitcnt vmcnt(0)
    v_perm_b32 v40, v12, v8, s20
    v_perm_b32 v41, v20, v16, s20
    v_perm_b32 v42, v28, v24, s20
    v_perm_b32 v43, v36, v32, s20
    v_perm_b32 v44, v12, v8, s21
    v_perm_b32 v45, v20, v16, s21
    v_perm_b32 v46, v28, v24, s21
    v_perm_b32 v47, v36, v32, s21
    v_perm_b32 v48, v13, v9, s20
    v_perm_b32 v49, v21, v17, s20
    v_perm_b32 v50, v29, v25, s20
    v_perm_b32 v51, v37, v33, s20
    v_perm_b32 v52, v13, v9, s21
    v_perm_b32 v53, v21, v17, s21
    v_perm_b32 v54, v29, v25, s21
    v_perm_b32 v55, v37, v33, s21
    v_perm_b32 v56, v14, v10, s20
    v_perm_b32 v57, v22, v18, s20
    v_perm_b32 v58, v30, v26, s20
    v_perm_b32 v59, v38, v34, s20
    v_perm_b32 v60, v14, v10, s21
    v_perm_b32 v61, v22, v18, s21
    v_perm_b32 v62, v30, v26, s21
    v_perm_b32 v63, v38, v34, s21
    v_perm_b32 v64, v15, v11, s20
    v_perm_b32 v65, v23, v19, s20
    v_perm_b32 v66, v31, v27, s20
    v_perm_b32 v67, v39, v35, s20
    v_perm_b32 v68, v15, v11, s21
    v_perm_b32 v69, v23, v19, s21
    v_perm_b32 v70, v31, v27, s21
    v_perm_b32 v71, v39, v35, s21
    buffer_store_dwordx4 v[40:43], v5, s[12:15], 0 offen offset:0
    buffer_store_dwordx4 v[44:47], v5, s[12:15], 0 offen offset:16
    buffer_store_dwordx4 v[48:51], v5, s[12:15], 0 offen offset:32
    buffer_store_dwordx4 v[52:55], v5, s[12:15], 0 offen offset:48
    buffer_store_dwordx4 v[56:59], v5, s[12:15], 0 offen offset:64
    buffer_store_dwordx4 v[60:63], v5, s[12:15], 0 offen offset:80
    buffer_store_dwordx4 v[64:67], v5, s[12:15], 0 offen offset:96
    buffer_store_dwordx4 v[68:71], v5, s[12:15], 0 offen offset:112
    s_endpgm
M_exitb:
    s_barrier
    s_barrier
    s_barrier
    s_barrier
M_exitw:
    s_waitcnt vmcnt(0)
M_exit:
    s_endpgm
.section .rodata,"a"
.p2align 6
.amdhsa_kernel mid_kernel
  .amdhsa_next_free_vgpr 256
  .amdhsa_next_free_sgpr 102
  .amdhsa_accum_offset 256
  .amdhsa_group_segment_fixed_size 0
  .amdhsa_kernarg_size 104
  .amdhsa_user_sgpr_count 2
  .amdhsa_user_sgpr_kernarg_segment_ptr 1
  .amdhsa_system_sgpr_workgroup_id_x 1
.end_amdhsa_kernel
.text
.globl fin_kernel
.p2align 12
.p2align 8
.type fin_kernel,@function
fin_kernel:
    s_nop 0
    s_cmp_ge_u32 s2, 256
    s_cbranch_scc1 F_exit
    s_load_dwordx2 s[6:7], s[0:1], 96
    s_load_dwordx2 s[4:5], s[0:1], 0
    s_load_dwordx2 s[30:31], s[0:1], 80
    v_lshrrev_b32 v1, 6, v0
    v_and_b32 v12, 63, v0
    v_readfirstlane_b32 s3, v1
    s_andn2_b32 s36, 1, s2
    s_lshl_b32 s36, s36, 2
    s_bfe_u32 s37, s2, 0x20003
    s_add_u32 s36, s36, s37
    s_bfe_u32 s37, s2, 0x20001
    s_lshl_b32 s37, s37, 3
    s_lshr_b32 s38, s2, 5
    s_add_u32 s37, s37, s38
    s_cmp_lt_u32 s3, 4
    s_cbranch_scc1 F_cons
    s_mul_i32 s52, s36, 276480
    s_mul_i32 s53, s37, 221184
    s_bfe_u32 s41, s3, 0x10001
    s_lshl_b32 s46, s41, 10
    s_mul_i32 s40, s41, 9216
    s_and_b32 s42, s3, 1
    s_cselect_b32 s52, s53, s52
    v_lshl_add_u32 v3, v12, 4, s52
    v_add_u32 v4, 54272, v3
    v_add_u32 v5, 108544, v3
    v_add_u32 v6, 162816, v3
    v_add_u32 v7, 221184, v3
    s_cbranch_scc1 F_ph
    v_lshrrev_b32 v8, 3, v12
    v_and_b32 v9, 7, v12
    v_lshlrev_b32 v8, 10, v8
    v_lshl_add_u32 v8, v9, 4, v8
    s_mul_i32 s52, s36, 5
    s_lshr_b32 s53, s52, 2
    s_lshl_b32 s53, s53, 13
    s_and_b32 s54, s52, 3
    s_lshl_b32 s54, s54, 7
    s_add_u32 s53, s53, s54
    s_add_u32 s53, s53, 4096
    v_add_u32 v3, s53, v8
    s_add_u32 s52, s52, 1
    s_lshr_b32 s53, s52, 2
    s_lshl_b32 s53, s53, 13
    s_and_b32 s54, s52, 3
    s_lshl_b32 s54, s54, 7
    s_add_u32 s53, s53, s54
    s_add_u32 s53, s53, 3072
    v_add_u32 v4, s53, v8
    s_add_u32 s52, s52, 1
    s_lshr_b32 s53, s52, 2
    s_lshl_b32 s53, s53, 13
    s_and_b32 s54, s52, 3
    s_lshl_b32 s54, s54, 7
    s_add_u32 s53, s53, s54
    s_add_u32 s53, s53, 2048
    v_add_u32 v5, s53, v8
    s_add_u32 s52, s52, 1
    s_lshr_b32 s53, s52, 2
    s_lshl_b32 s53, s53, 13
    s_and_b32 s54, s52, 3
    s_lshl_b32 s54, s54, 7
    s_add_u32 s53, s53, s54
    s_add_u32 s53, s53, 1024
    v_add_u32 v6, s53, v8
    s_add_u32 s52, s52, 1
    s_lshr_b32 s53, s52, 2
    s_lshl_b32 s53, s53, 13
    s_and_b32 s54, s52, 3
    s_lshl_b32 s54, s54, 7
    s_add_u32 s53, s53, s54
    s_add_u32 s53, s53, 4096
    v_add_u32 v7, s53, v8
    s_lshl_b32 s46, s41, 9
    s_waitcnt lgkmcnt(0)
    s_add_u32 s8, s6, 0x4ff000
    s_addc_u32 s9, s7, 0
    s_mov_b32 s10, 0x21d000
    s_mov_b32 s11, 0x00020000
    s_add_u32 m0, s40, 0
    s_nop 0
    buffer_load_dwordx4 v3, s[8:11], s46 offen offset:0 lds
    buffer_load_dwordx4 v4, s[8:11], s46 offen offset:1024 lds
    buffer_load_dwordx4 v5, s[8:11], s46 offen offset:2048 lds
    buffer_load_dwordx4 v6, s[8:11], s46 offen offset:3072 lds
    s_add_u32 m0, s40, 4096
    s_nop 0
    buffer_load_dwordx4 v7, s[8:11], s46 offen offset:0 lds
    s_add_u32 m0, s40, 18432
    s_add_u32 s46, s46, 81920
    buffer_load_dwordx4 v3, s[8:11], s46 offen offset:0 lds
    buffer_load_dwordx4 v4, s[8:11], s46 offen offset:1024 lds
    buffer_load_dwordx4 v5, s[8:11], s46 offen offset:2048 lds
    buffer_load_dwordx4 v6, s[8:11], s46 offen offset:3072 lds
    s_add_u32 m0, s40, 22528
    s_nop 0
    buffer_load_dwordx4 v7, s[8:11], s46 offen offset:0 lds
    s_add_u32 m0, s40, 36864
    s_add_u32 s46, s46, 81920
    buffer_load_dwordx4 v3, s[8:11], s46 offen offset:0 lds
    buffer_load_dwordx4 v4, s[8:11], s46 offen offset:1024 lds
    buffer_load_dwordx4 v5, s[8:11], s46 offen offset:2048 lds
    buffer_load_dwordx4 v6, s[8:11], s46 offen offset:3072 lds
    s_add_u32 m0, s40, 40960
    s_nop 0
    buffer_load_dwordx4 v7, s[8:11], s46 offen offset:0 lds
    s_add_u32 m0, s40, 55296
    s_add_u32 s46, s46, 81920
    buffer_load_dwordx4 v3, s[8:11], s46 offen offset:0 lds
    buffer_load_dwordx4 v4, s[8:11], s46 offen offset:1024 lds
    buffer_load_dwordx4 v5, s[8:11], s46 offen offset:2048 lds
    buffer_load_dwordx4 v6, s[8:11], s46 offen offset:3072 lds
    s_add_u32 m0, s40, 59392
    s_nop 0
    buffer_load_dwordx4 v7, s[8:11], s46 offen offset:0 lds
    s_add_u32 s16, s6, 0x1000000
    s_addc_u32 s17, s7, 0
    s_mov_b32 s18, 0x280000
    s_mov_b32 s19, 0x00020000
    s_mov_b32 s24, s4
    s_mov_b32 s25, s5
    s_mov_b32 s26, 0x280000
    s_mov_b32 s27, 0x00020000
    s_and_b32 s47, s3, 3
    v_lshrrev_b32 v13, 3, v12
    v_and_b32 v14, 7, v12
    v_xor_b32 v14, v14, v13
    v_lshlrev_b32 v13, 7, v13
    v_lshl_add_u32 v13, v14, 4, v13
    s_mul_i32 s48, s36, 10240
    s_mul_i32 s49, s37, 81920
    s_add_u32 s48, s48, s49
    s_lshl_b32 s49, s47, 10
    s_add_u32 s48, s48, s49
    s_lshl_b32 s50, s47, 10
    s_mul_i32 s51, s37, 81920
    s_mul_i32 s49, s36, 160
    s_add_u32 s51, s51, s49
    s_lshl_b32 s49, s47, 6
    v_add_u32 v16, s49, v12
    v_mul_u32_u24 v15, 6554, v16
    v_lshrrev_b32 v15, 16, v15
    v_mul_u32_u24 v15, 1120, v15
    v_lshl_add_u32 v16, v16, 4, v15
    v_add_u32 v17, s49, v12
    v_add_u32 v17, 256, v17
    v_mul_u32_u24 v15, 6554, v17
    v_lshrrev_b32 v15, 16, v15
    v_mul_u32_u24 v15, 1120, v15
    v_lshl_add_u32 v17, v17, 4, v15
    v_add_u32 v18, s49, v12
    v_add_u32 v18, 384, v18
    v_mul_u32_u24 v15, 6554, v18
    v_lshrrev_b32 v15, 16, v15
    v_mul_u32_u24 v15, 1120, v15
    v_lshl_add_u32 v18, v18, 4, v15
    s_add_u32 m0, s50, 110592
    s_nop 0
    buffer_load_dwordx4 v13, s[16:19], s48 offen lds
    s_add_u32 s48, s48, 4096
    s_waitcnt vmcnt(16)
    s_barrier
    s_add_u32 m0, s40, 73728
    s_add_u32 s46, s46, 81920
    buffer_load_dwordx4 v3, s[8:11], s46 offen offset:0 lds
    buffer_load_dwordx4 v4, s[8:11], s46 offen offset:1024 lds
    buffer_load_dwordx4 v5, s[8:11], s46 offen offset:2048 lds
    buffer_load_dwordx4 v6, s[8:11], s46 offen offset:3072 lds
    s_add_u32 m0, s40, 77824
    s_nop 0
    buffer_load_dwordx4 v7, s[8:11], s46 offen offset:0 lds
    s_waitcnt vmcnt(16)
    s_barrier
    s_add_u32 m0, s40, 92160
    s_add_u32 s46, s46, 81920
    buffer_load_dwordx4 v3, s[8:11], s46 offen offset:0 lds
    buffer_load_dwordx4 v4, s[8:11], s46 offen offset:1024 lds
    buffer_load_dwordx4 v5, s[8:11], s46 offen offset:2048 lds
    buffer_load_dwordx4 v6, s[8:11], s46 offen offset:3072 lds
    s_add_u32 m0, s40, 96256
    s_nop 0
    buffer_load_dwordx4 v7, s[8:11], s46 offen offset:0 lds
    s_add_u32 m0, s50, 120832
    s_nop 0
    buffer_load_dwordx4 v16, s[24:27], s51 offen lds
    s_waitcnt vmcnt(17)
    s_barrier
    s_add_u32 m0, s40, 0
    s_add_u32 s46, s46, 81920
    buffer_load_dwordx4 v3, s[8:11], s46 offen offset:0 lds
    buffer_load_dwordx4 v4, s[8:11], s46 offen offset:1024 lds
    buffer_load_dwordx4 v5, s[8:11], s46 offen offset:2048 lds
    buffer_load_dwordx4 v6, s[8:11], s46 offen offset:3072 lds
    s_add_u32 m0, s40, 4096
    s_nop 0
    buffer_load_dwordx4 v7, s[8:11], s46 offen offset:0 lds
    s_waitcnt vmcnt(17)
    s_barrier
    s_add_u32 m0, s40, 18432
    s_add_u32 s46, s46, 81920
    buffer_load_dwordx4 v3, s[8:11], s46 offen offset:0 lds
    buffer_load_dwordx4 v4, s[8:11], s46 offen offset:1024 lds
    buffer_load_dwordx4 v5, s[8:11], s46 offen offset:2048 lds
    buffer_load_dwordx4 v6, s[8:11], s46 offen offset:3072 lds
    s_add_u32 m0, s40, 22528
    s_nop 0
    buffer_load_dwordx4 v7, s[8:11], s46 offen offset:0 lds
    s_add_u32 m0, s50, 114688
    s_nop 0
    buffer_load_dwordx4 v13, s[16:19], s48 offen lds
    s_add_u32 s48, s48, 4096
    s_waitcnt vmcnt(17)
    s_barrier
    s_add_u32 m0, s40, 36864
    s_add_u32 s46, s46, 81920
    buffer_load_dwordx4 v3, s[8:11], s46 offen offset:0 lds
    buffer_load_dwordx4 v4, s[8:11], s46 offen offset:1024 lds
    buffer_load_dwordx4 v5, s[8:11], s46 offen offset:2048 lds
    buffer_load_dwordx4 v6, s[8:11], s46 offen offset:3072 lds
    s_add_u32 m0, s40, 40960
    s_nop 0
    buffer_load_dwordx4 v7, s[8:11], s46 offen offset:0 lds
    s_waitcnt vmcnt(17)
    s_barrier
    s_add_u32 m0, s40, 55296
    s_add_u32 s46, s46, 81920
    buffer_load_dwordx4 v3, s[8:11], s46 offen offset:0 lds
    buffer_load_dwordx4 v4, s[8:11], s46 offen offset:1024 lds
    buffer_load_dwordx4 v5, s[8:11], s46 offen offset:2048 lds
    buffer_load_dwordx4 v6, s[8:11], s46 offen offset:3072 lds
    s_add_u32 m0, s40, 59392
    s_nop 0
    buffer_load_dwordx4 v7, s[8:11], s46 offen offset:0 lds
    s_add_u32 m0, s50, 124928
    s_nop 0
    buffer_load_dwordx4 v17, s[24:27], s51 offen lds
    s_waitcnt vmcnt(17)
    s_barrier
    s_add_u32 m0, s40, 73728
    s_add_u32 s46, s46, 81920
    buffer_load_dwordx4 v3, s[8:11], s46 offen offset:0 lds
    buffer_load_dwordx4 v4, s[8:11], s46 offen offset:1024 lds
    buffer_load_dwordx4 v5, s[8:11], s46 offen offset:2048 lds
    buffer_load_dwordx4 v6, s[8:11], s46 offen offset:3072 lds
    s_add_u32 m0, s40, 77824
    s_nop 0
    buffer_load_dwordx4 v7, s[8:11], s46 offen offset:0 lds
    s_waitcnt vmcnt(17)
    s_barrier
    s_add_u32 m0, s40, 92160
    s_add_u32 s46, s46, 81920
    buffer_load_dwordx4 v3, s[8:11], s46 offen offset:0 lds
    buffer_load_dwordx4 v4, s[8:11], s46 offen offset:1024 lds
    buffer_load_dwordx4 v5, s[8:11], s46 offen offset:2048 lds
    buffer_load_dwordx4 v6, s[8:11], s46 offen offset:3072 lds
    s_add_u32 m0, s40, 96256
    s_nop 0
    buffer_load_dwordx4 v7, s[8:11], s46 offen offset:0 lds
    s_cmp_eq_u32 s41, 0
    s_cbranch_scc0 F_x5_0
    s_add_u32 m0, s50, 118784
    s_nop 0
    buffer_load_dwordx4 v13, s[16:19], s48 offen lds
    s_branch F_x5d_0
F_x5_0:
    s_add_u32 m0, s50, 126976
    s_nop 0
    buffer_load_dwordx4 v18, s[24:27], s51 offen lds
F_x5d_0:
    s_waitcnt vmcnt(17)
    s_barrier
    s_add_u32 m0, s40, 0
    s_add_u32 s46, s46, 81920
    buffer_load_dwordx4 v3, s[8:11], s46 offen offset:0 lds
    buffer_load_dwordx4 v4, s[8:11], s46 offen offset:1024 lds
    buffer_load_dwordx4 v5, s[8:11], s46 offen offset:2048 lds
    buffer_load_dwordx4 v6, s[8:11], s46 offen offset:3072 lds
    s_add_u32 m0, s40, 4096
    s_nop 0
    buffer_load_dwordx4 v7, s[8:11], s46 offen offset:0 lds
    s_waitcnt vmcnt(17)
    s_barrier
    s_add_u32 m0, s40, 18432
    s_add_u32 s46, s46, 81920
    buffer_load_dwordx4 v3, s[8:11], s46 offen offset:0 lds
    buffer_load_dwordx4 v4, s[8:11], s46 offen offset:1024 lds
    buffer_load_dwordx4 v5, s[8:11], s46 offen offset:2048 lds
    buffer_load_dwordx4 v6, s[8:11], s46 offen offset:3072 lds
    s_add_u32 m0, s40, 22528
    s_nop 0
    buffer_load_dwordx4 v7, s[8:11], s46 offen offset:0 lds
    s_waitcnt vmcnt(16)
    s_barrier
    s_add_u32 m0, s40, 36864
    s_add_u32 s46, s46, 81920
    buffer_load_dwordx4 v3, s[8:11], s46 offen offset:0 lds
    buffer_load_dwordx4 v4, s[8:11], s46 offen offset:1024 lds
    buffer_load_dwordx4 v5, s[8:11], s46 offen offset:2048 lds
    buffer_load_dwordx4 v6, s[8:11], s46 offen offset:3072 lds
    s_add_u32 m0, s40, 40960
    s_nop 0
    buffer_load_dwordx4 v7, s[8:11], s46 offen offset:0 lds
    s_waitcnt vmcnt(16)
    s_barrier
    s_add_u32 m0, s40, 55296
    s_add_u32 s46, s46, 81920
    buffer_load_dwordx4 v3, s[8:11], s46 offen offset:0 lds
    buffer_load_dwordx4 v4, s[8:11], s46 offen offset:1024 lds
    buffer_load_dwordx4 v5, s[8:11], s46 offen offset:2048 lds
    buffer_load_dwordx4 v6, s[8:11], s46 offen offset:3072 lds
    s_add_u32 m0, s40, 59392
    s_nop 0
    buffer_load_dwordx4 v7, s[8:11], s46 offen offset:0 lds
    s_waitcnt vmcnt(15)
    s_barrier
    s_add_u32 m0, s40, 73728
    s_add_u32 s46, s46, 81920
    buffer_load_dwordx4 v3, s[8:11], s46 offen offset:0 lds
    buffer_load_dwordx4 v4, s[8:11], s46 offen offset:1024 lds
    buffer_load_dwordx4 v5, s[8:11], s46 offen offset:2048 lds
    buffer_load_dwordx4 v6, s[8:11], s46 offen offset:3072 lds
    s_add_u32 m0, s40, 77824
    s_nop 0
    buffer_load_dwordx4 v7, s[8:11], s46 offen offset:0 lds
    s_waitcnt vmcnt(15)
    s_barrier
    s_add_u32 m0, s40, 92160
    s_add_u32 s46, s46, 81920
    buffer_load_dwordx4 v3, s[8:11], s46 offen offset:0 lds
    buffer_load_dwordx4 v4, s[8:11], s46 offen offset:1024 lds
    buffer_load_dwordx4 v5, s[8:11], s46 offen offset:2048 lds
    buffer_load_dwordx4 v6, s[8:11], s46 offen offset:3072 lds
    s_add_u32 m0, s40, 96256
    s_nop 0
    buffer_load_dwordx4 v7, s[8:11], s46 offen offset:0 lds
    s_waitcnt vmcnt(15)
    s_barrier
    s_add_u32 m0, s40, 0
    s_add_u32 s46, s46, 81920
    buffer_load_dwordx4 v3, s[8:11], s46 offen offset:0 lds
    buffer_load_dwordx4 v4, s[8:11], s46 offen offset:1024 lds
    buffer_load_dwordx4 v5, s[8:11], s46 offen offset:2048 lds
    buffer_load_dwordx4 v6, s[8:11], s46 offen offset:3072 lds
    s_add_u32 m0, s40, 4096
    s_nop 0
    buffer_load_dwordx4 v7, s[8:11], s46 offen offset:0 lds
    s_waitcnt vmcnt(15)
    s_barrier
    s_add_u32 m0, s40, 18432
    s_add_u32 s46, s46, 81920
    buffer_load_dwordx4 v3, s[8:11], s46 offen offset:0 lds
    buffer_load_dwordx4 v4, s[8:11], s46 offen offset:1024 lds
    buffer_load_dwordx4 v5, s[8:11], s46 offen offset:2048 lds
    buffer_load_dwordx4 v6, s[8:11], s46 offen offset:3072 lds
    s_add_u32 m0, s40, 22528
    s_nop 0
    buffer_load_dwordx4 v7, s[8:11], s46 offen offset:0 lds
    s_waitcnt vmcnt(15)
    s_barrier
    s_add_u32 m0, s40, 36864
    s_add_u32 s46, s46, 81920
    buffer_load_dwordx4 v3, s[8:11], s46 offen offset:0 lds
    buffer_load_dwordx4 v4, s[8:11], s46 offen offset:1024 lds
    buffer_load_dwordx4 v5, s[8:11], s46 offen offset:2048 lds
    buffer_load_dwordx4 v6, s[8:11], s46 offen offset:3072 lds
    s_add_u32 m0, s40, 40960
    s_nop 0
    buffer_load_dwordx4 v7, s[8:11], s46 offen offset:0 lds
    s_waitcnt vmcnt(15)
    s_barrier
    s_add_u32 m0, s40, 55296
    s_add_u32 s46, s46, 81920
    buffer_load_dwordx4 v3, s[8:11], s46 offen offset:0 lds
    buffer_load_dwordx4 v4, s[8:11], s46 offen offset:1024 lds
    buffer_load_dwordx4 v5, s[8:11], s46 offen offset:2048 lds
    buffer_load_dwordx4 v6, s[8:11], s46 offen offset:3072 lds
    s_add_u32 m0, s40, 59392
    s_nop 0
    buffer_load_dwordx4 v7, s[8:11], s46 offen offset:0 lds
    s_waitcnt vmcnt(15)
    s_barrier
    s_add_u32 m0, s40, 73728
    s_add_u32 s46, s46, 81920
    buffer_load_dwordx4 v3, s[8:11], s46 offen offset:0 lds
    buffer_load_dwordx4 v4, s[8:11], s46 offen offset:1024 lds
    buffer_load_dwordx4 v5, s[8:11], s46 offen offset:2048 lds
    buffer_load_dwordx4 v6, s[8:11], s46 offen offset:3072 lds
    s_add_u32 m0, s40, 77824
    s_nop 0
    buffer_load_dwordx4 v7, s[8:11], s46 offen offset:0 lds
    s_waitcnt vmcnt(15)
    s_barrier
    s_add_u32 m0, s40, 92160
    s_add_u32 s46, s46, 81920
    buffer_load_dwordx4 v3, s[8:11], s46 offen offset:0 lds
    buffer_load_dwordx4 v4, s[8:11], s46 offen offset:1024 lds
    buffer_load_dwordx4 v5, s[8:11], s46 offen offset:2048 lds
    buffer_load_dwordx4 v6, s[8:11], s46 offen offset:3072 lds
    s_add_u32 m0, s40, 96256
    s_nop 0
    buffer_load_dwordx4 v7, s[8:11], s46 offen offset:0 lds
    s_waitcnt vmcnt(15)
    s_barrier
    s_add_u32 m0, s40, 0
    s_add_u32 s46, s46, 81920
    buffer_load_dwordx4 v3, s[8:11], s46 offen offset:0 lds
    buffer_load_dwordx4 v4, s[8:11], s46 offen offset:1024 lds
    buffer_load_dwordx4 v5, s[8:11], s46 offen offset:2048 lds
    buffer_load_dwordx4 v6, s[8:11], s46 offen offset:3072 lds
    s_add_u32 m0, s40, 4096
    s_nop 0
    buffer_load_dwordx4 v7, s[8:11], s46 offen offset:0 lds
    s_waitcnt vmcnt(15)
    s_barrier
    s_add_u32 m0, s40, 18432
    s_add_u32 s46, s46, 81920
    buffer_load_dwordx4 v3, s[8:11], s46 offen offset:0 lds
    buffer_load_dwordx4 v4, s[8:11], s46 offen offset:1024 lds
    buffer_load_dwordx4 v5, s[8:11], s46 offen offset:2048 lds
    buffer_load_dwordx4 v6, s[8:11], s46 offen offset:3072 lds
    s_add_u32 m0, s40, 22528
    s_nop 0
    buffer_load_dwordx4 v7, s[8:11], s46 offen offset:0 lds
    s_waitcnt vmcnt(15)
    s_barrier
    s_add_u32 m0, s40, 36864
    s_add_u32 s46, s46, 81920
    buffer_load_dwordx4 v3, s[8:11], s46 offen offset:0 lds
    buffer_load_dwordx4 v4, s[8:11], s46 offen offset:1024 lds
    buffer_load_dwordx4 v5, s[8:11], s46 offen offset:2048 lds
    buffer_load_dwordx4 v6, s[8:11], s46 offen offset:3072 lds
    s_add_u32 m0, s40, 40960
    s_nop 0
    buffer_load_dwordx4 v7, s[8:11], s46 offen offset:0 lds
    s_waitcnt vmcnt(15)
    s_barrier
    s_waitcnt vmcnt(10)
    s_barrier
    s_waitcnt vmcnt(5)
    s_barrier
    s_waitcnt vmcnt(0)
    s_barrier
    s_endpgm
F_ph:
    s_add_u32 s40, s40, 5120
    s_waitcnt lgkmcnt(0)
    s_add_u32 s8, s6, 0x800000
    s_addc_u32 s9, s7, 0
    s_mov_b32 s10, 0x6c0000
    s_mov_b32 s11, 0x00020000
    s_add_u32 m0, s40, 0
    s_nop 0
    buffer_load_dwordx4 v3, s[8:11], s46 offen offset:0 lds
    buffer_load_dwordx4 v4, s[8:11], s46 offen offset:1024 lds
    buffer_load_dwordx4 v5, s[8:11], s46 offen offset:2048 lds
    buffer_load_dwordx4 v6, s[8:11], s46 offen offset:3072 lds
    s_add_u32 m0, s40, 18432
    s_add_u32 s46, s46, 2048
    buffer_load_dwordx4 v3, s[8:11], s46 offen offset:0 lds
    buffer_load_dwordx4 v4, s[8:11], s46 offen offset:1024 lds
    buffer_load_dwordx4 v5, s[8:11], s46 offen offset:2048 lds
    buffer_load_dwordx4 v6, s[8:11], s46 offen offset:3072 lds
    s_add_u32 m0, s40, 36864
    s_add_u32 s46, s46, 2048
    buffer_load_dwordx4 v3, s[8:11], s46 offen offset:0 lds
    buffer_load_dwordx4 v4, s[8:11], s46 offen offset:1024 lds
    buffer_load_dwordx4 v5, s[8:11], s46 offen offset:2048 lds
    buffer_load_dwordx4 v6, s[8:11], s46 offen offset:3072 lds
    s_add_u32 m0, s40, 55296
    s_add_u32 s46, s46, 2048
    buffer_load_dwordx4 v3, s[8:11], s46 offen offset:0 lds
    buffer_load_dwordx4 v4, s[8:11], s46 offen offset:1024 lds
    buffer_load_dwordx4 v5, s[8:11], s46 offen offset:2048 lds
    buffer_load_dwordx4 v6, s[8:11], s46 offen offset:3072 lds
    s_add_u32 s16, s6, 0x1000000
    s_addc_u32 s17, s7, 0
    s_mov_b32 s18, 0x280000
    s_mov_b32 s19, 0x00020000
    s_mov_b32 s24, s4
    s_mov_b32 s25, s5
    s_mov_b32 s26, 0x280000
    s_mov_b32 s27, 0x00020000
    s_and_b32 s47, s3, 3
    v_lshrrev_b32 v13, 3, v12
    v_and_b32 v14, 7, v12
    v_xor_b32 v14, v14, v13
    v_lshlrev_b32 v13, 7, v13
    v_lshl_add_u32 v13, v14, 4, v13
    s_mul_i32 s48, s36, 10240
    s_mul_i32 s49, s37, 81920
    s_add_u32 s48, s48, s49
    s_lshl_b32 s49, s47, 10
    s_add_u32 s48, s48, s49
    s_lshl_b32 s50, s47, 10
    s_mul_i32 s51, s37, 81920
    s_mul_i32 s49, s36, 160
    s_add_u32 s51, s51, s49
    s_lshl_b32 s49, s47, 6
    v_add_u32 v16, s49, v12
    v_mul_u32_u24 v15, 6554, v16
    v_lshrrev_b32 v15, 16, v15
    v_mul_u32_u24 v15, 1120, v15
    v_lshl_add_u32 v16, v16, 4, v15
    v_add_u32 v17, s49, v12
    v_add_u32 v17, 256, v17
    v_mul_u32_u24 v15, 6554, v17
    v_lshrrev_b32 v15, 16, v15
    v_mul_u32_u24 v15, 1120, v15
    v_lshl_add_u32 v17, v17, 4, v15
    v_add_u32 v18, s49, v12
    v_add_u32 v18, 384, v18
    v_mul_u32_u24 v15, 6554, v18
    v_lshrrev_b32 v15, 16, v15
    v_mul_u32_u24 v15, 1120, v15
    v_lshl_add_u32 v18, v18, 4, v15
    s_add_u32 m0, s50, 110592
    s_nop 0
    buffer_load_dwordx4 v13, s[16:19], s48 offen lds
    s_add_u32 s48, s48, 4096
    s_waitcnt vmcnt(13)
    s_barrier
    s_add_u32 m0, s40, 73728
    s_add_u32 s46, s46, 2048
    buffer_load_dwordx4 v3, s[8:11], s46 offen offset:0 lds
    buffer_load_dwordx4 v4, s[8:11], s46 offen offset:1024 lds
    buffer_load_dwordx4 v5, s[8:11], s46 offen offset:2048 lds
    buffer_load_dwordx4 v6, s[8:11], s46 offen offset:3072 lds
    s_waitcnt vmcnt(13)
    s_barrier
    s_add_u32 m0, s40, 92160
    s_add_u32 s46, s46, 2048
    buffer_load_dwordx4 v3, s[8:11], s46 offen offset:0 lds
    buffer_load_dwordx4 v4, s[8:11], s46 offen offset:1024 lds
    buffer_load_dwordx4 v5, s[8:11], s46 offen offset:2048 lds
    buffer_load_dwordx4 v6, s[8:11], s46 offen offset:3072 lds
    s_add_u32 m0, s50, 120832
    s_nop 0
    buffer_load_dwordx4 v16, s[24:27], s51 offen lds
    s_waitcnt vmcnt(14)
    s_barrier
    s_add_u32 m0, s40, 0
    s_add_u32 s46, s46, 2048
    buffer_load_dwordx4 v3, s[8:11], s46 offen offset:0 lds
    buffer_load_dwordx4 v4, s[8:11], s46 offen offset:1024 lds
    buffer_load_dwordx4 v5, s[8:11], s46 offen offset:2048 lds
    buffer_load_dwordx4 v6, s[8:11], s46 offen offset:3072 lds
    s_waitcnt vmcnt(14)
    s_barrier
    s_add_u32 m0, s40, 18432
    s_add_u32 s46, s46, 2048
    buffer_load_dwordx4 v3, s[8:11], s46 offen offset:0 lds
    buffer_load_dwordx4 v4, s[8:11], s46 offen offset:1024 lds
    buffer_load_dwordx4 v5, s[8:11], s46 offen offset:2048 lds
    buffer_load_dwordx4 v6, s[8:11], s46 offen offset:3072 lds
    s_add_u32 m0, s50, 114688
    s_nop 0
    buffer_load_dwordx4 v13, s[16:19], s48 offen lds
    s_add_u32 s48, s48, 4096
    s_waitcnt vmcnt(14)
    s_barrier
    s_add_u32 m0, s40, 36864
    s_add_u32 s46, s46, 2048
    buffer_load_dwordx4 v3, s[8:11], s46 offen offset:0 lds
    buffer_load_dwordx4 v4, s[8:11], s46 offen offset:1024 lds
    buffer_load_dwordx4 v5, s[8:11], s46 offen offset:2048 lds
    buffer_load_dwordx4 v6, s[8:11], s46 offen offset:3072 lds
    s_waitcnt vmcnt(14)
    s_barrier
    s_add_u32 m0, s40, 55296
    s_add_u32 s46, s46, 2048
    buffer_load_dwordx4 v3, s[8:11], s46 offen offset:0 lds
    buffer_load_dwordx4 v4, s[8:11], s46 offen offset:1024 lds
    buffer_load_dwordx4 v5, s[8:11], s46 offen offset:2048 lds
    buffer_load_dwordx4 v6, s[8:11], s46 offen offset:3072 lds
    s_add_u32 m0, s50, 124928
    s_nop 0
    buffer_load_dwordx4 v17, s[24:27], s51 offen lds
    s_waitcnt vmcnt(14)
    s_barrier
    s_add_u32 m0, s40, 73728
    s_add_u32 s46, s46, 2048
    buffer_load_dwordx4 v3, s[8:11], s46 offen offset:0 lds
    buffer_load_dwordx4 v4, s[8:11], s46 offen offset:1024 lds
    buffer_load_dwordx4 v5, s[8:11], s46 offen offset:2048 lds
    buffer_load_dwordx4 v6, s[8:11], s46 offen offset:3072 lds
    s_waitcnt vmcnt(14)
    s_barrier
    s_add_u32 m0, s40, 92160
    s_add_u32 s46, s46, 2048
    buffer_load_dwordx4 v3, s[8:11], s46 offen offset:0 lds
    buffer_load_dwordx4 v4, s[8:11], s46 offen offset:1024 lds
    buffer_load_dwordx4 v5, s[8:11], s46 offen offset:2048 lds
    buffer_load_dwordx4 v6, s[8:11], s46 offen offset:3072 lds
    s_cmp_eq_u32 s41, 0
    s_cbranch_scc0 F_x5_1
    s_add_u32 m0, s50, 118784
    s_nop 0
    buffer_load_dwordx4 v13, s[16:19], s48 offen lds
    s_branch F_x5d_1
F_x5_1:
    s_add_u32 m0, s50, 126976
    s_nop 0
    buffer_load_dwordx4 v18, s[24:27], s51 offen lds
F_x5d_1:
    s_waitcnt vmcnt(14)
    s_barrier
    s_add_u32 m0, s40, 0
    s_add_u32 s46, s46, 2048
    buffer_load_dwordx4 v3, s[8:11], s46 offen offset:0 lds
    buffer_load_dwordx4 v4, s[8:11], s46 offen offset:1024 lds
    buffer_load_dwordx4 v5, s[8:11], s46 offen offset:2048 lds
    buffer_load_dwordx4 v6, s[8:11], s46 offen offset:3072 lds
    s_waitcnt vmcnt(14)
    s_barrier
    s_add_u32 m0, s40, 18432
    s_add_u32 s46, s46, 2048
    buffer_load_dwordx4 v3, s[8:11], s46 offen offset:0 lds
    buffer_load_dwordx4 v4, s[8:11], s46 offen offset:1024 lds
    buffer_load_dwordx4 v5, s[8:11], s46 offen offset:2048 lds
    buffer_load_dwordx4 v6, s[8:11], s46 offen offset:3072 lds
    s_waitcnt vmcnt(13)
    s_barrier
    s_add_u32 m0, s40, 36864
    s_add_u32 s46, s46, 2048
    buffer_load_dwordx4 v3, s[8:11], s46 offen offset:0 lds
    buffer_load_dwordx4 v4, s[8:11], s46 offen offset:1024 lds
    buffer_load_dwordx4 v5, s[8:11], s46 offen offset:2048 lds
    buffer_load_dwordx4 v6, s[8:11], s46 offen offset:3072 lds
    s_waitcnt vmcnt(13)
    s_barrier
    s_add_u32 m0, s40, 55296
    s_nop 0
    s_add_u32 s46, s46, 2048
    buffer_load_dwordx4 v3, s[8:11], s46 offen offset:0 lds
    buffer_load_dwordx4 v4, s[8:11], s46 offen offset:1024 lds
    buffer_load_dwordx4 v5, s[8:11], s46 offen offset:2048 lds
    buffer_load_dwordx4 v6, s[8:11], s46 offen offset:3072 lds
    s_waitcnt vmcnt(12)
    s_barrier
    s_add_u32 m0, s40, 73728
    s_add_u32 s46, s46, 2048
    buffer_load_dwordx4 v3, s[8:11], s46 offen offset:0 lds
    buffer_load_dwordx4 v4, s[8:11], s46 offen offset:1024 lds
    buffer_load_dwordx4 v5, s[8:11], s46 offen offset:2048 lds
    buffer_load_dwordx4 v6, s[8:11], s46 offen offset:3072 lds
    s_waitcnt vmcnt(12)
    s_barrier
    s_add_u32 m0, s40, 92160
    s_add_u32 s46, s46, 2048
    buffer_load_dwordx4 v3, s[8:11], s46 offen offset:0 lds
    buffer_load_dwordx4 v4, s[8:11], s46 offen offset:1024 lds
    buffer_load_dwordx4 v5, s[8:11], s46 offen offset:2048 lds
    buffer_load_dwordx4 v6, s[8:11], s46 offen offset:3072 lds
    s_waitcnt vmcnt(12)
    s_barrier
    s_add_u32 m0, s40, 0
    s_add_u32 s46, s46, 2048
    buffer_load_dwordx4 v3, s[8:11], s46 offen offset:0 lds
    buffer_load_dwordx4 v4, s[8:11], s46 offen offset:1024 lds
    buffer_load_dwordx4 v5, s[8:11], s46 offen offset:2048 lds
    buffer_load_dwordx4 v6, s[8:11], s46 offen offset:3072 lds
    s_waitcnt vmcnt(12)
    s_barrier
    s_add_u32 m0, s40, 18432
    s_add_u32 s46, s46, 2048
    buffer_load_dwordx4 v3, s[8:11], s46 offen offset:0 lds
    buffer_load_dwordx4 v4, s[8:11], s46 offen offset:1024 lds
    buffer_load_dwordx4 v5, s[8:11], s46 offen offset:2048 lds
    buffer_load_dwordx4 v6, s[8:11], s46 offen offset:3072 lds
    s_waitcnt vmcnt(12)
    s_barrier
    s_add_u32 m0, s40, 36864
    s_add_u32 s46, s46, 2048
    buffer_load_dwordx4 v3, s[8:11], s46 offen offset:0 lds
    buffer_load_dwordx4 v4, s[8:11], s46 offen offset:1024 lds
    buffer_load_dwordx4 v5, s[8:11], s46 offen offset:2048 lds
    buffer_load_dwordx4 v6, s[8:11], s46 offen offset:3072 lds
    s_waitcnt vmcnt(12)
    s_barrier
    s_add_u32 m0, s40, 55296
    s_add_u32 s46, s46, 2048
    buffer_load_dwordx4 v3, s[8:11], s46 offen offset:0 lds
    buffer_load_dwordx4 v4, s[8:11], s46 offen offset:1024 lds
    buffer_load_dwordx4 v5, s[8:11], s46 offen offset:2048 lds
    buffer_load_dwordx4 v6, s[8:11], s46 offen offset:3072 lds
    s_waitcnt vmcnt(12)
    s_barrier
    s_add_u32 m0, s40, 73728
    s_add_u32 s46, s46, 2048
    buffer_load_dwordx4 v3, s[8:11], s46 offen offset:0 lds
    buffer_load_dwordx4 v4, s[8:11], s46 offen offset:1024 lds
    buffer_load_dwordx4 v5, s[8:11], s46 offen offset:2048 lds
    buffer_load_dwordx4 v6, s[8:11], s46 offen offset:3072 lds
    s_waitcnt vmcnt(12)
    s_barrier
    s_add_u32 m0, s40, 92160
    s_add_u32 s46, s46, 2048
    buffer_load_dwordx4 v3, s[8:11], s46 offen offset:0 lds
    buffer_load_dwordx4 v4, s[8:11], s46 offen offset:1024 lds
    buffer_load_dwordx4 v5, s[8:11], s46 offen offset:2048 lds
    buffer_load_dwordx4 v6, s[8:11], s46 offen offset:3072 lds
    s_waitcnt vmcnt(12)
    s_barrier
    s_add_u32 m0, s40, 0
    s_add_u32 s46, s46, 2048
    buffer_load_dwordx4 v3, s[8:11], s46 offen offset:0 lds
    buffer_load_dwordx4 v4, s[8:11], s46 offen offset:1024 lds
    buffer_load_dwordx4 v5, s[8:11], s46 offen offset:2048 lds
    buffer_load_dwordx4 v6, s[8:11], s46 offen offset:3072 lds
    s_waitcnt vmcnt(12)
    s_barrier
    s_add_u32 m0, s40, 18432
    s_add_u32 s46, s46, 2048
    buffer_load_dwordx4 v3, s[8:11], s46 offen offset:0 lds
    buffer_load_dwordx4 v4, s[8:11], s46 offen offset:1024 lds
    buffer_load_dwordx4 v5, s[8:11], s46 offen offset:2048 lds
    buffer_load_dwordx4 v6, s[8:11], s46 offen offset:3072 lds
    s_waitcnt vmcnt(12)
    s_barrier
    s_add_u32 m0, s40, 36864
    s_add_u32 s46, s46, 2048
    buffer_load_dwordx4 v3, s[8:11], s46 offen offset:0 lds
    buffer_load_dwordx4 v4, s[8:11], s46 offen offset:1024 lds
    buffer_load_dwordx4 v5, s[8:11], s46 offen offset:2048 lds
    buffer_load_dwordx4 v6, s[8:11], s46 offen offset:3072 lds
    s_waitcnt vmcnt(12)
    s_barrier
    s_waitcnt vmcnt(8)
    s_barrier
    s_waitcnt vmcnt(4)
    s_barrier
    s_waitcnt vmcnt(0)
    s_barrier
    s_endpgm
F_cons:
    v_and_b32 v1, 15, v0
    v_bfe_u32 v2, v0, 4, 2
    s_lshl_b32 s42, s37, 6
    s_lshl_b32 s43, s3, 4
    s_add_u32 s42, s42, s43
    v_add_u32 v14, s42, v1
    v_lshlrev_b32 v14, 3, v14
    s_waitcnt lgkmcnt(0)
    s_add_u32 s20, s6, 0x1400000
    s_addc_u32 s21, s7, 0
    s_mov_b32 s22, 0x4000
    s_mov_b32 s23, 0x00020000
    buffer_load_dwordx2 v[170:171], v14, s[20:23], 0 offen
    s_mov_b32 s32, s30
    s_mov_b32 s33, s31
    s_mov_b32 s34, 0x280000
    s_mov_b32 s35, 0x00020000
    v_lshlrev_b32 v3, 4, v12
    v_add_u32 v4, 55296, v3
    v_add_u32 v5, 110592, v3
    s_lshl_b32 s43, s3, 10
    v_add_u32 v6, s43, v3
    v_add_u32 v7, s43, v4
    v_add_u32 v8, s43, v5
    v_lshlrev_b32 v13, 3, v12
    v_sub_u32 v19, v6, v13
    v_sub_u32 v20, v7, v13
    v_sub_u32 v21, v8, v13
    v_lshrrev_b32 v13, 3, v1
    v_lshl_add_u32 v13, v2, 1, v13
    v_and_b32 v15, 7, v1
    v_xor_b32 v13, v13, v15
    v_lshlrev_b32 v3, 7, v15
    v_lshl_add_u32 v3, v13, 4, v3
    v_add_u32 v4, 55296, v3
    v_add_u32 v5, 110592, v3
    s_lshr_b32 s43, s3, 1
    s_lshl_b32 s43, s43, 2
    v_add_u32 v13, s43, v2
    v_and_b32 v14, 7, v1
    v_xor_b32 v13, v13, v14
    v_lshlrev_b32 v9, 7, v1
    v_lshl_add_u32 v9, v13, 4, v9
    v_add_u32 v9, 110592, v9
    s_mul_i32 s43, s3, 2560
    s_add_u32 s43, s43, 120832
    v_mul_u32_u24 v10, 160, v1
    v_lshl_add_u32 v10, v2, 3, v10
    v_add_u32 v10, s43, v10
    v_lshl_add_u32 v11, v12, 4, s43
    v_add_u32 v16, 0, v12
    v_mul_u32_u24 v15, 6554, v16
    v_lshrrev_b32 v15, 16, v15
    v_mul_u32_u24 v15, 1120, v15
    v_lshl_add_u32 v16, v16, 4, v15
    v_add_u32 v17, 64, v12
    v_mul_u32_u24 v15, 6554, v17
    v_lshrrev_b32 v15, 16, v15
    v_mul_u32_u24 v15, 1120, v15
    v_lshl_add_u32 v17, v17, 4, v15
    v_add_u32 v18, 128, v12
    v_mul_u32_u24 v15, 6554, v18
    v_lshrrev_b32 v15, 16, v15
    v_mul_u32_u24 v15, 1120, v15
    v_lshl_add_u32 v18, v18, 4, v15
    s_mul_i32 s42, s42, 1280
    s_mul_i32 s43, s36, 160
    s_add_u32 s42, s42, s43
    s_and_b32 s44, s3, 1
    s_lshl_b32 s44, s44, 4
    v_add_u32 v176, s44, v1
    v_lshrrev_b32 v177, 3, v176
    v_cmp_eq_u32 vcc, v177, v2
    v_and_b32 v177, 7, v176
    v_and_b32 v178, 1, v177
    v_lshlrev_b32 v178, 4, v178
    v_mov_b32 v179, 0x3f80
    v_lshlrev_b32 v179, v178, v179
    v_lshrrev_b32 v177, 1, v177
    v_cndmask_b32 v179, 0, v179, vcc
    v_cmp_eq_u32 vcc, 0, v177
    s_nop 1
    v_cndmask_b32 v172, 0, v179, vcc
    v_cmp_eq_u32 vcc, 1, v177
    s_nop 1
    v_cndmask_b32 v173, 0, v179, vcc
    v_cmp_eq_u32 vcc, 2, v177
    s_nop 1
    v_cndmask_b32 v174, 0, v179, vcc
    v_cmp_eq_u32 vcc, 3, v177
    s_nop 1
    v_cndmask_b32 v175, 0, v179, vcc
    s_mov_b64 exec, 0
    s_branch PGS_f_0
PGR_f:
    s_mov_b64 exec, -1
    s_barrier
    ds_read_b128 v[24:27], v6 offset:5120
    ds_read_b128 v[28:31], v3 offset:0
    ds_read_b128 v[32:35], v3 offset:1024
    ds_read_b128 v[36:39], v3 offset:2048
    ds_read_b128 v[40:43], v3 offset:3072
    ds_read_b128 v[44:47], v3 offset:4096
    ds_read_b128 v[48:51], v6 offset:14336
    ds_read_b128 v[52:55], v3 offset:9216
    ds_read_b128 v[56:59], v3 offset:10240
    ds_read_b128 v[60:63], v3 offset:11264
    ds_read_b128 v[64:67], v3 offset:12288
    ds_read_b128 v[68:71], v3 offset:13312
    s_waitcnt lgkmcnt(0)
    s_barrier
    ds_read_b64 v[72:73], v19 offset:23552
    ds_read_b64 v[74:75], v19 offset:24064
    ds_read_b128 v[76:79], v3 offset:18432
    v_mfma_f32_16x16x32_bf16 v[120:123], v[28:31], v[24:27], 0
    ds_read_b128 v[80:83], v3 offset:19456
    v_mfma_f32_16x16x32_bf16 v[124:127], v[32:35], v[24:27], 0
    ds_read_b128 v[84:87], v3 offset:20480
    v_mfma_f32_16x16x32_bf16 v[128:131], v[36:39], v[24:27], 0
    ds_read_b128 v[88:91], v3 offset:21504
    v_mfma_f32_16x16x32_bf16 v[132:135], v[40:43], v[24:27], 0
    ds_read_b128 v[92:95], v3 offset:22528
    v_mfma_f32_16x16x32_bf16 v[136:139], v[44:47], v[24:27], 0
    ds_read_b128 v[96:99], v6 offset:32768
    v_mfma_f32_16x16x32_bf16 v[120:123], v[52:55], v[48:51], v[120:123]
    ds_read_b128 v[100:103], v3 offset:27648
    v_mfma_f32_16x16x32_bf16 v[124:127], v[56:59], v[48:51], v[124:127]
    ds_read_b128 v[104:107], v3 offset:28672
    v_mfma_f32_16x16x32_bf16 v[128:131], v[60:63], v[48:51], v[128:131]
    ds_read_b128 v[108:111], v3 offset:29696
    v_mfma_f32_16x16x32_bf16 v[132:135], v[64:67], v[48:51], v[132:135]
    ds_read_b128 v[112:115], v3 offset:30720
    v_mfma_f32_16x16x32_bf16 v[136:139], v[68:71], v[48:51], v[136:139]
    ds_read_b128 v[116:119], v3 offset:31744
    s_waitcnt lgkmcnt(0)
    s_barrier
    ds_read_b128 v[24:27], v6 offset:41984
    ds_read_b128 v[28:31], v3 offset:36864
    v_mfma_f32_16x16x32_bf16 v[120:123], v[76:79], v[72:75], v[120:123]
    ds_read_b128 v[32:35], v3 offset:37888
    v_mfma_f32_16x16x32_bf16 v[124:127], v[80:83], v[72:75], v[124:127]
    ds_read_b128 v[36:39], v3 offset:38912
    v_mfma_f32_16x16x32_bf16 v[128:131], v[84:87], v[72:75], v[128:131]
    ds_read_b128 v[40:43], v3 offset:39936
    v_mfma_f32_16x16x32_bf16 v[132:135], v[88:91], v[72:75], v[132:135]
    ds_read_b128 v[44:47], v3 offset:40960
    v_mfma_f32_16x16x32_bf16 v[136:139], v[92:95], v[72:75], v[136:139]
    ds_read_b128 v[48:51], v6 offset:51200
    v_mfma_f32_16x16x32_bf16 v[120:123], v[100:103], v[96:99], v[120:123]
    ds_read_b128 v[52:55], v3 offset:46080
    v_mfma_f32_16x16x32_bf16 v[124:127], v[104:107], v[96:99], v[124:127]
    ds_read_b128 v[56:59], v3 offset:47104
    v_mfma_f32_16x16x32_bf16 v[128:131], v[108:111], v[96:99], v[128:131]
    ds_read_b128 v[60:63], v3 offset:48128
    v_mfma_f32_16x16x32_bf16 v[132:135], v[112:115], v[96:99], v[132:135]
    ds_read_b128 v[64:67], v3 offset:49152
    v_mfma_f32_16x16x32_bf16 v[136:139], v[116:119], v[96:99], v[136:139]
    ds_read_b128 v[68:71], v3 offset:50176
    s_waitcnt lgkmcnt(0)
    s_barrier
    ds_read_b128 v[72:75], v7 offset:5120
    ds_read_b128 v[76:79], v4 offset:0
    v_mfma_f32_16x16x32_bf16 v[120:123], v[28:31], v[24:27], v[120:123]
    ds_read_b128 v[80:83], v4 offset:1024
    v_mfma_f32_16x16x32_bf16 v[124:127], v[32:35], v[24:27], v[124:127]
    ds_read_b128 v[84:87], v4 offset:2048
    v_mfma_f32_16x16x32_bf16 v[128:131], v[36:39], v[24:27], v[128:131]
    ds_read_b128 v[88:91], v4 offset:3072
    v_mfma_f32_16x16x32_bf16 v[132:135], v[40:43], v[24:27], v[132:135]
    ds_read_b128 v[92:95], v4 offset:4096
    v_mfma_f32_16x16x32_bf16 v[136:139], v[44:47], v[24:27], v[136:139]
    ds_read_b64 v[96:97], v20 offset:14336
    ds_read_b64 v[98:99], v20 offset:14848
    v_mfma_f32_16x16x32_bf16 v[120:123], v[52:55], v[48:51], v[120:123]
    ds_read_b128 v[100:103], v4 offset:9216
    v_mfma_f32_16x16x32_bf16 v[124:127], v[56:59], v[48:51], v[124:127]
    ds_read_b128 v[104:107], v4 offset:10240
    v_mfma_f32_16x16x32_bf16 v[128:131], v[60:63], v[48:51], v[128:131]
    ds_read_b128 v[108:111], v4 offset:11264
    v_mfma_f32_16x16x32_bf16 v[132:135], v[64:67], v[48:51], v[132:135]
    ds_read_b128 v[112:115], v4 offset:12288
    v_mfma_f32_16x16x32_bf16 v[136:139], v[68:71], v[48:51], v[136:139]
    ds_read_b128 v[116:119], v4 offset:13312
    s_waitcnt lgkmcnt(0)
    s_barrier
    ds_read_b128 v[24:27], v7 offset:23552
    ds_read_b128 v[28:31], v4 offset:18432
    v_mfma_f32_16x16x32_bf16 v[120:123], v[76:79], v[72:75], v[120:123]
    ds_read_b128 v[32:35], v4 offset:19456
    v_mfma_f32_16x16x32_bf16 v[124:127], v[80:83], v[72:75], v[124:127]
    ds_read_b128 v[36:39], v4 offset:20480
    v_mfma_f32_16x16x32_bf16 v[128:131], v[84:87], v[72:75], v[128:131]
    ds_read_b128 v[40:43], v4 offset:21504
    v_mfma_f32_16x16x32_bf16 v[132:135], v[88:91], v[72:75], v[132:135]
    ds_read_b128 v[44:47], v4 offset:22528
    v_mfma_f32_16x16x32_bf16 v[136:139], v[92:95], v[72:75], v[136:139]
    ds_read_b128 v[48:51], v7 offset:32768
    v_mfma_f32_16x16x32_bf16 v[120:123], v[100:103], v[96:99], v[120:123]
    ds_read_b128 v[52:55], v4 offset:27648
    v_mfma_f32_16x16x32_bf16 v[124:127], v[104:107], v[96:99], v[124:127]
    ds_read_b128 v[56:59], v4 offset:28672
    v_mfma_f32_16x16x32_bf16 v[128:131], v[108:111], v[96:99], v[128:131]
    ds_read_b128 v[60:63], v4 offset:29696
    v_mfma_f32_16x16x32_bf16 v[132:135], v[112:115], v[96:99], v[132:135]
    ds_read_b128 v[64:67], v4 offset:30720
    v_mfma_f32_16x16x32_bf16 v[136:139], v[116:119], v[96:99], v[136:139]
    ds_read_b128 v[68:71], v4 offset:31744
    s_waitcnt lgkmcnt(0)
    s_barrier
    ds_read_b128 v[72:75], v7 offset:41984
    ds_read_b128 v[76:79], v4 offset:36864
    v_mfma_f32_16x16x32_bf16 v[120:123], v[28:31], v[24:27], v[120:123]
    ds_read_b128 v[80:83], v4 offset:37888
    v_mfma_f32_16x16x32_bf16 v[124:127], v[32:35], v[24:27], v[124:127]
    ds_read_b128 v[84:87], v4 offset:38912
    v_mfma_f32_16x16x32_bf16 v[128:131], v[36:39], v[24:27], v[128:131]
    ds_read_b128 v[88:91], v4 offset:39936
    v_mfma_f32_16x16x32_bf16 v[132:135], v[40:43], v[24:27], v[132:135]
    ds_read_b128 v[92:95], v4 offset:40960
    v_mfma_f32_16x16x32_bf16 v[136:139], v[44:47], v[24:27], v[136:139]
    ds_read_b128 v[96:99], v7 offset:51200
    v_mfma_f32_16x16x32_bf16 v[120:123], v[52:55], v[48:51], v[120:123]
    ds_read_b128 v[100:103], v4 offset:46080
    v_mfma_f32_16x16x32_bf16 v[124:127], v[56:59], v[48:51], v[124:127]
    ds_read_b128 v[104:107], v4 offset:47104
    v_mfma_f32_16x16x32_bf16 v[128:131], v[60:63], v[48:51], v[128:131]
    ds_read_b128 v[108:111], v4 offset:48128
    v_mfma_f32_16x16x32_bf16 v[132:135], v[64:67], v[48:51], v[132:135]
    ds_read_b128 v[112:115], v4 offset:49152
    v_mfma_f32_16x16x32_bf16 v[136:139], v[68:71], v[48:51], v[136:139]
    ds_read_b128 v[116:119], v4 offset:50176
    s_waitcnt lgkmcnt(0)
    s_barrier
    ds_read_b64 v[24:25], v19 offset:5120
    ds_read_b64 v[26:27], v19 offset:5632
    ds_read_b128 v[28:31], v3 offset:0
    v_mfma_f32_16x16x32_bf16 v[120:123], v[76:79], v[72:75], v[120:123]
    ds_read_b128 v[32:35], v3 offset:1024
    v_mfma_f32_16x16x32_bf16 v[124:127], v[80:83], v[72:75], v[124:127]
    ds_read_b128 v[36:39], v3 offset:2048
    v_mfma_f32_16x16x32_bf16 v[128:131], v[84:87], v[72:75], v[128:131]
    ds_read_b128 v[40:43], v3 offset:3072
    v_mfma_f32_16x16x32_bf16 v[132:135], v[88:91], v[72:75], v[132:135]
    ds_read_b128 v[44:47], v3 offset:4096
    v_mfma_f32_16x16x32_bf16 v[136:139], v[92:95], v[72:75], v[136:139]
    ds_read_b128 v[48:51], v6 offset:14336
    v_mfma_f32_16x16x32_bf16 v[120:123], v[100:103], v[96:99], v[120:123]
    ds_read_b128 v[52:55], v3 offset:9216
    v_mfma_f32_16x16x32_bf16 v[124:127], v[104:107], v[96:99], v[124:127]
    ds_read_b128 v[56:59], v3 offset:10240
    v_mfma_f32_16x16x32_bf16 v[128:131], v[108:111], v[96:99], v[128:131]
    ds_read_b128 v[60:63], v3 offset:11264
    v_mfma_f32_16x16x32_bf16 v[132:135], v[112:115], v[96:99], v[132:135]
    ds_read_b128 v[64:67], v3 offset:12288
    v_mfma_f32_16x16x32_bf16 v[136:139], v[116:119], v[96:99], v[136:139]
    ds_read_b128 v[68:71], v3 offset:13312
    s_waitcnt lgkmcnt(0)
    s_barrier
    ds_read_b128 v[72:75], v6 offset:23552
    ds_read_b128 v[76:79], v3 offset:18432
    v_mfma_f32_16x16x32_bf16 v[120:123], v[28:31], v[24:27], v[120:123]
    ds_read_b128 v[80:83], v3 offset:19456
    v_mfma_f32_16x16x32_bf16 v[124:127], v[32:35], v[24:27], v[124:127]
    ds_read_b128 v[84:87], v3 offset:20480
    v_mfma_f32_16x16x32_bf16 v[128:131], v[36:39], v[24:27], v[128:131]
    ds_read_b128 v[88:91], v3 offset:21504
    v_mfma_f32_16x16x32_bf16 v[132:135], v[40:43], v[24:27], v[132:135]
    ds_read_b128 v[92:95], v3 offset:22528
    v_mfma_f32_16x16x32_bf16 v[136:139], v[44:47], v[24:27], v[136:139]
    ds_read_b128 v[96:99], v6 offset:32768
    v_mfma_f32_16x16x32_bf16 v[120:123], v[52:55], v[48:51], v[120:123]
    ds_read_b128 v[100:103], v3 offset:27648
    v_mfma_f32_16x16x32_bf16 v[124:127], v[56:59], v[48:51], v[124:127]
    ds_read_b128 v[104:107], v3 offset:28672
    v_mfma_f32_16x16x32_bf16 v[128:131], v[60:63], v[48:51], v[128:131]
    ds_read_b128 v[108:111], v3 offset:29696
    v_mfma_f32_16x16x32_bf16 v[132:135], v[64:67], v[48:51], v[132:135]
    ds_read_b128 v[112:115], v3 offset:30720
    v_mfma_f32_16x16x32_bf16 v[136:139], v[68:71], v[48:51], v[136:139]
    ds_read_b128 v[116:119], v3 offset:31744
    s_waitcnt lgkmcnt(0)
    s_barrier
    ds_read_b128 v[24:27], v6 offset:41984
    ds_read_b128 v[28:31], v3 offset:36864
    v_mfma_f32_16x16x32_bf16 v[120:123], v[76:79], v[72:75], v[120:123]
    ds_read_b128 v[32:35], v3 offset:37888
    v_mfma_f32_16x16x32_bf16 v[124:127], v[80:83], v[72:75], v[124:127]
    ds_read_b128 v[36:39], v3 offset:38912
    v_mfma_f32_16x16x32_bf16 v[128:131], v[84:87], v[72:75], v[128:131]
    ds_read_b128 v[40:43], v3 offset:39936
    v_mfma_f32_16x16x32_bf16 v[132:135], v[88:91], v[72:75], v[132:135]
    ds_read_b128 v[44:47], v3 offset:40960
    v_mfma_f32_16x16x32_bf16 v[136:139], v[92:95], v[72:75], v[136:139]
    ds_read_b64 v[48:49], v19 offset:51200
    ds_read_b64 v[50:51], v19 offset:51712
    v_mfma_f32_16x16x32_bf16 v[120:123], v[100:103], v[96:99], v[120:123]
    ds_read_b128 v[52:55], v3 offset:46080
    v_mfma_f32_16x16x32_bf16 v[124:127], v[104:107], v[96:99], v[124:127]
    ds_read_b128 v[56:59], v3 offset:47104
    v_mfma_f32_16x16x32_bf16 v[128:131], v[108:111], v[96:99], v[128:131]
    ds_read_b128 v[60:63], v3 offset:48128
    v_mfma_f32_16x16x32_bf16 v[132:135], v[112:115], v[96:99], v[132:135]
    ds_read_b128 v[64:67], v3 offset:49152
    v_mfma_f32_16x16x32_bf16 v[136:139], v[116:119], v[96:99], v[136:139]
    ds_read_b128 v[68:71], v3 offset:50176
    s_waitcnt lgkmcnt(0)
    s_barrier
    ds_read_b128 v[72:75], v7 offset:5120
    ds_read_b128 v[76:79], v4 offset:0
    v_mfma_f32_16x16x32_bf16 v[120:123], v[28:31], v[24:27], v[120:123]
    ds_read_b128 v[80:83], v4 offset:1024
    v_mfma_f32_16x16x32_bf16 v[124:127], v[32:35], v[24:27], v[124:127]
    ds_read_b128 v[84:87], v4 offset:2048
    v_mfma_f32_16x16x32_bf16 v[128:131], v[36:39], v[24:27], v[128:131]
    ds_read_b128 v[88:91], v4 offset:3072
    v_mfma_f32_16x16x32_bf16 v[132:135], v[40:43], v[24:27], v[132:135]
    ds_read_b128 v[92:95], v4 offset:4096
    v_mfma_f32_16x16x32_bf16 v[136:139], v[44:47], v[24:27], v[136:139]
    ds_read_b128 v[96:99], v7 offset:14336
    v_mfma_f32_16x16x32_bf16 v[120:123], v[52:55], v[48:51], v[120:123]
    ds_read_b128 v[100:103], v4 offset:9216
    v_mfma_f32_16x16x32_bf16 v[124:127], v[56:59], v[48:51], v[124:127]
    ds_read_b128 v[104:107], v4 offset:10240
    v_mfma_f32_16x16x32_bf16 v[128:131], v[60:63], v[48:51], v[128:131]
    ds_read_b128 v[108:111], v4 offset:11264
    v_mfma_f32_16x16x32_bf16 v[132:135], v[64:67], v[48:51], v[132:135]
    ds_read_b128 v[112:115], v4 offset:12288
    v_mfma_f32_16x16x32_bf16 v[136:139], v[68:71], v[48:51], v[136:139]
    ds_read_b128 v[116:119], v4 offset:13312
    s_waitcnt lgkmcnt(0)
    s_barrier
    ds_read_b128 v[24:27], v7 offset:23552
    ds_read_b128 v[28:31], v4 offset:18432
    v_mfma_f32_16x16x32_bf16 v[120:123], v[76:79], v[72:75], v[120:123]
    ds_read_b128 v[32:35], v4 offset:19456
    v_mfma_f32_16x16x32_bf16 v[124:127], v[80:83], v[72:75], v[124:127]
    ds_read_b128 v[36:39], v4 offset:20480
    v_mfma_f32_16x16x32_bf16 v[128:131], v[84:87], v[72:75], v[128:131]
    ds_read_b128 v[40:43], v4 offset:21504
    v_mfma_f32_16x16x32_bf16 v[132:135], v[88:91], v[72:75], v[132:135]
    ds_read_b128 v[44:47], v4 offset:22528
    v_mfma_f32_16x16x32_bf16 v[136:139], v[92:95], v[72:75], v[136:139]
    ds_read_b128 v[48:51], v7 offset:32768
    v_mfma_f32_16x16x32_bf16 v[120:123], v[100:103], v[96:99], v[120:123]
    ds_read_b128 v[52:55], v4 offset:27648
    v_mfma_f32_16x16x32_bf16 v[124:127], v[104:107], v[96:99], v[124:127]
    ds_read_b128 v[56:59], v4 offset:28672
    v_mfma_f32_16x16x32_bf16 v[128:131], v[108:111], v[96:99], v[128:131]
    ds_read_b128 v[60:63], v4 offset:29696
    v_mfma_f32_16x16x32_bf16 v[132:135], v[112:115], v[96:99], v[132:135]
    ds_read_b128 v[64:67], v4 offset:30720
    v_mfma_f32_16x16x32_bf16 v[136:139], v[116:119], v[96:99], v[136:139]
    ds_read_b128 v[68:71], v4 offset:31744
    s_waitcnt lgkmcnt(0)
    s_barrier
    ds_read_b64 v[72:73], v20 offset:41984
    ds_read_b64 v[74:75], v20 offset:42496
    ds_read_b128 v[76:79], v4 offset:36864
    v_mfma_f32_16x16x32_bf16 v[120:123], v[28:31], v[24:27], v[120:123]
    ds_read_b128 v[80:83], v4 offset:37888
    v_mfma_f32_16x16x32_bf16 v[124:127], v[32:35], v[24:27], v[124:127]
    ds_read_b128 v[84:87], v4 offset:38912
    v_mfma_f32_16x16x32_bf16 v[128:131], v[36:39], v[24:27], v[128:131]
    ds_read_b128 v[88:91], v4 offset:39936
    v_mfma_f32_16x16x32_bf16 v[132:135], v[40:43], v[24:27], v[132:135]
    ds_read_b128 v[92:95], v4 offset:40960
    v_mfma_f32_16x16x32_bf16 v[136:139], v[44:47], v[24:27], v[136:139]
    ds_read_b128 v[96:99], v7 offset:51200
    v_mfma_f32_16x16x32_bf16 v[120:123], v[52:55], v[48:51], v[120:123]
    ds_read_b128 v[100:103], v4 offset:46080
    v_mfma_f32_16x16x32_bf16 v[124:127], v[56:59], v[48:51], v[124:127]
    ds_read_b128 v[104:107], v4 offset:47104
    v_mfma_f32_16x16x32_bf16 v[128:131], v[60:63], v[48:51], v[128:131]
    ds_read_b128 v[108:111], v4 offset:48128
    v_mfma_f32_16x16x32_bf16 v[132:135], v[64:67], v[48:51], v[132:135]
    ds_read_b128 v[112:115], v4 offset:49152
    v_mfma_f32_16x16x32_bf16 v[136:139], v[68:71], v[48:51], v[136:139]
    ds_read_b128 v[116:119], v4 offset:50176
    s_waitcnt lgkmcnt(0)
    s_barrier
    ds_read_b128 v[24:27], v6 offset:5120
    ds_read_b128 v[28:31], v3 offset:0
    v_mfma_f32_16x16x32_bf16 v[120:123], v[76:79], v[72:75], v[120:123]
    ds_read_b128 v[32:35], v3 offset:1024
    v_mfma_f32_16x16x32_bf16 v[124:127], v[80:83], v[72:75], v[124:127]
    ds_read_b128 v[36:39], v3 offset:2048
    v_mfma_f32_16x16x32_bf16 v[128:131], v[84:87], v[72:75], v[128:131]
    ds_read_b128 v[40:43], v3 offset:3072
    v_mfma_f32_16x16x32_bf16 v[132:135], v[88:91], v[72:75], v[132:135]
    ds_read_b128 v[44:47], v3 offset:4096
    v_mfma_f32_16x16x32_bf16 v[136:139], v[92:95], v[72:75], v[136:139]
    ds_read_b128 v[48:51], v6 offset:14336
    v_mfma_f32_16x16x32_bf16 v[120:123], v[100:103], v[96:99], v[120:123]
    ds_read_b128 v[52:55], v3 offset:9216
    v_mfma_f32_16x16x32_bf16 v[124:127], v[104:107], v[96:99], v[124:127]
    ds_read_b128 v[56:59], v3 offset:10240
    v_mfma_f32_16x16x32_bf16 v[128:131], v[108:111], v[96:99], v[128:131]
    ds_read_b128 v[60:63], v3 offset:11264
    v_mfma_f32_16x16x32_bf16 v[132:135], v[112:115], v[96:99], v[132:135]
    ds_read_b128 v[64:67], v3 offset:12288
    v_mfma_f32_16x16x32_bf16 v[136:139], v[116:119], v[96:99], v[136:139]
    ds_read_b128 v[68:71], v3 offset:13312
    ds_read_b128 v[140:143], v9 offset:0
    ds_read_b64 v[160:161], v10 offset:0
    ds_read_b128 v[144:147], v9 offset:2048
    ds_read_b64 v[162:163], v10 offset:32
    ds_read_b128 v[148:151], v9 offset:4096
    ds_read_b64 v[164:165], v10 offset:64
    ds_read_b128 v[152:155], v9 offset:6144
    ds_read_b64 v[166:167], v10 offset:96
    ds_read_b128 v[156:159], v9 offset:8192
    ds_read_b64 v[168:169], v10 offset:128
    s_waitcnt lgkmcnt(0)
    s_barrier
    s_waitcnt vmcnt(0)
    ds_read_b128 v[72:75], v6 offset:23552
    ds_read_b128 v[76:79], v3 offset:18432
    v_mfma_f32_16x16x32_bf16 v[184:187], v[140:143], v[172:175], 0
    v_mfma_f32_16x16x32_bf16 v[120:123], v[28:31], v[24:27], v[120:123]
    ds_read_b128 v[80:83], v3 offset:19456
    v_lshlrev_b32 v176, 16, v160
    v_and_b32 v177, 0xffff0000, v160
    v_mfma_f32_16x16x32_bf16 v[124:127], v[32:35], v[24:27], v[124:127]
    ds_read_b128 v[84:87], v3 offset:20480
    v_lshlrev_b32 v178, 16, v161
    v_and_b32 v179, 0xffff0000, v161
    v_mfma_f32_16x16x32_bf16 v[128:131], v[36:39], v[24:27], v[128:131]
    ds_read_b128 v[88:91], v3 offset:21504
    v_add_f32 v176, v176, v171
    v_add_f32 v177, v177, v171
    v_mfma_f32_16x16x32_bf16 v[132:135], v[40:43], v[24:27], v[132:135]
    ds_read_b128 v[92:95], v3 offset:22528
    v_add_f32 v178, v178, v171
    v_add_f32 v179, v179, v171
    v_mfma_f32_16x16x32_bf16 v[136:139], v[44:47], v[24:27], v[136:139]
    ds_read_b64 v[96:97], v19 offset:32768
    ds_read_b64 v[98:99], v19 offset:33280
    v_cvt_pk_bf16_f32 v176, 0, v176
    v_cvt_pk_bf16_f32 v177, 0, v177
    v_mfma_f32_16x16x32_bf16 v[120:123], v[52:55], v[48:51], v[120:123]
    ds_read_b128 v[100:103], v3 offset:27648
    v_cvt_pk_bf16_f32 v178, 0, v178
    v_cvt_pk_bf16_f32 v179, 0, v179
    v_mfma_f32_16x16x32_bf16 v[124:127], v[56:59], v[48:51], v[124:127]
    ds_read_b128 v[104:107], v3 offset:28672
    v_mul_f32 v176, v176, v170
    v_mul_f32 v177, v177, v170
    v_mfma_f32_16x16x32_bf16 v[128:131], v[60:63], v[48:51], v[128:131]
    ds_read_b128 v[108:111], v3 offset:29696
    v_mul_f32 v178, v178, v170
    v_mul_f32 v179, v179, v170
    v_mfma_f32_16x16x32_bf16 v[132:135], v[64:67], v[48:51], v[132:135]
    ds_read_b128 v[112:115], v3 offset:30720
    v_cvt_pk_bf16_f32 v176, 0, v176
    v_cvt_pk_bf16_f32 v177, 0, v177
    v_mfma_f32_16x16x32_bf16 v[136:139], v[68:71], v[48:51], v[136:139]
    ds_read_b128 v[116:119], v3 offset:31744
    v_cvt_pk_bf16_f32 v178, 0, v178
    v_cvt_pk_bf16_f32 v179, 0, v179
    s_waitcnt lgkmcnt(0)
    s_barrier
    ds_read_b128 v[24:27], v6 offset:41984
    ds_read_b128 v[28:31], v3 offset:36864
    v_mfma_f32_16x16x32_bf16 v[120:123], v[76:79], v[72:75], v[120:123]
    ds_read_b128 v[32:35], v3 offset:37888
    v_mul_f32 v176, v176, v184
    v_mul_f32 v177, v177, v185
    v_mfma_f32_16x16x32_bf16 v[124:127], v[80:83], v[72:75], v[124:127]
    ds_read_b128 v[36:39], v3 offset:38912
    v_mul_f32 v178, v178, v186
    v_mul_f32 v179, v179, v187
    v_mfma_f32_16x16x32_bf16 v[128:131], v[84:87], v[72:75], v[128:131]
    ds_read_b128 v[40:43], v3 offset:39936
    v_cvt_pk_bf16_f32 v176, 0, v176
    v_cvt_pk_bf16_f32 v177, 0, v177
    v_mfma_f32_16x16x32_bf16 v[132:135], v[88:91], v[72:75], v[132:135]
    ds_read_b128 v[44:47], v3 offset:40960
    v_cvt_pk_bf16_f32 v178, 0, v178
    v_cvt_pk_bf16_f32 v179, 0, v179
    v_mfma_f32_16x16x32_bf16 v[136:139], v[92:95], v[72:75], v[136:139]
PGS_f_0:
    s_cbranch_execz PGR_f
    ds_read_b128 v[48:51], v6 offset:51200
    v_lshlrev_b32 v184, 16, v160
    v_and_b32 v185, 0xffff0000, v160
    v_mfma_f32_16x16x32_bf16 v[120:123], v[100:103], v[96:99], v[120:123]
    ds_read_b128 v[52:55], v3 offset:46080
    v_lshlrev_b32 v186, 16, v161
    v_and_b32 v187, 0xffff0000, v161
    v_mfma_f32_16x16x32_bf16 v[124:127], v[104:107], v[96:99], v[124:127]
    ds_read_b128 v[56:59], v3 offset:47104
    v_add_f32 v140, v176, v184
    v_add_f32 v141, v177, v185
    v_mfma_f32_16x16x32_bf16 v[128:131], v[108:111], v[96:99], v[128:131]
    ds_read_b128 v[60:63], v3 offset:48128
    v_add_f32 v142, v178, v186
    v_add_f32 v143, v179, v187
    v_mfma_f32_16x16x32_bf16 v[132:135], v[112:115], v[96:99], v[132:135]
    ds_read_b128 v[64:67], v3 offset:49152
    v_cvt_pk_bf16_f32 v140, 0, v140
    v_cvt_pk_bf16_f32 v141, 0, v141
    v_mfma_f32_16x16x32_bf16 v[136:139], v[116:119], v[96:99], v[136:139]
    ds_read_b128 v[68:71], v3 offset:50176
    v_cvt_pk_bf16_f32 v142, 0, v142
    v_cvt_pk_bf16_f32 v143, 0, v143
    s_waitcnt lgkmcnt(0)
    s_barrier
    ds_read_b128 v[72:75], v7 offset:5120
    ds_read_b128 v[76:79], v4 offset:0
    v_mfma_f32_16x16x32_bf16 v[188:191], v[144:147], v[172:175], 0
    v_mfma_f32_16x16x32_bf16 v[120:123], v[28:31], v[24:27], v[120:123]
    ds_read_b128 v[80:83], v4 offset:1024
    v_lshlrev_b32 v180, 16, v162
    v_and_b32 v181, 0xffff0000, v162
    v_mfma_f32_16x16x32_bf16 v[124:127], v[32:35], v[24:27], v[124:127]
    ds_read_b128 v[84:87], v4 offset:2048
    v_lshlrev_b32 v182, 16, v163
    v_and_b32 v183, 0xffff0000, v163
    v_mfma_f32_16x16x32_bf16 v[128:131], v[36:39], v[24:27], v[128:131]
    ds_read_b128 v[88:91], v4 offset:3072
    v_add_f32 v180, v180, v171
    v_add_f32 v181, v181, v171
    v_mfma_f32_16x16x32_bf16 v[132:135], v[40:43], v[24:27], v[132:135]
    ds_read_b128 v[92:95], v4 offset:4096
    v_add_f32 v182, v182, v171
    v_add_f32 v183, v183, v171
    v_mfma_f32_16x16x32_bf16 v[136:139], v[44:47], v[24:27], v[136:139]
    ds_read_b128 v[96:99], v7 offset:14336
    v_cvt_pk_bf16_f32 v180, 0, v180
    v_cvt_pk_bf16_f32 v181, 0, v181
    v_mfma_f32_16x16x32_bf16 v[120:123], v[52:55], v[48:51], v[120:123]
    ds_read_b128 v[100:103], v4 offset:9216
    v_cvt_pk_bf16_f32 v182, 0, v182
    v_cvt_pk_bf16_f32 v183, 0, v183
    v_mfma_f32_16x16x32_bf16 v[124:127], v[56:59], v[48:51], v[124:127]
    ds_read_b128 v[104:107], v4 offset:10240
    v_mul_f32 v180, v180, v170
    v_mul_f32 v181, v181, v170
    v_mfma_f32_16x16x32_bf16 v[128:131], v[60:63], v[48:51], v[128:131]
    ds_read_b128 v[108:111], v4 offset:11264
    v_mul_f32 v182, v182, v170
    v_mul_f32 v183, v183, v170
    v_mfma_f32_16x16x32_bf16 v[132:135], v[64:67], v[48:51], v[132:135]
    ds_read_b128 v[112:115], v4 offset:12288
    v_cvt_pk_bf16_f32 v180, 0, v180
    v_cvt_pk_bf16_f32 v181, 0, v181
    v_mfma_f32_16x16x32_bf16 v[136:139], v[68:71], v[48:51], v[136:139]
    ds_read_b128 v[116:119], v4 offset:13312
    v_cvt_pk_bf16_f32 v182, 0, v182
    v_cvt_pk_bf16_f32 v183, 0, v183
    s_waitcnt lgkmcnt(0)
    s_barrier
    ds_read_b64 v[24:25], v20 offset:23552
    ds_read_b64 v[26:27], v20 offset:24064
    ds_read_b128 v[28:31], v4 offset:18432
    v_mfma_f32_16x16x32_bf16 v[120:123], v[76:79], v[72:75], v[120:123]
    ds_read_b128 v[32:35], v4 offset:19456
    v_mul_f32 v180, v180, v188
    v_mul_f32 v181, v181, v189
    v_mfma_f32_16x16x32_bf16 v[124:127], v[80:83], v[72:75], v[124:127]
    ds_read_b128 v[36:39], v4 offset:20480
    v_mul_f32 v182, v182, v190
    v_mul_f32 v183, v183, v191
    v_mfma_f32_16x16x32_bf16 v[128:131], v[84:87], v[72:75], v[128:131]
    ds_read_b128 v[40:43], v4 offset:21504
    v_cvt_pk_bf16_f32 v180, 0, v180
    v_cvt_pk_bf16_f32 v181, 0, v181
    v_mfma_f32_16x16x32_bf16 v[132:135], v[88:91], v[72:75], v[132:135]
    ds_read_b128 v[44:47], v4 offset:22528
    v_cvt_pk_bf16_f32 v182, 0, v182
    v_cvt_pk_bf16_f32 v183, 0, v183
    v_mfma_f32_16x16x32_bf16 v[136:139], v[92:95], v[72:75], v[136:139]
    ds_read_b128 v[48:51], v7 offset:32768
    v_lshlrev_b32 v188, 16, v162
    v_and_b32 v189, 0xffff0000, v162
    v_mfma_f32_16x16x32_bf16 v[120:123], v[100:103], v[96:99], v[120:123]
    ds_read_b128 v[52:55], v4 offset:27648
    v_lshlrev_b32 v190, 16, v163
    v_and_b32 v191, 0xffff0000, v163
    v_mfma_f32_16x16x32_bf16 v[124:127], v[104:107], v[96:99], v[124:127]
    ds_read_b128 v[56:59], v4 offset:28672
    v_add_f32 v144, v180, v188
    v_add_f32 v145, v181, v189
    v_mfma_f32_16x16x32_bf16 v[128:131], v[108:111], v[96:99], v[128:131]
    ds_read_b128 v[60:63], v4 offset:29696
    v_add_f32 v146, v182, v190
    v_add_f32 v147, v183, v191
    v_mfma_f32_16x16x32_bf16 v[132:135], v[112:115], v[96:99], v[132:135]
    ds_read_b128 v[64:67], v4 offset:30720
    v_cvt_pk_bf16_f32 v144, 0, v144
    v_cvt_pk_bf16_f32 v145, 0, v145
    v_mfma_f32_16x16x32_bf16 v[136:139], v[116:119], v[96:99], v[136:139]
    ds_read_b128 v[68:71], v4 offset:31744
    v_cvt_pk_bf16_f32 v146, 0, v146
    v_cvt_pk_bf16_f32 v147, 0, v147
    s_waitcnt lgkmcnt(0)
    s_barrier
    ds_read_b128 v[72:75], v7 offset:41984
    ds_read_b128 v[76:79], v4 offset:36864
    v_mfma_f32_16x16x32_bf16 v[184:187], v[148:151], v[172:175], 0
    v_mfma_f32_16x16x32_bf16 v[120:123], v[28:31], v[24:27], v[120:123]
    ds_read_b128 v[80:83], v4 offset:37888
    v_lshlrev_b32 v176, 16, v164
    v_and_b32 v177, 0xffff0000, v164
    v_mfma_f32_16x16x32_bf16 v[124:127], v[32:35], v[24:27], v[124:127]
    ds_read_b128 v[84:87], v4 offset:38912
    v_lshlrev_b32 v178, 16, v165
    v_and_b32 v179, 0xffff0000, v165
    v_mfma_f32_16x16x32_bf16 v[128:131], v[36:39], v[24:27], v[128:131]
    ds_read_b128 v[88:91], v4 offset:39936
    v_add_f32 v176, v176, v171
    v_add_f32 v177, v177, v171
    v_mfma_f32_16x16x32_bf16 v[132:135], v[40:43], v[24:27], v[132:135]
    ds_read_b128 v[92:95], v4 offset:40960
    v_add_f32 v178, v178, v171
    v_add_f32 v179, v179, v171
    v_mfma_f32_16x16x32_bf16 v[136:139], v[44:47], v[24:27], v[136:139]
    ds_read_b128 v[96:99], v7 offset:51200
    v_cvt_pk_bf16_f32 v176, 0, v176
    v_cvt_pk_bf16_f32 v177, 0, v177
    v_mfma_f32_16x16x32_bf16 v[120:123], v[52:55], v[48:51], v[120:123]
    ds_read_b128 v[100:103], v4 offset:46080
    v_cvt_pk_bf16_f32 v178, 0, v178
    v_cvt_pk_bf16_f32 v179, 0, v179
    v_mfma_f32_16x16x32_bf16 v[124:127], v[56:59], v[48:51], v[124:127]
    ds_read_b128 v[104:107], v4 offset:47104
    v_mul_f32 v176, v176, v170
    v_mul_f32 v177, v177, v170
    v_mfma_f32_16x16x32_bf16 v[128:131], v[60:63], v[48:51], v[128:131]
    ds_read_b128 v[108:111], v4 offset:48128
    v_mul_f32 v178, v178, v170
    v_mul_f32 v179, v179, v170
    v_mfma_f32_16x16x32_bf16 v[132:135], v[64:67], v[48:51], v[132:135]
    ds_read_b128 v[112:115], v4 offset:49152
    v_cvt_pk_bf16_f32 v176, 0, v176
    v_cvt_pk_bf16_f32 v177, 0, v177
    v_mfma_f32_16x16x32_bf16 v[136:139], v[68:71], v[48:51], v[136:139]
    ds_read_b128 v[116:119], v4 offset:50176
    v_cvt_pk_bf16_f32 v178, 0, v178
    v_cvt_pk_bf16_f32 v179, 0, v179
    s_waitcnt lgkmcnt(0)
    s_barrier
    ds_read_b128 v[24:27], v6 offset:5120
    ds_read_b128 v[28:31], v3 offset:0
    v_mfma_f32_16x16x32_bf16 v[120:123], v[76:79], v[72:75], v[120:123]
    ds_read_b128 v[32:35], v3 offset:1024
    v_mul_f32 v176, v176, v184
    v_mul_f32 v177, v177, v185
    v_mfma_f32_16x16x32_bf16 v[124:127], v[80:83], v[72:75], v[124:127]
    ds_read_b128 v[36:39], v3 offset:2048
    v_mul_f32 v178, v178, v186
    v_mul_f32 v179, v179, v187
    v_mfma_f32_16x16x32_bf16 v[128:131], v[84:87], v[72:75], v[128:131]
    ds_read_b128 v[40:43], v3 offset:3072
    v_cvt_pk_bf16_f32 v176, 0, v176
    v_cvt_pk_bf16_f32 v177, 0, v177
    v_mfma_f32_16x16x32_bf16 v[132:135], v[88:91], v[72:75], v[132:135]
    ds_read_b128 v[44:47], v3 offset:4096
    v_cvt_pk_bf16_f32 v178, 0, v178
    v_cvt_pk_bf16_f32 v179, 0, v179
    v_mfma_f32_16x16x32_bf16 v[136:139], v[92:95], v[72:75], v[136:139]
    ds_read_b64 v[48:49], v19 offset:14336
    ds_read_b64 v[50:51], v19 offset:14848
    v_lshlrev_b32 v184, 16, v164
    v_and_b32 v185, 0xffff0000, v164
    v_mfma_f32_16x16x32_bf16 v[120:123], v[100:103], v[96:99], v[120:123]
    ds_read_b128 v[52:55], v3 offset:9216
    v_lshlrev_b32 v186, 16, v165
    v_and_b32 v187, 0xffff0000, v165
    v_mfma_f32_16x16x32_bf16 v[124:127], v[104:107], v[96:99], v[124:127]
    ds_read_b128 v[56:59], v3 offset:10240
    v_add_f32 v148, v176, v184
    v_add_f32 v149, v177, v185
    v_mfma_f32_16x16x32_bf16 v[128:131], v[108:111], v[96:99], v[128:131]
    ds_read_b128 v[60:63], v3 offset:11264
    v_add_f32 v150, v178, v186
    v_add_f32 v151, v179, v187
    v_mfma_f32_16x16x32_bf16 v[132:135], v[112:115], v[96:99], v[132:135]
    ds_read_b128 v[64:67], v3 offset:12288
    v_cvt_pk_bf16_f32 v148, 0, v148
    v_cvt_pk_bf16_f32 v149, 0, v149
    v_mfma_f32_16x16x32_bf16 v[136:139], v[116:119], v[96:99], v[136:139]
    ds_read_b128 v[68:71], v3 offset:13312
    v_cvt_pk_bf16_f32 v150, 0, v150
    v_cvt_pk_bf16_f32 v151, 0, v151
    s_waitcnt lgkmcnt(0)
    s_barrier
    ds_read_b128 v[72:75], v6 offset:23552
    ds_read_b128 v[76:79], v3 offset:18432
    v_mfma_f32_16x16x32_bf16 v[188:191], v[152:155], v[172:175], 0
    v_mfma_f32_16x16x32_bf16 v[120:123], v[28:31], v[24:27], v[120:123]
    ds_read_b128 v[80:83], v3 offset:19456
    v_lshlrev_b32 v180, 16, v166
    v_and_b32 v181, 0xffff0000, v166
    v_mfma_f32_16x16x32_bf16 v[124:127], v[32:35], v[24:27], v[124:127]
    ds_read_b128 v[84:87], v3 offset:20480
    v_lshlrev_b32 v182, 16, v167
    v_and_b32 v183, 0xffff0000, v167
    v_mfma_f32_16x16x32_bf16 v[128:131], v[36:39], v[24:27], v[128:131]
    ds_read_b128 v[88:91], v3 offset:21504
    v_add_f32 v180, v180, v171
    v_add_f32 v181, v181, v171
    v_mfma_f32_16x16x32_bf16 v[132:135], v[40:43], v[24:27], v[132:135]
    ds_read_b128 v[92:95], v3 offset:22528
    v_add_f32 v182, v182, v171
    v_add_f32 v183, v183, v171
    v_mfma_f32_16x16x32_bf16 v[136:139], v[44:47], v[24:27], v[136:139]
    ds_read_b128 v[96:99], v6 offset:32768
    v_cvt_pk_bf16_f32 v180, 0, v180
    v_cvt_pk_bf16_f32 v181, 0, v181
    v_mfma_f32_16x16x32_bf16 v[120:123], v[52:55], v[48:51], v[120:123]
    ds_read_b128 v[100:103], v3 offset:27648
    v_cvt_pk_bf16_f32 v182, 0, v182
    v_cvt_pk_bf16_f32 v183, 0, v183
    v_mfma_f32_16x16x32_bf16 v[124:127], v[56:59], v[48:51], v[124:127]
    ds_read_b128 v[104:107], v3 offset:28672
    v_mul_f32 v180, v180, v170
    v_mul_f32 v181, v181, v170
    v_mfma_f32_16x16x32_bf16 v[128:131], v[60:63], v[48:51], v[128:131]
    ds_read_b128 v[108:111], v3 offset:29696
    v_mul_f32 v182, v182, v170
    v_mul_f32 v183, v183, v170
    v_mfma_f32_16x16x32_bf16 v[132:135], v[64:67], v[48:51], v[132:135]
    ds_read_b128 v[112:115], v3 offset:30720
    v_cvt_pk_bf16_f32 v180, 0, v180
    v_cvt_pk_bf16_f32 v181, 0, v181
    v_mfma_f32_16x16x32_bf16 v[136:139], v[68:71], v[48:51], v[136:139]
    ds_read_b128 v[116:119], v3 offset:31744
    v_cvt_pk_bf16_f32 v182, 0, v182
    v_cvt_pk_bf16_f32 v183, 0, v183
    s_waitcnt lgkmcnt(0)
    s_barrier
    ds_read_b128 v[24:27], v6 offset:41984
    ds_read_b128 v[28:31], v3 offset:36864
    v_mfma_f32_16x16x32_bf16 v[120:123], v[76:79], v[72:75], v[120:123]
    ds_read_b128 v[32:35], v3 offset:37888
    v_mul_f32 v180, v180, v188
    v_mul_f32 v181, v181, v189
    v_mfma_f32_16x16x32_bf16 v[124:127], v[80:83], v[72:75], v[124:127]
    ds_read_b128 v[36:39], v3 offset:38912
    v_mul_f32 v182, v182, v190
    v_mul_f32 v183, v183, v191
    v_mfma_f32_16x16x32_bf16 v[128:131], v[84:87], v[72:75], v[128:131]
    ds_read_b128 v[40:43], v3 offset:39936
    v_cvt_pk_bf16_f32 v180, 0, v180
    v_cvt_pk_bf16_f32 v181, 0, v181
    v_mfma_f32_16x16x32_bf16 v[132:135], v[88:91], v[72:75], v[132:135]
    ds_read_b128 v[44:47], v3 offset:40960
    v_cvt_pk_bf16_f32 v182, 0, v182
    v_cvt_pk_bf16_f32 v183, 0, v183
    v_mfma_f32_16x16x32_bf16 v[136:139], v[92:95], v[72:75], v[136:139]
    ds_read_b128 v[48:51], v6 offset:51200
    v_lshlrev_b32 v188, 16, v166
    v_and_b32 v189, 0xffff0000, v166
    v_mfma_f32_16x16x32_bf16 v[120:123], v[100:103], v[96:99], v[120:123]
    ds_read_b128 v[52:55], v3 offset:46080
    v_lshlrev_b32 v190, 16, v167
    v_and_b32 v191, 0xffff0000, v167
    v_mfma_f32_16x16x32_bf16 v[124:127], v[104:107], v[96:99], v[124:127]
    ds_read_b128 v[56:59], v3 offset:47104
    v_add_f32 v152, v180, v188
    v_add_f32 v153, v181, v189
    v_mfma_f32_16x16x32_bf16 v[128:131], v[108:111], v[96:99], v[128:131]
    ds_read_b128 v[60:63], v3 offset:48128
    v_add_f32 v154, v182, v190
    v_add_f32 v155, v183, v191
    v_mfma_f32_16x16x32_bf16 v[132:135], v[112:115], v[96:99], v[132:135]
    ds_read_b128 v[64:67], v3 offset:49152
    v_cvt_pk_bf16_f32 v152, 0, v152
    v_cvt_pk_bf16_f32 v153, 0, v153
    v_mfma_f32_16x16x32_bf16 v[136:139], v[116:119], v[96:99], v[136:139]
    ds_read_b128 v[68:71], v3 offset:50176
    v_cvt_pk_bf16_f32 v154, 0, v154
    v_cvt_pk_bf16_f32 v155, 0, v155
    s_waitcnt lgkmcnt(0)
    s_barrier
    ds_read_b64 v[72:73], v20 offset:5120
    ds_read_b64 v[74:75], v20 offset:5632
    ds_read_b128 v[76:79], v4 offset:0
    v_mfma_f32_16x16x32_bf16 v[184:187], v[156:159], v[172:175], 0
    v_mfma_f32_16x16x32_bf16 v[120:123], v[28:31], v[24:27], v[120:123]
    ds_read_b128 v[80:83], v4 offset:1024
    v_lshlrev_b32 v176, 16, v168
    v_and_b32 v177, 0xffff0000, v168
    v_mfma_f32_16x16x32_bf16 v[124:127], v[32:35], v[24:27], v[124:127]
    ds_read_b128 v[84:87], v4 offset:2048
    v_lshlrev_b32 v178, 16, v169
    v_and_b32 v179, 0xffff0000, v169
    v_mfma_f32_16x16x32_bf16 v[128:131], v[36:39], v[24:27], v[128:131]
    ds_read_b128 v[88:91], v4 offset:3072
    v_add_f32 v176, v176, v171
    v_add_f32 v177, v177, v171
    v_mfma_f32_16x16x32_bf16 v[132:135], v[40:43], v[24:27], v[132:135]
    ds_read_b128 v[92:95], v4 offset:4096
    v_add_f32 v178, v178, v171
    v_add_f32 v179, v179, v171
    v_mfma_f32_16x16x32_bf16 v[136:139], v[44:47], v[24:27], v[136:139]
    ds_read_b128 v[96:99], v7 offset:14336
    v_cvt_pk_bf16_f32 v176, 0, v176
    v_cvt_pk_bf16_f32 v177, 0, v177
    v_mfma_f32_16x16x32_bf16 v[120:123], v[52:55], v[48:51], v[120:123]
    ds_read_b128 v[100:103], v4 offset:9216
    v_cvt_pk_bf16_f32 v178, 0, v178
    v_cvt_pk_bf16_f32 v179, 0, v179
    v_mfma_f32_16x16x32_bf16 v[124:127], v[56:59], v[48:51], v[124:127]
    ds_read_b128 v[104:107], v4 offset:10240
    v_mul_f32 v176, v176, v170
    v_mul_f32 v177, v177, v170
    v_mfma_f32_16x16x32_bf16 v[128:131], v[60:63], v[48:51], v[128:131]
    ds_read_b128 v[108:111], v4 offset:11264
    v_mul_f32 v178, v178, v170
    v_mul_f32 v179, v179, v170
    v_mfma_f32_16x16x32_bf16 v[132:135], v[64:67], v[48:51], v[132:135]
    ds_read_b128 v[112:115], v4 offset:12288
    v_cvt_pk_bf16_f32 v176, 0, v176
    v_cvt_pk_bf16_f32 v177, 0, v177
    v_mfma_f32_16x16x32_bf16 v[136:139], v[68:71], v[48:51], v[136:139]
    ds_read_b128 v[116:119], v4 offset:13312
    v_cvt_pk_bf16_f32 v178, 0, v178
    v_cvt_pk_bf16_f32 v179, 0, v179
    s_waitcnt lgkmcnt(0)
    s_barrier
    ds_read_b128 v[24:27], v7 offset:23552
    ds_read_b128 v[28:31], v4 offset:18432
    v_mfma_f32_16x16x32_bf16 v[120:123], v[76:79], v[72:75], v[120:123]
    ds_read_b128 v[32:35], v4 offset:19456
    v_mul_f32 v176, v176, v184
    v_mul_f32 v177, v177, v185
    v_mfma_f32_16x16x32_bf16 v[124:127], v[80:83], v[72:75], v[124:127]
    ds_read_b128 v[36:39], v4 offset:20480
    v_mul_f32 v178, v178, v186
    v_mul_f32 v179, v179, v187
    v_mfma_f32_16x16x32_bf16 v[128:131], v[84:87], v[72:75], v[128:131]
    ds_read_b128 v[40:43], v4 offset:21504
    v_cvt_pk_bf16_f32 v176, 0, v176
    v_cvt_pk_bf16_f32 v177, 0, v177
    v_mfma_f32_16x16x32_bf16 v[132:135], v[88:91], v[72:75], v[132:135]
    ds_read_b128 v[44:47], v4 offset:22528
    v_cvt_pk_bf16_f32 v178, 0, v178
    v_cvt_pk_bf16_f32 v179, 0, v179
    v_mfma_f32_16x16x32_bf16 v[136:139], v[92:95], v[72:75], v[136:139]
    ds_read_b128 v[48:51], v7 offset:32768
    v_lshlrev_b32 v184, 16, v168
    v_and_b32 v185, 0xffff0000, v168
    v_mfma_f32_16x16x32_bf16 v[120:123], v[100:103], v[96:99], v[120:123]
    ds_read_b128 v[52:55], v4 offset:27648
    v_lshlrev_b32 v186, 16, v169
    v_and_b32 v187, 0xffff0000, v169
    v_mfma_f32_16x16x32_bf16 v[124:127], v[104:107], v[96:99], v[124:127]
    ds_read_b128 v[56:59], v4 offset:28672
    v_add_f32 v156, v176, v184
    v_add_f32 v157, v177, v185
    v_mfma_f32_16x16x32_bf16 v[128:131], v[108:111], v[96:99], v[128:131]
    ds_read_b128 v[60:63], v4 offset:29696
    v_add_f32 v158, v178, v186
    v_add_f32 v159, v179, v187
    v_mfma_f32_16x16x32_bf16 v[132:135], v[112:115], v[96:99], v[132:135]
    ds_read_b128 v[64:67], v4 offset:30720
    v_cvt_pk_bf16_f32 v156, 0, v156
    v_cvt_pk_bf16_f32 v157, 0, v157
    v_mfma_f32_16x16x32_bf16 v[136:139], v[116:119], v[96:99], v[136:139]
    ds_read_b128 v[68:71], v4 offset:31744
    v_cvt_pk_bf16_f32 v158, 0, v158
    v_cvt_pk_bf16_f32 v159, 0, v159
    s_waitcnt lgkmcnt(0)
    s_barrier
    ds_read_b128 v[72:75], v7 offset:41984
    ds_read_b128 v[76:79], v4 offset:36864
    v_mfma_f32_16x16x32_bf16 v[120:123], v[28:31], v[24:27], v[120:123]
    ds_read_b128 v[80:83], v4 offset:37888
    v_mfma_f32_16x16x32_bf16 v[124:127], v[32:35], v[24:27], v[124:127]
    ds_read_b128 v[84:87], v4 offset:38912
    v_mfma_f32_16x16x32_bf16 v[128:131], v[36:39], v[24:27], v[128:131]
    ds_read_b128 v[88:91], v4 offset:39936
    v_mfma_f32_16x16x32_bf16 v[132:135], v[40:43], v[24:27], v[132:135]
    ds_read_b128 v[92:95], v4 offset:40960
    v_mfma_f32_16x16x32_bf16 v[136:139], v[44:47], v[24:27], v[136:139]
    ds_read_b64 v[96:97], v20 offset:51200
    ds_read_b64 v[98:99], v20 offset:51712
    v_mfma_f32_16x16x32_bf16 v[120:123], v[52:55], v[48:51], v[120:123]
    ds_read_b128 v[100:103], v4 offset:46080
    v_mfma_f32_16x16x32_bf16 v[124:127], v[56:59], v[48:51], v[124:127]
    ds_read_b128 v[104:107], v4 offset:47104
    v_mfma_f32_16x16x32_bf16 v[128:131], v[60:63], v[48:51], v[128:131]
    ds_read_b128 v[108:111], v4 offset:48128
    v_mfma_f32_16x16x32_bf16 v[132:135], v[64:67], v[48:51], v[132:135]
    ds_read_b128 v[112:115], v4 offset:49152
    v_mfma_f32_16x16x32_bf16 v[136:139], v[68:71], v[48:51], v[136:139]
    ds_read_b128 v[116:119], v4 offset:50176
    s_waitcnt lgkmcnt(0)
    s_barrier
    ds_read_b128 v[24:27], v6 offset:5120
    ds_read_b128 v[28:31], v3 offset:0
    v_mfma_f32_16x16x32_bf16 v[120:123], v[76:79], v[72:75], v[120:123]
    ds_read_b128 v[32:35], v3 offset:1024
    v_mfma_f32_16x16x32_bf16 v[124:127], v[80:83], v[72:75], v[124:127]
    ds_read_b128 v[36:39], v3 offset:2048
    v_mfma_f32_16x16x32_bf16 v[128:131], v[84:87], v[72:75], v[128:131]
    ds_read_b128 v[40:43], v3 offset:3072
    v_mfma_f32_16x16x32_bf16 v[132:135], v[88:91], v[72:75], v[132:135]
    ds_read_b128 v[44:47], v3 offset:4096
    v_mfma_f32_16x16x32_bf16 v[136:139], v[92:95], v[72:75], v[136:139]
    ds_read_b128 v[48:51], v6 offset:14336
    v_mfma_f32_16x16x32_bf16 v[120:123], v[100:103], v[96:99], v[120:123]
    ds_read_b128 v[52:55], v3 offset:9216
    v_mfma_f32_16x16x32_bf16 v[124:127], v[104:107], v[96:99], v[124:127]
    ds_read_b128 v[56:59], v3 offset:10240
    v_mfma_f32_16x16x32_bf16 v[128:131], v[108:111], v[96:99], v[128:131]
    ds_read_b128 v[60:63], v3 offset:11264
    v_mfma_f32_16x16x32_bf16 v[132:135], v[112:115], v[96:99], v[132:135]
    ds_read_b128 v[64:67], v3 offset:12288
    v_mfma_f32_16x16x32_bf16 v[136:139], v[116:119], v[96:99], v[136:139]
    ds_read_b128 v[68:71], v3 offset:13312
    s_waitcnt lgkmcnt(0)
    s_barrier
    ds_read_b128 v[72:75], v6 offset:23552
    ds_read_b128 v[76:79], v3 offset:18432
    v_mfma_f32_16x16x32_bf16 v[120:123], v[28:31], v[24:27], v[120:123]
    ds_read_b128 v[80:83], v3 offset:19456
    v_mfma_f32_16x16x32_bf16 v[124:127], v[32:35], v[24:27], v[124:127]
    ds_read_b128 v[84:87], v3 offset:20480
    v_mfma_f32_16x16x32_bf16 v[128:131], v[36:39], v[24:27], v[128:131]
    ds_read_b128 v[88:91], v3 offset:21504
    v_mfma_f32_16x16x32_bf16 v[132:135], v[40:43], v[24:27], v[132:135]
    ds_read_b128 v[92:95], v3 offset:22528
    v_mfma_f32_16x16x32_bf16 v[136:139], v[44:47], v[24:27], v[136:139]
    ds_read_b64 v[96:97], v19 offset:32768
    ds_read_b64 v[98:99], v19 offset:33280
    v_mfma_f32_16x16x32_bf16 v[120:123], v[52:55], v[48:51], v[120:123]
    ds_read_b128 v[100:103], v3 offset:27648
    v_mfma_f32_16x16x32_bf16 v[124:127], v[56:59], v[48:51], v[124:127]
    ds_read_b128 v[104:107], v3 offset:28672
    v_mfma_f32_16x16x32_bf16 v[128:131], v[60:63], v[48:51], v[128:131]
    ds_read_b128 v[108:111], v3 offset:29696
    v_mfma_f32_16x16x32_bf16 v[132:135], v[64:67], v[48:51], v[132:135]
    ds_read_b128 v[112:115], v3 offset:30720
    v_mfma_f32_16x16x32_bf16 v[136:139], v[68:71], v[48:51], v[136:139]
    ds_read_b128 v[116:119], v3 offset:31744
    s_waitcnt lgkmcnt(0)
    s_barrier
    ds_read_b128 v[24:27], v6 offset:41984
    ds_read_b128 v[28:31], v3 offset:36864
    v_mfma_f32_16x16x32_bf16 v[120:123], v[76:79], v[72:75], v[120:123]
    ds_read_b128 v[32:35], v3 offset:37888
    v_mfma_f32_16x16x32_bf16 v[124:127], v[80:83], v[72:75], v[124:127]
    ds_read_b128 v[36:39], v3 offset:38912
    v_mfma_f32_16x16x32_bf16 v[128:131], v[84:87], v[72:75], v[128:131]
    ds_read_b128 v[40:43], v3 offset:39936
    v_mfma_f32_16x16x32_bf16 v[132:135], v[88:91], v[72:75], v[132:135]
    ds_read_b128 v[44:47], v3 offset:40960
    v_mfma_f32_16x16x32_bf16 v[136:139], v[92:95], v[72:75], v[136:139]
    ds_read_b128 v[48:51], v6 offset:51200
    v_mfma_f32_16x16x32_bf16 v[120:123], v[100:103], v[96:99], v[120:123]
    ds_read_b128 v[52:55], v3 offset:46080
    v_mfma_f32_16x16x32_bf16 v[124:127], v[104:107], v[96:99], v[124:127]
    ds_read_b128 v[56:59], v3 offset:47104
    v_mfma_f32_16x16x32_bf16 v[128:131], v[108:111], v[96:99], v[128:131]
    ds_read_b128 v[60:63], v3 offset:48128
    v_mfma_f32_16x16x32_bf16 v[132:135], v[112:115], v[96:99], v[132:135]
    ds_read_b128 v[64:67], v3 offset:49152
    v_mfma_f32_16x16x32_bf16 v[136:139], v[116:119], v[96:99], v[136:139]
    ds_read_b128 v[68:71], v3 offset:50176
    s_waitcnt lgkmcnt(6)
    v_mfma_f32_16x16x32_bf16 v[120:123], v[28:31], v[24:27], v[120:123]
    v_mfma_f32_16x16x32_bf16 v[124:127], v[32:35], v[24:27], v[124:127]
    v_mfma_f32_16x16x32_bf16 v[128:131], v[36:39], v[24:27], v[128:131]
    v_mfma_f32_16x16x32_bf16 v[132:135], v[40:43], v[24:27], v[132:135]
    v_mfma_f32_16x16x32_bf16 v[136:139], v[44:47], v[24:27], v[136:139]
    s_waitcnt lgkmcnt(0)
    v_mfma_f32_16x16x32_bf16 v[120:123], v[52:55], v[48:51], v[120:123]
    v_mfma_f32_16x16x32_bf16 v[124:127], v[56:59], v[48:51], v[124:127]
    v_mfma_f32_16x16x32_bf16 v[128:131], v[60:63], v[48:51], v[128:131]
    v_mfma_f32_16x16x32_bf16 v[132:135], v[64:67], v[48:51], v[132:135]
    v_mfma_f32_16x16x32_bf16 v[136:139], v[68:71], v[48:51], v[136:139]
    s_nop 7
    v_cvt_pk_bf16_f32 v120, 0, v120
    v_cvt_pk_bf16_f32 v121, 0, v121
    v_cvt_pk_bf16_f32 v122, 0, v122
    v_cvt_pk_bf16_f32 v123, 0, v123
    v_add_f32 v120, v120, v140
    v_add_f32 v121, v121, v141
    v_add_f32 v122, v122, v142
    v_add_f32 v123, v123, v143
    v_cvt_pk_bf16_f32 v192, v120, v121
    v_cvt_pk_bf16_f32 v193, v122, v123
    ds_write_b64 v10, v[192:193] offset:0
    v_cvt_pk_bf16_f32 v124, 0, v124
    v_cvt_pk_bf16_f32 v125, 0, v125
    v_cvt_pk_bf16_f32 v126, 0, v126
    v_cvt_pk_bf16_f32 v127, 0, v127
    v_add_f32 v124, v124, v144
    v_add_f32 v125, v125, v145
    v_add_f32 v126, v126, v146
    v_add_f32 v127, v127, v147
    v_cvt_pk_bf16_f32 v194, v124, v125
    v_cvt_pk_bf16_f32 v195, v126, v127
    ds_write_b64 v10, v[194:195] offset:32
    v_cvt_pk_bf16_f32 v128, 0, v128
    v_cvt_pk_bf16_f32 v129, 0, v129
    v_cvt_pk_bf16_f32 v130, 0, v130
    v_cvt_pk_bf16_f32 v131, 0, v131
    v_add_f32 v128, v128, v148
    v_add_f32 v129, v129, v149
    v_add_f32 v130, v130, v150
    v_add_f32 v131, v131, v151
    v_cvt_pk_bf16_f32 v196, v128, v129
    v_cvt_pk_bf16_f32 v197, v130, v131
    ds_write_b64 v10, v[196:197] offset:64
    v_cvt_pk_bf16_f32 v132, 0, v132
    v_cvt_pk_bf16_f32 v133, 0, v133
    v_cvt_pk_bf16_f32 v134, 0, v134
    v_cvt_pk_bf16_f32 v135, 0, v135
    v_add_f32 v132, v132, v152
    v_add_f32 v133, v133, v153
    v_add_f32 v134, v134, v154
    v_add_f32 v135, v135, v155
    v_cvt_pk_bf16_f32 v198, v132, v133
    v_cvt_pk_bf16_f32 v199, v134, v135
    ds_write_b64 v10, v[198:199] offset:96
    s_nop 3
    v_cvt_pk_bf16_f32 v136, 0, v136
    v_cvt_pk_bf16_f32 v137, 0, v137
    v_cvt_pk_bf16_f32 v138, 0, v138
    v_cvt_pk_bf16_f32 v139, 0, v139
    v_add_f32 v136, v136, v156
    v_add_f32 v137, v137, v157
    v_add_f32 v138, v138, v158
    v_add_f32 v139, v139, v159
    v_cvt_pk_bf16_f32 v200, v136, v137
    v_cvt_pk_bf16_f32 v201, v138, v139
    ds_write_b64 v10, v[200:201] offset:128
    s_waitcnt lgkmcnt(0)
    ds_read_b128 v[24:27], v11 offset:0
    ds_read_b128 v[28:31], v11 offset:1024
    ds_read_b128 v[32:35], v11 offset:2048
    s_waitcnt lgkmcnt(2)
    buffer_store_dwordx4 v[24:27], v16, s[32:35], s42 offen
    s_waitcnt lgkmcnt(1)
    buffer_store_dwordx4 v[28:31], v17, s[32:35], s42 offen
    s_waitcnt lgkmcnt(0)
    s_mov_b64 exec, 0xffffffff
    buffer_store_dwordx4 v[32:35], v18, s[32:35], s42 offen
    s_mov_b64 exec, -1
F_exit:
    s_endpgm
CODE_END:
.section .rodata,"a"
.p2align 6
.amdhsa_kernel fin_kernel
  .amdhsa_next_free_vgpr 208
  .amdhsa_next_free_sgpr 80
  .amdhsa_accum_offset 208
  .amdhsa_group_segment_fixed_size 0
  .amdhsa_kernarg_size 104
  .amdhsa_user_sgpr_count 2
  .amdhsa_user_sgpr_kernarg_segment_ptr 1
  .amdhsa_system_sgpr_workgroup_id_x 1
.end_amdhsa_kernel
```
